```python
import torch

def _softmax(x, axis=-1):
    return torch.softmax(x, dim=axis)
def _gelu(x):
    return torch.nn.functional.gelu(x, approximate="tanh")
def _silu(x):
    return torch.nn.functional.silu(x)
def _sigmoid(x):
    return torch.sigmoid(x)
def _layernorm(x, axis=-1, eps=1e-5):
    m = x.mean(dim=axis, keepdim=True)
    v = x.var(dim=axis, keepdim=True, unbiased=False)
    return (x - m) / torch.sqrt(v + eps)
def _scatter_add(tgt, idx, src, axis=0):
    return tgt.clone().index_add_(axis, idx, src)
def _segment_sum(src, seg, n):
    out = torch.zeros((n,) + src.shape[1:], dtype=src.dtype)
    return out.index_add_(0, seg, src)
def _pad(x, pw):
    flat = tuple(v for pair in reversed(pw) for v in pair)
    return torch.nn.functional.pad(x, flat)

kernel_name = 'recurrent_scan__ssm_conv_s4d__mixer_s_mlp__prompt'

def setup_inputs():

    _w = (lambda a: (lambda t: t.to(torch.bfloat16) if t.is_floating_point() else t)(torch.as_tensor(a)))
    def _A_setup():
        Bsz, L, D, N = 1, 2048, 512, 128
        return {
            "u": _w((lambda *s: torch.randn(*s, dtype=torch.bfloat16) * 0.05)(Bsz, L, D)),
            "log_A_real": _w((lambda *s: torch.randn(*s, dtype=torch.bfloat16) * 6.4)(D, N) * 0.5),
            "A_imag": _w((lambda *s: torch.randn(*s, dtype=torch.bfloat16) * 0.05)(D, N) * 3.14),
            "C_real": _w((lambda *s: torch.randn(*s, dtype=torch.bfloat16) * 0.05)(D, N) / N ** 0.5),
            "C_imag": _w((lambda *s: torch.randn(*s, dtype=torch.bfloat16) * 0.05)(D, N) / N ** 0.5),
            "log_dt": _w((lambda *s: torch.randn(*s, dtype=torch.bfloat16) * 0.05)(D) * 0.5 - 4.0),
            "D_skip": _w((lambda *s: torch.randn(*s, dtype=torch.bfloat16) * 0.05)(D)),
        }
    _A_in = _A_setup()

    def _B_setup():
        B, S, D, F = 1, 2048, 512, 1792
        return {
            "x":  _w((lambda *s: torch.randn(*s, dtype=torch.bfloat16) * 0.05)(B, S, D)),
            "w1": _w((lambda *s: torch.randn(*s, dtype=torch.bfloat16) * 6.4)(D, D) * (D ** -0.5)),
            "w2": _w((lambda *s: torch.randn(*s, dtype=torch.bfloat16) * 6.4)(D, D) * (D ** -0.5)),
            "w3": _w((lambda *s: torch.randn(*s, dtype=torch.bfloat16) * 6.4)(D, F) * (D ** -0.5)),
            "w4": _w((lambda *s: torch.randn(*s, dtype=torch.bfloat16) * 6.4)(F, D) * (F ** -0.5)),
        }
    _B_in = _B_setup()

    return {
        "A_u": _A_in["u"],
        "A_log_A_real": _A_in["log_A_real"],
        "A_A_imag": _A_in["A_imag"],
        "A_C_real": _A_in["C_real"],
        "A_C_imag": _A_in["C_imag"],
        "A_log_dt": _A_in["log_dt"],
        "A_D_skip": _A_in["D_skip"],
        "B_x": _B_in["x"],
        "B_w1": _B_in["w1"],
        "B_w2": _B_in["w2"],
        "B_w3": _B_in["w3"],
        "B_w4": _B_in["w4"],
    }

def reference(A_u, A_log_A_real, A_A_imag, A_C_real, A_C_imag, A_log_dt, A_D_skip, B_x, B_w1, B_w2, B_w3, B_w4):
    def _A_ref(u, log_A_real, A_imag, C_real, C_imag, log_dt, D_skip):
        L = u.shape[1]
        dt = torch.exp(log_dt)
        A = -torch.exp(log_A_real) + 1j * A_imag
        C = (C_real + 1j * C_imag) * dt[:, None]
        pos = (lambda x, dt: x.to(dt))(torch.arange(L), log_dt.dtype)
        P = torch.exp((A * dt[:, None])[:, :, None] * pos[None, None, :])
        K = 2.0 * torch.einsum("dn,dnl->dl", C, P).real
        L2 = 2 * L
        u_t = (lambda x, *d: x.permute(*d))(u, 0, 2, 1)
        Kf = (lambda x, *a, **k: torch.fft.rfft(x.float(), *a, **k))(K, L2)
        Uf = (lambda x, *a, **k: torch.fft.rfft(x.float(), *a, **k))(u_t, L2)
        y = (lambda x, *a, **k: torch.fft.irfft(x, *a, **k).to(torch.bfloat16))(Uf * Kf[None, :, :], L2)[:, :, :L]
        y = (lambda x, *d: x.permute(*d))(y, 0, 2, 1)
        return y + u * D_skip[None, None, :]

    def _B_ref(x, w1, w2, w3, w4):
        B, S, D = x.shape
        h = _gelu(_layernorm(x, axis=-1) @ w1)
        c = D // 4
        g0 = _pad(h[:, :, 0*c:1*c], ((0, 0), (1, 0), (0, 0)))[:, :S, :]
        g1 = _pad(h[:, :, 1*c:2*c], ((0, 0), (0, 1), (0, 0)))[:, 1:, :]
        g2 = _pad(h[:, :, 2*c:3*c], ((0, 0), (2, 0), (0, 0)))[:, :S, :]
        g3 = _pad(h[:, :, 3*c:   ], ((0, 0), (0, 2), (0, 0)))[:, 2:, :]
        hs = torch.concatenate([g0, g1, g2, g3], axis=-1) @ w2
        x1 = x + hs
        h2 = _gelu(_layernorm(x1, axis=-1) @ w3) @ w4
        return x1 + h2

    x = A_u
    xn = _layernorm(x, axis=-1)
    s = _A_ref(xn, A_log_A_real, A_A_imag, A_C_real, A_C_imag, A_log_dt, A_D_skip)
    g = _silu(_B_ref(xn, B_w1, B_w2, B_w3, B_w4))
    return x + s * g
```

```asm
; @launch grid=(256,1,1) block=(256,1,1) lds=163840
.amdgcn_target "amdgcn-amd-amdhsa--gfx950"
.text
.globl recurrent_scan__ssm_conv_s4d__mixer_s_mlp__prompt_kernel
.p2align 8
.type recurrent_scan__ssm_conv_s4d__mixer_s_mlp__prompt_kernel,@function
recurrent_scan__ssm_conv_s4d__mixer_s_mlp__prompt_kernel:
  s_cmp_ge_u32 s2, 0x100
  s_cbranch_scc1 L_end
  s_load_dwordx16 s[4:19], s[0:1], 0
  s_load_dwordx8 s[20:27], s[0:1], 64
  s_load_dwordx4 s[28:31], s[0:1], 96
  s_load_dwordx2 s[32:33], s[0:1], 112
  s_getpc_b64 s[66:67]
L_pc:
  v_lshrrev_b32 v6, 6, v0
  v_and_b32 v7, 3, v0
  s_lshr_b32 s81, s2, 3
  v_mad_u32_u24 v6, v6, 4, v7
  s_mul_i32 s81, s81, 16
  v_add_lshl_u32 v6, v6, s81, 7
  s_mov_b32 s81, L_end-L_pc
  v_mov_b32 v11, s67
  v_min_u32 v6, s81, v6
  v_add_co_u32 v10, vcc, s66, v6
  s_nop 1
  v_addc_co_u32 v11, vcc, 0, v11, vcc
  global_load_dword v253, v[10:11], off
  v_lshrrev_b32 v6, 6, v0
  v_and_b32 v1, 63, v0
  v_readfirstlane_b32 s3, v6
  v_and_b32 v2, 15, v0
  v_bfe_u32 v3, v0, 4, 2
  v_and_b32 v4, 31, v0
  v_bfe_u32 v5, v0, 5, 1
  s_and_b32 s34, s2, 7
  s_lshr_b32 s35, s2, 3
  s_lshr_b32 s76, s2, 6
  s_and_b32 s77, s35, 7
  s_lshl_b32 s78, s34, 8
  s_lshl_b32 s85, s76, 6
  s_add_u32 s78, s78, s85
  s_lshr_b32 s81, s77, 2
  s_add_u32 s79, s81, 1
  s_sub_u32 s81, 0, s79
  s_bitcmp1_b32 s77, 1
  s_cselect_b32 s79, s81, s79
  s_lshr_b32 s89, s3, 1
  s_and_b32 s90, s3, 1
  s_lshl_b32 s87, s34, 6
  s_lshl_b32 s85, s35, 1
  s_add_u32 s87, s87, s85
  s_add_u32 s87, s87, s89
  s_mov_b32 s38, 0x200000
  s_mov_b32 s39, 0x20000
  s_mov_b32 s42, 0x80000
  s_mov_b32 s43, 0x20000
  s_mov_b32 s46, 0x80000
  s_mov_b32 s47, 0x20000
  s_mov_b32 s50, 0x1c0000
  s_mov_b32 s51, 0x20000
  s_mov_b32 s54, 0x1c0000
  s_mov_b32 s55, 0x20000
  s_mov_b32 s58, 0x200000
  s_mov_b32 s59, 0x20000
  s_mov_b32 s62, 0x2000000
  s_mov_b32 s63, 0x20000
  s_lshl_b32 s82, s90, 6
  s_lshl_b32 s85, s87, 7
  s_add_u32 s82, s82, s85
  v_add_lshl_u32 v11, s82, v1, 1
  s_lshl_b32 s83, s87, 1
  v_mov_b32 v12, s83
  v_mov_b32 v9, 0
  s_lshl_b32 s91, s3, 4
  s_add_u32 s91, s91, s78
  s_sub_u32 s81, s91, s79
  s_movk_i32 s82, 0x7ff
  v_add_u32 v7, 0, v3
  v_add_u32 v8, s81, v7
  v_med3_i32 v8, v8, 0, s82
  v_xor_b32 v7, v7, v2
  v_lshlrev_b32 v7, 4, v7
  v_lshl_add_u32 v13, v8, 10, v7
  v_add_u32 v7, 4, v3
  v_add_u32 v8, s81, v7
  v_med3_i32 v8, v8, 0, s82
  v_xor_b32 v7, v7, v2
  v_lshlrev_b32 v7, 4, v7
  v_lshl_add_u32 v14, v8, 10, v7
  v_add_u32 v7, 8, v3
  v_add_u32 v8, s81, v7
  v_med3_i32 v8, v8, 0, s82
  v_xor_b32 v7, v7, v2
  v_lshlrev_b32 v7, 4, v7
  v_lshl_add_u32 v15, v8, 10, v7
  v_add_u32 v7, 12, v3
  v_add_u32 v8, s81, v7
  v_med3_i32 v8, v8, 0, s82
  v_xor_b32 v7, v7, v2
  v_lshlrev_b32 v7, 4, v7
  v_lshl_add_u32 v16, v8, 10, v7
  s_add_u32 s81, s78, 64
  s_sub_u32 s81, s81, s79
  s_cmp_gt_i32 s79, 0
  s_cselect_b32 s81, s81, s78
  v_add_u32 v8, s81, v3
  v_min_i32 v8, s82, v8
  v_xor_b32 v7, v3, v2
  v_lshlrev_b32 v7, 4, v7
  v_lshl_add_u32 v17, v8, 10, v7
  v_lshrrev_b32 v7, 3, v1
  v_and_b32 v8, 2, v7
  v_and_b32 v6, 7, v1
  v_xor_b32 v8, v8, v6
  v_lshlrev_b32 v8, 4, v8
  v_lshl_add_u32 v8, v7, 10, v8
  s_lshl_b32 s81, s77, 7
  s_lshl_b32 s85, s3, 15
  s_add_u32 s81, s81, s85
  v_add_u32 v18, s81, v8
  v_xor_b32 v8, 64, v18
  v_add_u32 v19, 7168, v8
  v_add_u32 v20, 14336, v18
  v_add_u32 v21, 21504, v8
  s_lshr_b32 s81, s77, 1
  s_add_u32 s81, s81, s76
  s_add_u32 s82, s81, 0
  s_and_b32 s82, s82, 3
  s_lshl_b32 s92, s82, 8
  s_add_u32 s82, s81, 1
  s_and_b32 s82, s82, 3
  s_lshl_b32 s93, s82, 8
  s_add_u32 s82, s81, 2
  s_and_b32 s82, s82, 3
  s_lshl_b32 s94, s82, 8
  s_add_u32 s82, s81, 3
  s_and_b32 s82, s82, 3
  s_lshl_b32 s95, s82, 8
  s_lshl_b32 s96, s3, 12
  v_xor_b32 v6, v3, v2
  v_lshlrev_b32 v6, 4, v6
  v_lshl_add_u32 v6, v2, 8, v6
  v_add_u32 v31, 0x4000, v6
  v_xor_b32 v32, 64, v31
  v_xor_b32 v33, 128, v31
  v_xor_b32 v34, 192, v31
  v_bfe_u32 v6, v1, 2, 2
  v_lshl_add_u32 v7, v3, 3, v6
  v_lshrrev_b32 v6, 1, v6
  v_and_b32 v8, 1, v3
  v_lshl_add_u32 v6, v8, 1, v6
  v_lshlrev_b32 v6, 5, v6
  v_lshl_add_u32 v6, v7, 7, v6
  v_and_b32 v7, 3, v1
  v_lshl_add_u32 v48, v7, 3, v6
  v_xor_b32 v49, 32, v48
  v_xor_b32 v50, 64, v48
  v_xor_b32 v51, 96, v48
  s_lshl_b32 s81, s3, 5
  v_xor_b32 v35, s81, v48
  v_add_u32 v36, 0x10000, v35
  v_bfe_u32 v6, v1, 2, 2
  v_lshl_add_u32 v6, v5, 2, v6
  v_lshlrev_b32 v6, 6, v6
  v_lshl_add_u32 v6, v8, 5, v6
  v_lshl_add_u32 v37, v7, 3, v6
  v_lshlrev_b32 v38, 4, v1
  v_mov_b32 v40, 0x3f803f80
  v_mov_b32 v41, 0x3f803f80
  v_mov_b32 v42, 0x3f803f80
  v_mov_b32 v43, 0x3f803f80
  v_cmp_eq_u32 s[66:67], 1, v7
  v_cmp_eq_u32 s[68:69], 2, v7
  v_cmp_eq_u32 s[70:71], 3, v7
  s_lshl_b32 s81, s3, 8
  s_add_u32 s81, s81, 0x21000
  v_lshl_add_u32 v39, v2, 4, s81
  v_lshlrev_b32 v44, 4, v2
  v_add_u32 v44, 0x21000, v44
  s_mov_b32 s81, 0x21400
  v_writelane_b32 v39, s81, 4
  s_mov_b32 s81, 0x21410
  v_writelane_b32 v39, s81, 16
  v_lshlrev_b32 v6, 11, v5
  v_lshl_add_u32 v6, v8, 8, v6
  v_lshl_add_u32 v6, v2, 4, v6
  v_add_u32 v45, 0x20000, v6
  v_xor_b32 v6, s3, v8
  v_lshl_add_u32 v6, v6, 4, v2
  v_lshl_add_u32 v6, v5, 11, v6
  v_add_lshl_u32 v46, s78, v6, 4
  v_lshl_add_u32 v47, v3, 11, s91
  v_add_lshl_u32 v47, v47, v2, 4
  s_mov_b32 s72, 0x409d30fc
  s_mov_b32 s73, 0x409d30fc
  s_mov_b32 s74, 0xbeeff558
  s_mov_b32 s75, 0xbeeff558
  s_waitcnt lgkmcnt(0)
  s_mov_b64 s[36:37], s[4:5]
  s_mov_b64 s[40:41], s[20:21]
  s_mov_b64 s[60:61], s[32:33]
  s_load_dword s80, s[32:33], 0
  global_load_ushort v22, v11, s[6:7]
  global_load_ushort v23, v11, s[8:9]
  global_load_ushort v24, v11, s[10:11]
  global_load_ushort v25, v11, s[12:13]
  global_load_ushort v26, v12, s[14:15]
  global_load_ushort v27, v12, s[16:17]
  s_lshl_b32 s88, s92, 9
  s_add_u32 m0, s96, 0x0
  s_nop 0
  buffer_load_dwordx4 v18, s[40:43], s88 offen lds
  buffer_load_dwordx4 v19, s[40:43], s88 offen offset:1024 lds
  buffer_load_dwordx4 v20, s[40:43], s88 offen offset:2048 lds
  buffer_load_dwordx4 v21, s[40:43], s88 offen offset:3072 lds
  s_mul_i32 s81, s3, 14464
  s_add_u32 s81, s81, 0x10000
  v_lshl_add_u32 v65, v1, 2, s81
  v_mul_u32_u24 v66, 272, v4
  v_lshl_add_u32 v66, v5, 4, v66
  v_add_u32 v66, s81, v66
  s_mul_i32 s81, s3, 3072
  s_add_u32 s81, s81, 0x24000
  v_lshlrev_b32 v67, 5, v4
  v_lshl_add_u32 v67, v5, 4, v67
  v_add_u32 v67, s81, v67
  v_cmp_eq_u32 vcc, 0, v5
  v_lshlrev_b32 v7, 4, v4
  v_lshlrev_b32 v8, 3, v4
  v_add_u32 v68, 1024, v7
  v_add_u32 v6, 1536, v8
  v_cndmask_b32 v68, v6, v68, vcc
  v_add_u32 v7, 1032, v7
  v_add_u32 v8, 1792, v8
  v_cndmask_b32 v69, v8, v7, vcc
  v_add_u32 v68, s81, v68
  v_add_u32 v69, s81, v69
  v_lshlrev_b32 v8, 2, v4
  v_lshl_add_u32 v8, v5, 9, v8
  v_add_u32 v70, s81, v8
  s_lshl_b32 s81, s3, 12
  v_add_u32 v31, s81, v31
  v_add_u32 v32, s81, v32
  v_add_u32 v33, s81, v33
  v_add_u32 v34, s81, v34
  v_xor_b32 v71, 0x1000, v31
  v_xor_b32 v72, 0x1000, v32
  v_xor_b32 v73, 0x1000, v33
  v_xor_b32 v74, 0x1000, v34
  v_xor_b32 v75, 0x2000, v31
  v_xor_b32 v76, 0x2000, v32
  v_xor_b32 v77, 0x2000, v33
  v_xor_b32 v78, 0x2000, v34
  v_xor_b32 v79, 0x3000, v31
  v_xor_b32 v80, 0x3000, v32
  v_xor_b32 v81, 0x3000, v33
  v_xor_b32 v82, 0x3000, v34
  v_add_u32 v83, 0x10000, v31
  v_add_u32 v84, 0x10000, v32
  v_add_u32 v85, 0x10000, v33
  v_add_u32 v86, 0x10000, v34
  v_add_u32 v87, 0x10000, v71
  v_add_u32 v88, 0x10000, v72
  v_add_u32 v89, 0x10000, v73
  v_add_u32 v90, 0x10000, v74
  v_add_u32 v91, 0x10000, v75
  v_add_u32 v92, 0x10000, v76
  v_add_u32 v93, 0x10000, v77
  v_add_u32 v94, 0x10000, v78
  v_add_u32 v95, 0x10000, v79
  v_add_u32 v96, 0x10000, v80
  v_add_u32 v97, 0x10000, v81
  v_add_u32 v98, 0x10000, v82
  s_add_u32 m0, s96, 0x4000
  s_nop 0
  buffer_load_dwordx4 v13, s[36:39], s92 offen lds
  s_add_u32 m0, s96, 0x4400
  s_nop 0
  buffer_load_dwordx4 v14, s[36:39], s92 offen lds
  s_add_u32 m0, s96, 0x4800
  s_nop 0
  buffer_load_dwordx4 v15, s[36:39], s92 offen lds
  s_add_u32 m0, s96, 0x4c00
  s_nop 0
  buffer_load_dwordx4 v16, s[36:39], s92 offen lds
  v_lshlrev_b32 v8, 3, v0
  s_movk_i32 s82, 0x80
  s_mov_b32 s81, 0x27000
  v_add_u32 v6, 1, v8
  v_cvt_f32_u32 v7, v6
  v_cvt_pk_bf16_f32 v7, v7, 0
  v_subrev_u32 v7, 0x4280, v7
  v_med3_i32 v7, v6, v7, s82
  v_lshl_add_u32 v54, v7, 2, s81
  v_add_u32 v6, 2, v8
  v_cvt_f32_u32 v7, v6
  v_cvt_pk_bf16_f32 v7, v7, 0
  v_subrev_u32 v7, 0x4280, v7
  v_med3_i32 v7, v6, v7, s82
  v_lshl_add_u32 v55, v7, 2, s81
  v_add_u32 v6, 3, v8
  v_cvt_f32_u32 v7, v6
  v_cvt_pk_bf16_f32 v7, v7, 0
  v_subrev_u32 v7, 0x4280, v7
  v_med3_i32 v7, v6, v7, s82
  v_lshl_add_u32 v56, v7, 2, s81
  v_add_u32 v6, 4, v8
  v_cvt_f32_u32 v7, v6
  v_cvt_pk_bf16_f32 v7, v7, 0
  v_subrev_u32 v7, 0x4280, v7
  v_med3_i32 v7, v6, v7, s82
  v_lshl_add_u32 v57, v7, 2, s81
  v_add_u32 v6, 5, v8
  v_cvt_f32_u32 v7, v6
  v_cvt_pk_bf16_f32 v7, v7, 0
  v_subrev_u32 v7, 0x4280, v7
  v_med3_i32 v7, v6, v7, s82
  v_lshl_add_u32 v58, v7, 2, s81
  v_add_u32 v6, 6, v8
  v_cvt_f32_u32 v7, v6
  v_cvt_pk_bf16_f32 v7, v7, 0
  v_subrev_u32 v7, 0x4280, v7
  v_med3_i32 v7, v6, v7, s82
  v_lshl_add_u32 v59, v7, 2, s81
  v_add_u32 v6, 7, v8
  v_cvt_f32_u32 v7, v6
  v_cvt_pk_bf16_f32 v7, v7, 0
  v_subrev_u32 v7, 0x4280, v7
  v_med3_i32 v7, v6, v7, s82
  v_lshl_add_u32 v60, v7, 2, s81
  v_add_u32 v6, 8, v8
  v_cvt_f32_u32 v7, v6
  v_cvt_pk_bf16_f32 v7, v7, 0
  v_subrev_u32 v7, 0x4280, v7
  v_med3_i32 v7, v6, v7, s82
  v_lshl_add_u32 v61, v7, 2, s81
  v_add_u32 v6, 9, v8
  v_cvt_f32_u32 v7, v6
  v_cvt_pk_bf16_f32 v7, v7, 0
  v_subrev_u32 v7, 0x4280, v7
  v_med3_i32 v7, v6, v7, s82
  v_lshl_add_u32 v62, v7, 2, s81
  v_add_u32 v6, 10, v8
  v_cvt_f32_u32 v7, v6
  v_cvt_pk_bf16_f32 v7, v7, 0
  v_subrev_u32 v7, 0x4280, v7
  v_med3_i32 v7, v6, v7, s82
  v_lshl_add_u32 v63, v7, 2, s81
  v_add_u32 v6, 11, v8
  v_cvt_f32_u32 v7, v6
  v_cvt_pk_bf16_f32 v7, v7, 0
  v_subrev_u32 v7, 0x4280, v7
  v_med3_i32 v7, v6, v7, s82
  v_lshl_add_u32 v64, v7, 2, s81
  s_lshl_b32 s81, s3, 10
  s_lshl_b32 s82, s3, 8
  s_add_u32 m0, s81, 0x20000
  s_nop 0
  buffer_load_dwordx4 v17, s[36:39], s82 offen lds
  s_mov_b64 s[44:45], s[22:23]
  s_mov_b64 s[48:49], s[24:25]
  s_mov_b64 s[52:53], s[26:27]
  s_mov_b64 s[56:57], s[28:29]
  s_lshr_b32 s83, s78, 6
  s_lshl_b32 s4, s83, 7
  s_lshl_b32 s85, s3, 5
  s_add_u32 s4, s4, s85
  s_lshl_b32 s85, s77, 2
  s_add_u32 s4, s4, s85
  s_add_u32 s4, s4, 0x1000
  s_add_u32 s5, s4, 0x2000
  s_lshl_b32 s7, s34, 9
  s_lshl_b32 s85, s90, 8
  s_add_u32 s7, s7, s85
  s_lshl_b32 s85, s89, 7
  s_add_u32 s7, s7, s85
  s_lshl_b32 s85, s35, 2
  s_add_u32 s7, s7, s85
  s_add_u32 s7, s7, 0x5000
  s_lshl_b32 s9, s77, 18
  s_lshl_b32 s85, s3, 16
  s_add_u32 s9, s9, s85
  s_add_u32 s9, s9, 0x100000
  s_lshl_b32 s10, s77, 18
  s_add_u32 s10, s10, 0x300000
  s_lshl_b32 s11, s91, 6
  s_lshl_b32 s85, s77, 7
  s_add_u32 s11, s11, s85
  s_add_u32 s11, s11, 0x500000
  s_mul_i32 s12, s91, 1536
  s_lshl_b32 s85, s77, 10
  s_add_u32 s12, s12, s85
  s_add_u32 s12, s12, 0x1600000
  s_cmp_ge_u32 s35, 28
  s_cselect_b32 s81, 28, 0
  s_sub_u32 s84, s35, s81
  s_cmp_ge_u32 s84, 14
  s_cselect_b32 s81, 1, 0
  s_lshl_b32 s14, s34, 8
  s_lshl_b32 s85, s81, 7
  s_add_u32 s14, s14, s85
  s_mul_i32 s81, s81, 14
  s_sub_u32 s81, s84, s81
  s_lshl_b32 s15, s81, 2
  s_add_u32 s15, s15, s3
  s_and_b32 s16, s81, 1
  s_lshr_b32 s82, s81, 1
  s_mul_i32 s83, s16, 3
  s_lshr_b32 s84, s14, 5
  s_add_u32 s84, s84, s83
  s_mul_i32 s13, s84, 114688
  s_mul_i32 s85, s3, 28672
  s_add_u32 s13, s13, s85
  s_mul_i32 s85, s16, 14336
  s_add_u32 s13, s13, s85
  s_lshl_b32 s85, s82, 11
  s_add_u32 s13, s13, s85
  s_add_u32 s13, s13, 0x600000
  s_lshl_b32 s6, s14, 3
  s_lshl_b32 s85, s83, 8
  s_add_u32 s6, s6, s85
  s_lshl_b32 s85, s16, 7
  s_add_u32 s6, s6, s85
  s_lshl_b32 s85, s3, 5
  s_add_u32 s6, s6, s85
  s_lshl_b32 s85, s82, 2
  s_add_u32 s6, s6, s85
  s_add_u32 s6, s6, 0x8000
  s_cmp_eq_u32 s16, 0
  s_cselect_b32 s81, 1, -1
  s_cmp_ge_u32 s35, 28
  s_cselect_b32 s13, 0x1500000, s13
  s_cselect_b32 s6, 0xd000, s6
  s_cselect_b32 s81, 0, s81
  s_mul_i32 s17, s81, 114688
  s_lshl_b32 s18, s81, 8
  s_cmp_ge_u32 s35, 28
  s_cselect_b32 s81, 4, 0
  s_sub_u32 s81, s35, s81
  s_mul_i32 s82, s34, 28
  s_add_u32 s82, s82, s81
  s_lshl_b32 s81, s82, 2
  s_add_u32 s81, s81, s3
  s_and_b32 s82, s81, 15
  s_lshr_b32 s83, s81, 4
  s_lshl_b32 s84, s83, 15
  s_lshl_b32 s85, s82, 6
  s_add_u32 s84, s84, s85
  v_lshrrev_b32 v6, 2, v1
  v_and_b32 v7, 3, v1
  v_lshlrev_b32 v7, 4, v7
  v_lshl_add_u32 v6, v6, 10, v7
  v_add_u32 v30, s84, v6
  s_lshr_b32 s81, s82, 1
  s_and_b32 s82, s82, 1
  s_mul_i32 s20, s81, 229376
  s_lshl_b32 s85, s82, 10
  s_add_u32 s20, s20, s85
  s_add_u32 s20, s20, 0x1200000
  s_lshl_b32 s8, s81, 9
  s_lshl_b32 s85, s82, 2
  s_add_u32 s8, s8, s85
  s_add_u32 s8, s8, 0x6000
  s_and_b32 s81, s83, 3
  s_bfe_u32 s82, s83, 0x10002
  s_lshr_b32 s83, s83, 3
  s_mul_i32 s84, s81, 57344
  s_mul_i32 s85, s82, 28672
  s_add_u32 s84, s84, s85
  s_lshl_b32 s85, s83, 12
  s_add_u32 s84, s84, s85
  s_add_u32 s20, s20, s84
  s_mul_i32 s84, s81, 112
  s_mul_i32 s85, s82, 56
  s_add_u32 s84, s84, s85
  s_lshl_b32 s85, s83, 3
  s_add_u32 s84, s84, s85
  s_add_u32 s8, s8, s84
  s_lshl_b32 s81, s3, 4
  v_add_u32 v6, s81, v2
  v_add_u32 v7, s79, v6
  v_add_u32 v6, 64, v6
  v_cmp_gt_i32 vcc, 0, v7
  s_nop 1
  v_cndmask_b32 v6, v7, v6, vcc
  v_lshlrev_b32 v7, 4, v6
  v_add_u32 v53, 0x21008, v7
  v_and_b32 v7, 15, v6
  v_lshlrev_b32 v8, 8, v6
  s_and_b32 s81, s77, 1
  s_lshl_b32 s81, s81, 3
  v_lshrrev_b32 v6, 1, v3
  v_or_b32 v6, s81, v6
  v_xor_b32 v6, v6, v7
  v_lshl_add_u32 v6, v6, 4, v8
  v_and_b32 v7, 1, v3
  v_lshl_add_u32 v6, v7, 3, v6
  s_sub_u32 s19, 4, s76
  s_and_b32 s19, s19, 3
  s_lshl_b32 s81, s19, 15
  s_add_u32 s81, s81, 0x4000
  s_lshr_b32 s82, s77, 1
  s_lshl_b32 s83, s82, 10
  s_add_u32 s83, s83, 0x1c000
  v_mov_b32 v7, s81
  v_mov_b32 v52, s83
  v_cmp_gt_u32 vcc, 0x4000, v8
  s_nop 1
  v_cndmask_b32 v7, v52, v7, vcc
  v_add_u32 v52, v7, v6
  s_waitcnt vmcnt(9)
  s_waitcnt lgkmcnt(0)
  v_lshlrev_b32 v22, 16, v22
  v_lshlrev_b32 v23, 16, v23
  v_lshlrev_b32 v24, 16, v24
  v_lshlrev_b32 v25, 16, v25
  v_lshlrev_b32 v26, 16, v26
  v_lshlrev_b32 v27, 16, v27
  v_mul_f32 v26, 0x3fb8aa3b, v26
  v_mul_f32 v22, 0x3fb8aa3b, v22
  s_mul_i32 s80, s80, 1664525
  v_exp_f32 v26, v26
  v_exp_f32 v22, v22
  s_add_u32 s80, s80, 1013904223
  v_cvt_pk_bf16_f32 v26, v26, v26
  s_getreg_b32 s81, hwreg(HW_REG_XCC_ID, 0, 4)
  s_add_u32 s21, s81, s80
  s_add_u32 s21, s21, 1
  v_mov_b32 v10, s21
  s_lshl_b32 s81, s34, 7
  s_lshl_b32 s85, s35, 2
  s_add_u32 s81, s81, s85
  s_add_u32 s81, s81, 0x7000
  s_cmp_eq_u32 s3, 0
  s_cselect_b32 s81, s81, 0x2000000
  s_mov_b64 exec, 1
  buffer_store_dword v10, v9, s[60:63], s81 offen sc1
  s_mov_b64 exec, -1
  v_mov_b32 v10, s80
  s_lshl_b32 s22, s35, 2
  s_add_u32 s22, s22, s3
  v_min_u32 v11, 27, v1
  v_lshlrev_b32 v11, 7, v11
  v_and_b32 v26, 0xffff0000, v26
  v_cvt_pk_bf16_f32 v22, v22, v22
  v_and_b32 v22, 0xffff0000, v22
  v_mul_f32 v22, v22, v26
  v_mul_f32 v23, v23, v26
  v_mul_f32 v22, 0xbfb8aa3b, v22
  v_mul_f32 v23, 0x3e22f983, v23
  v_add_f32 v26, v26, v26
  v_mul_f32 v106, v24, v26
  v_mul_f32 v107, v25, v26
  v_mul_f32 v6, 0x3f800000, v22
  v_mul_f32 v7, 0x3f800000, v23
  v_exp_f32 v6, v6
  v_fract_f32 v7, v7
  v_cos_f32 v100, v7
  v_sin_f32 v101, v7
  v_mul_f32 v100, v100, v6
  v_mul_f32 v101, v101, v6
  v_mul_f32 v6, 0x41000000, v22
  v_mul_f32 v7, 0x41000000, v23
  v_exp_f32 v6, v6
  v_fract_f32 v7, v7
  v_cos_f32 v102, v7
  v_sin_f32 v103, v7
  v_mul_f32 v102, v102, v6
  v_mul_f32 v103, v103, v6
  v_mul_f32 v6, 0x43800000, v22
  v_mul_f32 v7, 0x43800000, v23
  v_exp_f32 v6, v6
  v_fract_f32 v7, v7
  v_cos_f32 v104, v7
  v_sin_f32 v105, v7
  v_mul_f32 v104, v104, v6
  v_mul_f32 v105, v105, v6
  v_mov_b32 v116, 0x3f80
  v_cvt_pk_bf16_f32 v117, v102, v103
  ds_write_b32 v65, v116 offset:0
  v_pk_mul_f32 v[108:109], v[102:103], v[102:103] op_sel_hi:[1,0]
  v_pk_fma_f32 v[110:111], v[102:103], v[102:103], v[108:109] op_sel:[1,1,0] op_sel_hi:[0,1,1] neg_lo:[0,1,0]
  v_cvt_pk_bf16_f32 v118, v110, v111
  ds_write_b32 v65, v117 offset:272
  v_pk_mul_f32 v[108:109], v[110:111], v[102:103] op_sel_hi:[1,0]
  v_pk_fma_f32 v[110:111], v[110:111], v[102:103], v[108:109] op_sel:[1,1,0] op_sel_hi:[0,1,1] neg_lo:[0,1,0]
  v_cvt_pk_bf16_f32 v119, v110, v111
  ds_write_b32 v65, v118 offset:544
  v_pk_mul_f32 v[108:109], v[110:111], v[102:103] op_sel_hi:[1,0]
  v_pk_fma_f32 v[110:111], v[110:111], v[102:103], v[108:109] op_sel:[1,1,0] op_sel_hi:[0,1,1] neg_lo:[0,1,0]
  v_cvt_pk_bf16_f32 v116, v110, v111
  ds_write_b32 v65, v119 offset:816
  v_pk_mul_f32 v[108:109], v[110:111], v[102:103] op_sel_hi:[1,0]
  v_pk_fma_f32 v[110:111], v[110:111], v[102:103], v[108:109] op_sel:[1,1,0] op_sel_hi:[0,1,1] neg_lo:[0,1,0]
  v_cvt_pk_bf16_f32 v117, v110, v111
  ds_write_b32 v65, v116 offset:1088
  v_pk_mul_f32 v[108:109], v[110:111], v[102:103] op_sel_hi:[1,0]
  v_pk_fma_f32 v[110:111], v[110:111], v[102:103], v[108:109] op_sel:[1,1,0] op_sel_hi:[0,1,1] neg_lo:[0,1,0]
  v_cvt_pk_bf16_f32 v118, v110, v111
  ds_write_b32 v65, v117 offset:1360
  v_pk_mul_f32 v[108:109], v[110:111], v[102:103] op_sel_hi:[1,0]
  v_pk_fma_f32 v[110:111], v[110:111], v[102:103], v[108:109] op_sel:[1,1,0] op_sel_hi:[0,1,1] neg_lo:[0,1,0]
  v_cvt_pk_bf16_f32 v119, v110, v111
  ds_write_b32 v65, v118 offset:1632
  v_pk_mul_f32 v[108:109], v[110:111], v[102:103] op_sel_hi:[1,0]
  v_pk_fma_f32 v[110:111], v[110:111], v[102:103], v[108:109] op_sel:[1,1,0] op_sel_hi:[0,1,1] neg_lo:[0,1,0]
  v_cvt_pk_bf16_f32 v116, v110, v111
  ds_write_b32 v65, v119 offset:1904
  v_pk_mul_f32 v[108:109], v[110:111], v[102:103] op_sel_hi:[1,0]
  v_pk_fma_f32 v[110:111], v[110:111], v[102:103], v[108:109] op_sel:[1,1,0] op_sel_hi:[0,1,1] neg_lo:[0,1,0]
  v_cvt_pk_bf16_f32 v117, v110, v111
  ds_write_b32 v65, v116 offset:2176
  v_pk_mul_f32 v[108:109], v[110:111], v[102:103] op_sel_hi:[1,0]
  v_pk_fma_f32 v[110:111], v[110:111], v[102:103], v[108:109] op_sel:[1,1,0] op_sel_hi:[0,1,1] neg_lo:[0,1,0]
  v_cvt_pk_bf16_f32 v118, v110, v111
  ds_write_b32 v65, v117 offset:2448
  v_pk_mul_f32 v[108:109], v[110:111], v[102:103] op_sel_hi:[1,0]
  v_pk_fma_f32 v[110:111], v[110:111], v[102:103], v[108:109] op_sel:[1,1,0] op_sel_hi:[0,1,1] neg_lo:[0,1,0]
  v_cvt_pk_bf16_f32 v119, v110, v111
  ds_write_b32 v65, v118 offset:2720
  v_pk_mul_f32 v[108:109], v[110:111], v[102:103] op_sel_hi:[1,0]
  v_pk_fma_f32 v[110:111], v[110:111], v[102:103], v[108:109] op_sel:[1,1,0] op_sel_hi:[0,1,1] neg_lo:[0,1,0]
  v_cvt_pk_bf16_f32 v116, v110, v111
  ds_write_b32 v65, v119 offset:2992
  v_pk_mul_f32 v[108:109], v[110:111], v[102:103] op_sel_hi:[1,0]
  v_pk_fma_f32 v[110:111], v[110:111], v[102:103], v[108:109] op_sel:[1,1,0] op_sel_hi:[0,1,1] neg_lo:[0,1,0]
  v_cvt_pk_bf16_f32 v117, v110, v111
  ds_write_b32 v65, v116 offset:3264
  v_pk_mul_f32 v[108:109], v[110:111], v[102:103] op_sel_hi:[1,0]
  v_pk_fma_f32 v[110:111], v[110:111], v[102:103], v[108:109] op_sel:[1,1,0] op_sel_hi:[0,1,1] neg_lo:[0,1,0]
  v_cvt_pk_bf16_f32 v118, v110, v111
  ds_write_b32 v65, v117 offset:3536
  v_pk_mul_f32 v[108:109], v[110:111], v[102:103] op_sel_hi:[1,0]
  v_pk_fma_f32 v[110:111], v[110:111], v[102:103], v[108:109] op_sel:[1,1,0] op_sel_hi:[0,1,1] neg_lo:[0,1,0]
  v_cvt_pk_bf16_f32 v119, v110, v111
  ds_write_b32 v65, v118 offset:3808
  v_pk_mul_f32 v[108:109], v[110:111], v[102:103] op_sel_hi:[1,0]
  v_pk_fma_f32 v[110:111], v[110:111], v[102:103], v[108:109] op_sel:[1,1,0] op_sel_hi:[0,1,1] neg_lo:[0,1,0]
  v_cvt_pk_bf16_f32 v116, v110, v111
  ds_write_b32 v65, v119 offset:4080
  v_pk_mul_f32 v[108:109], v[110:111], v[102:103] op_sel_hi:[1,0]
  v_pk_fma_f32 v[110:111], v[110:111], v[102:103], v[108:109] op_sel:[1,1,0] op_sel_hi:[0,1,1] neg_lo:[0,1,0]
  v_cvt_pk_bf16_f32 v117, v110, v111
  ds_write_b32 v65, v116 offset:4352
  v_pk_mul_f32 v[108:109], v[110:111], v[102:103] op_sel_hi:[1,0]
  v_pk_fma_f32 v[110:111], v[110:111], v[102:103], v[108:109] op_sel:[1,1,0] op_sel_hi:[0,1,1] neg_lo:[0,1,0]
  v_cvt_pk_bf16_f32 v118, v110, v111
  ds_write_b32 v65, v117 offset:4624
  v_pk_mul_f32 v[108:109], v[110:111], v[102:103] op_sel_hi:[1,0]
  v_pk_fma_f32 v[110:111], v[110:111], v[102:103], v[108:109] op_sel:[1,1,0] op_sel_hi:[0,1,1] neg_lo:[0,1,0]
  v_cvt_pk_bf16_f32 v119, v110, v111
  ds_write_b32 v65, v118 offset:4896
  v_pk_mul_f32 v[108:109], v[110:111], v[102:103] op_sel_hi:[1,0]
  v_pk_fma_f32 v[110:111], v[110:111], v[102:103], v[108:109] op_sel:[1,1,0] op_sel_hi:[0,1,1] neg_lo:[0,1,0]
  v_cvt_pk_bf16_f32 v116, v110, v111
  ds_write_b32 v65, v119 offset:5168
  v_pk_mul_f32 v[108:109], v[110:111], v[102:103] op_sel_hi:[1,0]
  v_pk_fma_f32 v[110:111], v[110:111], v[102:103], v[108:109] op_sel:[1,1,0] op_sel_hi:[0,1,1] neg_lo:[0,1,0]
  v_cvt_pk_bf16_f32 v117, v110, v111
  ds_write_b32 v65, v116 offset:5440
  v_pk_mul_f32 v[108:109], v[110:111], v[102:103] op_sel_hi:[1,0]
  v_pk_fma_f32 v[110:111], v[110:111], v[102:103], v[108:109] op_sel:[1,1,0] op_sel_hi:[0,1,1] neg_lo:[0,1,0]
  v_cvt_pk_bf16_f32 v118, v110, v111
  ds_write_b32 v65, v117 offset:5712
  v_pk_mul_f32 v[108:109], v[110:111], v[102:103] op_sel_hi:[1,0]
  v_pk_fma_f32 v[110:111], v[110:111], v[102:103], v[108:109] op_sel:[1,1,0] op_sel_hi:[0,1,1] neg_lo:[0,1,0]
  v_cvt_pk_bf16_f32 v119, v110, v111
  ds_write_b32 v65, v118 offset:5984
  v_pk_mul_f32 v[108:109], v[110:111], v[102:103] op_sel_hi:[1,0]
  v_pk_fma_f32 v[110:111], v[110:111], v[102:103], v[108:109] op_sel:[1,1,0] op_sel_hi:[0,1,1] neg_lo:[0,1,0]
  v_cvt_pk_bf16_f32 v116, v110, v111
  ds_write_b32 v65, v119 offset:6256
  v_pk_mul_f32 v[108:109], v[110:111], v[102:103] op_sel_hi:[1,0]
  v_pk_fma_f32 v[110:111], v[110:111], v[102:103], v[108:109] op_sel:[1,1,0] op_sel_hi:[0,1,1] neg_lo:[0,1,0]
  v_cvt_pk_bf16_f32 v117, v110, v111
  ds_write_b32 v65, v116 offset:6528
  v_pk_mul_f32 v[108:109], v[110:111], v[102:103] op_sel_hi:[1,0]
  v_pk_fma_f32 v[110:111], v[110:111], v[102:103], v[108:109] op_sel:[1,1,0] op_sel_hi:[0,1,1] neg_lo:[0,1,0]
  v_cvt_pk_bf16_f32 v118, v110, v111
  ds_write_b32 v65, v117 offset:6800
  v_pk_mul_f32 v[108:109], v[110:111], v[102:103] op_sel_hi:[1,0]
  v_pk_fma_f32 v[110:111], v[110:111], v[102:103], v[108:109] op_sel:[1,1,0] op_sel_hi:[0,1,1] neg_lo:[0,1,0]
  v_cvt_pk_bf16_f32 v119, v110, v111
  ds_write_b32 v65, v118 offset:7072
  v_pk_mul_f32 v[108:109], v[110:111], v[102:103] op_sel_hi:[1,0]
  v_pk_fma_f32 v[110:111], v[110:111], v[102:103], v[108:109] op_sel:[1,1,0] op_sel_hi:[0,1,1] neg_lo:[0,1,0]
  v_cvt_pk_bf16_f32 v116, v110, v111
  ds_write_b32 v65, v119 offset:7344
  v_pk_mul_f32 v[108:109], v[110:111], v[102:103] op_sel_hi:[1,0]
  v_pk_fma_f32 v[110:111], v[110:111], v[102:103], v[108:109] op_sel:[1,1,0] op_sel_hi:[0,1,1] neg_lo:[0,1,0]
  v_cvt_pk_bf16_f32 v117, v110, v111
  ds_write_b32 v65, v116 offset:7616
  v_pk_mul_f32 v[108:109], v[110:111], v[102:103] op_sel_hi:[1,0]
  v_pk_fma_f32 v[110:111], v[110:111], v[102:103], v[108:109] op_sel:[1,1,0] op_sel_hi:[0,1,1] neg_lo:[0,1,0]
  s_add_u32 m0, s96, 0xc000
  s_nop 0
  buffer_load_dwordx4 v13, s[36:39], s93 offen lds
  v_cvt_pk_bf16_f32 v118, v110, v111
  ds_write_b32 v65, v117 offset:7888
  v_pk_mul_f32 v[108:109], v[110:111], v[102:103] op_sel_hi:[1,0]
  v_pk_fma_f32 v[110:111], v[110:111], v[102:103], v[108:109] op_sel:[1,1,0] op_sel_hi:[0,1,1] neg_lo:[0,1,0]
  v_cvt_pk_bf16_f32 v119, v110, v111
  ds_write_b32 v65, v118 offset:8160
  v_cvt_pk_bf16_f32 v116, v106, -v107
  ds_write_b32 v65, v119 offset:8432
  v_pk_mul_f32 v[108:109], v[106:107], v[100:101] op_sel_hi:[1,0]
  v_pk_fma_f32 v[110:111], v[106:107], v[100:101], v[108:109] op_sel:[1,1,0] op_sel_hi:[0,1,1] neg_lo:[0,1,0]
  v_cvt_pk_bf16_f32 v117, v110, -v111
  ds_write_b32 v65, v116 offset:8704
  v_pk_mul_f32 v[108:109], v[110:111], v[100:101] op_sel_hi:[1,0]
  v_pk_fma_f32 v[110:111], v[110:111], v[100:101], v[108:109] op_sel:[1,1,0] op_sel_hi:[0,1,1] neg_lo:[0,1,0]
  v_cvt_pk_bf16_f32 v118, v110, -v111
  ds_write_b32 v65, v117 offset:8976
  s_add_u32 m0, s96, 0xc400
  s_nop 0
  buffer_load_dwordx4 v14, s[36:39], s93 offen lds
  v_pk_mul_f32 v[108:109], v[110:111], v[100:101] op_sel_hi:[1,0]
  v_pk_fma_f32 v[110:111], v[110:111], v[100:101], v[108:109] op_sel:[1,1,0] op_sel_hi:[0,1,1] neg_lo:[0,1,0]
  v_cvt_pk_bf16_f32 v119, v110, -v111
  ds_write_b32 v65, v118 offset:9248
  v_pk_mul_f32 v[108:109], v[110:111], v[100:101] op_sel_hi:[1,0]
  v_pk_fma_f32 v[110:111], v[110:111], v[100:101], v[108:109] op_sel:[1,1,0] op_sel_hi:[0,1,1] neg_lo:[0,1,0]
  v_cvt_pk_bf16_f32 v116, v110, -v111
  ds_write_b32 v65, v119 offset:9520
  v_pk_mul_f32 v[108:109], v[110:111], v[100:101] op_sel_hi:[1,0]
  v_pk_fma_f32 v[110:111], v[110:111], v[100:101], v[108:109] op_sel:[1,1,0] op_sel_hi:[0,1,1] neg_lo:[0,1,0]
  v_cvt_pk_bf16_f32 v117, v110, -v111
  ds_write_b32 v65, v116 offset:9792
  v_pk_mul_f32 v[108:109], v[110:111], v[100:101] op_sel_hi:[1,0]
  v_pk_fma_f32 v[110:111], v[110:111], v[100:101], v[108:109] op_sel:[1,1,0] op_sel_hi:[0,1,1] neg_lo:[0,1,0]
  v_cvt_pk_bf16_f32 v118, v110, -v111
  ds_write_b32 v65, v117 offset:10064
  s_add_u32 m0, s96, 0xc800
  s_nop 0
  buffer_load_dwordx4 v15, s[36:39], s93 offen lds
  v_pk_mul_f32 v[108:109], v[110:111], v[100:101] op_sel_hi:[1,0]
  v_pk_fma_f32 v[110:111], v[110:111], v[100:101], v[108:109] op_sel:[1,1,0] op_sel_hi:[0,1,1] neg_lo:[0,1,0]
  v_cvt_pk_bf16_f32 v119, v110, -v111
  ds_write_b32 v65, v118 offset:10336
  v_pk_mul_f32 v[108:109], v[100:101], v[100:101] op_sel_hi:[1,0]
  v_pk_fma_f32 v[114:115], v[100:101], v[100:101], v[108:109] op_sel:[1,1,0] op_sel_hi:[0,1,1] neg_lo:[0,1,0]
  v_pk_mul_f32 v[108:109], v[106:107], v[104:105] op_sel_hi:[1,0]
  v_pk_fma_f32 v[110:111], v[106:107], v[104:105], v[108:109] op_sel:[1,1,0] op_sel_hi:[0,1,1] neg_lo:[0,1,0]
  v_cvt_pk_bf16_f32 v116, v110, -v111
  ds_write_b32 v65, v119 offset:10608
  v_pk_mul_f32 v[108:109], v[110:111], v[114:115] op_sel_hi:[1,0]
  v_pk_fma_f32 v[112:113], v[110:111], v[114:115], v[108:109] op_sel:[1,1,0] op_sel_hi:[0,1,1] neg_lo:[0,1,0]
  v_cvt_pk_bf16_f32 v117, v112, -v113
  ds_write_b32 v65, v116 offset:10880
  v_pk_mul_f32 v[108:109], v[112:113], v[114:115] op_sel_hi:[1,0]
  v_pk_fma_f32 v[112:113], v[112:113], v[114:115], v[108:109] op_sel:[1,1,0] op_sel_hi:[0,1,1] neg_lo:[0,1,0]
  s_add_u32 m0, s96, 0xcc00
  s_nop 0
  buffer_load_dwordx4 v16, s[36:39], s93 offen lds
  v_cvt_pk_bf16_f32 v118, v112, -v113
  ds_write_b32 v65, v117 offset:11152
  v_pk_mul_f32 v[108:109], v[112:113], v[114:115] op_sel_hi:[1,0]
  v_pk_fma_f32 v[112:113], v[112:113], v[114:115], v[108:109] op_sel:[1,1,0] op_sel_hi:[0,1,1] neg_lo:[0,1,0]
  v_cvt_pk_bf16_f32 v119, v112, -v113
  ds_write_b32 v65, v118 offset:11424
  v_pk_mul_f32 v[108:109], v[114:115], v[114:115] op_sel_hi:[1,0]
  v_pk_fma_f32 v[114:115], v[114:115], v[114:115], v[108:109] op_sel:[1,1,0] op_sel_hi:[0,1,1] neg_lo:[0,1,0]
  v_pk_mul_f32 v[108:109], v[110:111], v[104:105] op_sel_hi:[1,0]
  v_pk_fma_f32 v[110:111], v[110:111], v[104:105], v[108:109] op_sel:[1,1,0] op_sel_hi:[0,1,1] neg_lo:[0,1,0]
  v_cvt_pk_bf16_f32 v116, v110, -v111
  ds_write_b32 v65, v119 offset:11696
  v_pk_mul_f32 v[108:109], v[110:111], v[114:115] op_sel_hi:[1,0]
  v_pk_fma_f32 v[112:113], v[110:111], v[114:115], v[108:109] op_sel:[1,1,0] op_sel_hi:[0,1,1] neg_lo:[0,1,0]
  v_cvt_pk_bf16_f32 v117, v112, -v113
  ds_write_b32 v65, v116 offset:11968
  s_lshl_b32 s88, s93, 9
  s_add_u32 m0, s96, 0x8000
  s_nop 0
  buffer_load_dwordx4 v18, s[40:43], s88 offen lds
  v_pk_mul_f32 v[108:109], v[110:111], v[104:105] op_sel_hi:[1,0]
  v_pk_fma_f32 v[110:111], v[110:111], v[104:105], v[108:109] op_sel:[1,1,0] op_sel_hi:[0,1,1] neg_lo:[0,1,0]
  v_cvt_pk_bf16_f32 v118, v110, -v111
  ds_write_b32 v65, v117 offset:12240
  v_pk_mul_f32 v[108:109], v[110:111], v[114:115] op_sel_hi:[1,0]
  v_pk_fma_f32 v[112:113], v[110:111], v[114:115], v[108:109] op_sel:[1,1,0] op_sel_hi:[0,1,1] neg_lo:[0,1,0]
  v_cvt_pk_bf16_f32 v119, v112, -v113
  ds_write_b32 v65, v118 offset:12512
  v_pk_mul_f32 v[108:109], v[110:111], v[104:105] op_sel_hi:[1,0]
  v_pk_fma_f32 v[110:111], v[110:111], v[104:105], v[108:109] op_sel:[1,1,0] op_sel_hi:[0,1,1] neg_lo:[0,1,0]
  v_cvt_pk_bf16_f32 v116, v110, -v111
  ds_write_b32 v65, v119 offset:12784
  v_pk_mul_f32 v[108:109], v[110:111], v[104:105] op_sel_hi:[1,0]
  v_pk_fma_f32 v[110:111], v[110:111], v[104:105], v[108:109] op_sel:[1,1,0] op_sel_hi:[0,1,1] neg_lo:[0,1,0]
  v_cvt_pk_bf16_f32 v117, v110, -v111
  ds_write_b32 v65, v116 offset:13056
  buffer_load_dwordx4 v19, s[40:43], s88 offen offset:1024 lds
  v_pk_mul_f32 v[108:109], v[110:111], v[104:105] op_sel_hi:[1,0]
  v_pk_fma_f32 v[110:111], v[110:111], v[104:105], v[108:109] op_sel:[1,1,0] op_sel_hi:[0,1,1] neg_lo:[0,1,0]
  v_cvt_pk_bf16_f32 v118, v110, -v111
  ds_write_b32 v65, v117 offset:13328
  v_pk_mul_f32 v[108:109], v[110:111], v[104:105] op_sel_hi:[1,0]
  v_pk_fma_f32 v[110:111], v[110:111], v[104:105], v[108:109] op_sel:[1,1,0] op_sel_hi:[0,1,1] neg_lo:[0,1,0]
  v_cvt_pk_bf16_f32 v119, v110, -v111
  ds_write_b32 v65, v118 offset:13600
  v_pk_mul_f32 v[108:109], v[110:111], v[104:105] op_sel_hi:[1,0]
  v_pk_fma_f32 v[110:111], v[110:111], v[104:105], v[108:109] op_sel:[1,1,0] op_sel_hi:[0,1,1] neg_lo:[0,1,0]
  v_cvt_pk_bf16_f32 v116, v110, -v111
  ds_write_b32 v65, v119 offset:13872
  ds_write_b32 v65, v116 offset:14144
  ds_read_b128 a[160:163], v66 offset:8704
  ds_read_b128 a[192:195], v66 offset:0
  ds_read_b128 a[164:167], v66 offset:8736
  ds_read_b128 a[196:199], v66 offset:32
  ds_read_b128 a[168:171], v66 offset:8768
  ds_read_b128 a[200:203], v66 offset:64
  ds_read_b128 a[172:175], v66 offset:8800
  ds_read_b128 a[204:207], v66 offset:96
  ds_read_b128 a[176:179], v66 offset:8832
  ds_read_b128 a[208:211], v66 offset:128
  ds_read_b128 a[180:183], v66 offset:8864
  ds_read_b128 a[212:215], v66 offset:160
  ds_read_b128 a[184:187], v66 offset:8896
  ds_read_b128 a[216:219], v66 offset:192
  ds_read_b128 a[188:191], v66 offset:8928
  ds_read_b128 a[220:223], v66 offset:224
  s_waitcnt lgkmcnt(14)
  v_mfma_f32_32x32x16_bf16 v[100:115], a[160:163], a[192:195], 0
  buffer_load_dwordx4 v20, s[40:43], s88 offen offset:2048 lds
  s_waitcnt lgkmcnt(12)
  v_mfma_f32_32x32x16_bf16 v[100:115], a[164:167], a[196:199], v[100:115]
  s_waitcnt lgkmcnt(10)
  v_mfma_f32_32x32x16_bf16 v[100:115], a[168:171], a[200:203], v[100:115]
  buffer_load_dwordx4 v21, s[40:43], s88 offen offset:3072 lds
  s_waitcnt lgkmcnt(8)
  v_mfma_f32_32x32x16_bf16 v[100:115], a[172:175], a[204:207], v[100:115]
  s_waitcnt lgkmcnt(6)
  v_mfma_f32_32x32x16_bf16 v[100:115], a[176:179], a[208:211], v[100:115]
  s_lshl_b32 s88, s3, 11
  s_add_u32 m0, s88, 0x21800
  s_nop 0
  buffer_load_dwordx4 v30, s[52:55], 0 offen lds
  s_waitcnt lgkmcnt(4)
  v_mfma_f32_32x32x16_bf16 v[100:115], a[180:183], a[212:215], v[100:115]
  s_waitcnt lgkmcnt(2)
  v_mfma_f32_32x32x16_bf16 v[100:115], a[184:187], a[216:219], v[100:115]
  s_movk_i32 s88, 0x3c00
  buffer_load_dwordx4 v30, s[52:55], s88 offen offset:1024 lds
  s_waitcnt lgkmcnt(0)
  v_mfma_f32_32x32x16_bf16 v[100:115], a[188:191], a[220:223], v[100:115]
  s_nop 11
  ds_write_b128 v67, v[100:103]
  ds_write_b64 v68, v[104:105]
  ds_write_b64 v69, v[106:107]
  ds_write_b32 v70, v108 offset:2048
  ds_write_b32 v70, v109 offset:2176
  ds_write_b32 v70, v110 offset:2304
  ds_write_b32 v70, v111 offset:2432
  v_xor_b32 v22, 32, v52
  v_xor_b32 v23, 64, v52
  v_xor_b32 v24, 96, v52
  s_waitcnt vmcnt(11)
  s_waitcnt lgkmcnt(0)
  s_barrier
  ds_read_b128 a[0:3], v31 offset:0
  ds_read_b64_tr_b16 a[64:65], v35 offset:0
  ds_read_b64_tr_b16 a[66:67], v35 offset:512
  ds_read_b128 a[16:19], v71 offset:0
  ds_read_b128 a[32:35], v75 offset:0
  ds_read_b128 a[48:51], v79 offset:0
  ds_read_b128 a[4:7], v32 offset:0
  ds_read_b64_tr_b16 a[68:69], v35 offset:4096
  ds_read_b64_tr_b16 a[70:71], v35 offset:4608
  ds_read_b128 a[20:23], v72 offset:0
  ds_read_b128 a[36:39], v76 offset:0
  ds_read_b128 a[52:55], v80 offset:0
  ds_read_b128 a[8:11], v33 offset:0
  ds_read_b64_tr_b16 a[72:73], v35 offset:8192
  ds_read_b64_tr_b16 a[74:75], v35 offset:8704
  ds_read_b128 a[24:27], v73 offset:0
  ds_read_b128 a[40:43], v77 offset:0
  ds_read_b128 a[56:59], v81 offset:0
  ds_read_b128 a[12:15], v34 offset:0
  ds_read_b64_tr_b16 a[76:77], v35 offset:12288
  ds_read_b64_tr_b16 a[78:79], v35 offset:12800
  ds_read_b128 a[28:31], v74 offset:0
  ds_read_b128 a[44:47], v78 offset:0
  ds_read_b128 a[60:63], v82 offset:0
  s_add_u32 m0, s96, 0x14000
  s_nop 0
  buffer_load_dwordx4 v13, s[36:39], s94 offen lds
  s_add_u32 m0, s96, 0x14400
  s_nop 0
  buffer_load_dwordx4 v14, s[36:39], s94 offen lds
  s_waitcnt lgkmcnt(15)
  v_mfma_f32_16x16x32_bf16 v[116:119], v[40:43], a[0:3], 0
  v_mfma_f32_16x16x32_bf16 v[120:123], a[0:3], a[0:3], 0
  s_add_u32 m0, s96, 0x14800
  s_nop 0
  buffer_load_dwordx4 v15, s[36:39], s94 offen lds
  v_mfma_f32_16x16x32_bf16 v[100:103], a[64:67], a[0:3], 0
  v_mfma_f32_16x16x32_bf16 v[124:127], a[64:67], v[40:43], 0
  v_mfma_f32_16x16x32_bf16 v[104:107], a[64:67], a[16:19], 0
  v_mfma_f32_16x16x32_bf16 v[108:111], a[64:67], a[32:35], 0
  s_add_u32 m0, s96, 0x14c00
  s_nop 0
  buffer_load_dwordx4 v16, s[36:39], s94 offen lds
  v_mfma_f32_16x16x32_bf16 v[112:115], a[64:67], a[48:51], 0
  v_mfma_f32_16x16x32_bf16 v[116:119], v[40:43], a[4:7], v[116:119]
  v_mfma_f32_16x16x32_bf16 v[120:123], a[4:7], a[4:7], v[120:123]
  v_mfma_f32_16x16x32_bf16 v[100:103], a[68:71], a[4:7], v[100:103]
  s_lshl_b32 s88, s94, 9
  s_add_u32 m0, s96, 0x10000
  s_nop 0
  buffer_load_dwordx4 v18, s[40:43], s88 offen lds
  v_mfma_f32_16x16x32_bf16 v[124:127], a[68:71], v[40:43], v[124:127]
  s_waitcnt lgkmcnt(14)
  v_mfma_f32_16x16x32_bf16 v[104:107], a[68:71], a[20:23], v[104:107]
  s_waitcnt lgkmcnt(13)
  v_mfma_f32_16x16x32_bf16 v[108:111], a[68:71], a[36:39], v[108:111]
  s_waitcnt lgkmcnt(0)
  s_cmp_lg_u32 s19, 0
  s_cbranch_scc1 L_cap_1
  ds_read_b64 v[128:129], v52
  ds_read_b64 v[130:131], v22
  ds_read_b64 v[132:133], v23
  ds_read_b64 v[134:135], v24
L_cap_1:
  v_mfma_f32_16x16x32_bf16 v[112:115], a[68:71], a[52:55], v[112:115]
  buffer_load_dwordx4 v19, s[40:43], s88 offen offset:1024 lds
  v_mfma_f32_16x16x32_bf16 v[116:119], v[40:43], a[8:11], v[116:119]
  v_mfma_f32_16x16x32_bf16 v[120:123], a[8:11], a[8:11], v[120:123]
  v_mfma_f32_16x16x32_bf16 v[100:103], a[72:75], a[8:11], v[100:103]
  v_mfma_f32_16x16x32_bf16 v[124:127], a[72:75], v[40:43], v[124:127]
  s_waitcnt vmcnt(8)
  s_waitcnt lgkmcnt(0)
  s_barrier
  ds_read_b128 a[80:83], v31 offset:32768
  ds_read_b64_tr_b16 a[144:145], v35 offset:32768
  ds_read_b64_tr_b16 a[146:147], v35 offset:33280
  buffer_load_dwordx4 v20, s[40:43], s88 offen offset:2048 lds
  v_mfma_f32_16x16x32_bf16 v[104:107], a[72:75], a[24:27], v[104:107]
  ds_read_b128 a[96:99], v71 offset:32768
  ds_read_b128 a[112:115], v75 offset:32768
  ds_read_b128 a[128:131], v79 offset:32768
  v_mfma_f32_16x16x32_bf16 v[108:111], a[72:75], a[40:43], v[108:111]
  ds_read_b128 a[84:87], v32 offset:32768
  ds_read_b64_tr_b16 a[148:149], v35 offset:36864
  v_mfma_f32_16x16x32_bf16 v[112:115], a[72:75], a[56:59], v[112:115]
  ds_read_b64_tr_b16 a[150:151], v35 offset:37376
  ds_read_b128 a[100:103], v72 offset:32768
  v_mfma_f32_16x16x32_bf16 v[116:119], v[40:43], a[12:15], v[116:119]
  ds_read_b128 a[116:119], v76 offset:32768
  ds_read_b128 a[132:135], v80 offset:32768
  buffer_load_dwordx4 v21, s[40:43], s88 offen offset:3072 lds
  v_mfma_f32_16x16x32_bf16 v[120:123], a[12:15], a[12:15], v[120:123]
  ds_read_b128 a[88:91], v33 offset:32768
  ds_read_b64_tr_b16 a[152:153], v35 offset:40960
  v_mfma_f32_16x16x32_bf16 v[100:103], a[76:79], a[12:15], v[100:103]
  ds_read_b64_tr_b16 a[154:155], v35 offset:41472
  ds_read_b128 a[104:107], v73 offset:32768
  v_mfma_f32_16x16x32_bf16 v[124:127], a[76:79], v[40:43], v[124:127]
  ds_read_b128 a[120:123], v77 offset:32768
  ds_read_b128 a[136:139], v81 offset:32768
  v_mfma_f32_16x16x32_bf16 v[104:107], a[76:79], a[28:31], v[104:107]
  ds_read_b128 a[92:95], v34 offset:32768
  ds_read_b64_tr_b16 a[156:157], v35 offset:45056
  s_add_u32 m0, s96, 0x1c000
  s_nop 0
  buffer_load_dwordx4 v13, s[36:39], s95 offen lds
  v_mfma_f32_16x16x32_bf16 v[108:111], a[76:79], a[44:47], v[108:111]
  ds_read_b64_tr_b16 a[158:159], v35 offset:45568
  ds_read_b128 a[108:111], v74 offset:32768
  v_mfma_f32_16x16x32_bf16 v[112:115], a[76:79], a[60:63], v[112:115]
  ds_read_b128 a[124:127], v78 offset:32768
  ds_read_b128 a[140:143], v82 offset:32768
  s_waitcnt lgkmcnt(15)
  v_mfma_f32_16x16x32_bf16 v[116:119], v[40:43], a[80:83], v[116:119]
  v_lshlrev_b32 v17, 2, v0
  v_mfma_f32_16x16x32_bf16 v[120:123], a[80:83], a[80:83], v[120:123]
  s_add_u32 m0, s96, 0x1c400
  s_nop 0
  buffer_load_dwordx4 v14, s[36:39], s95 offen lds
  v_add_u32 v17, 0x24000, v17
  v_mfma_f32_16x16x32_bf16 v[100:103], a[144:147], a[80:83], v[100:103]
  ds_read2st64_b32 v[66:67], v17 offset0:0 offset1:12
  v_mfma_f32_16x16x32_bf16 v[124:127], a[144:147], v[40:43], v[124:127]
  ds_read2st64_b32 v[68:69], v17 offset0:24 offset1:36
  v_mfma_f32_16x16x32_bf16 v[104:107], a[144:147], a[96:99], v[104:107]
  s_waitcnt lgkmcnt(0)
  s_cmp_lg_u32 s19, 1
  s_cbranch_scc1 L_cap_2
  ds_read_b64 v[128:129], v52
  ds_read_b64 v[130:131], v22
  ds_read_b64 v[132:133], v23
  ds_read_b64 v[134:135], v24
L_cap_2:
  v_mfma_f32_16x16x32_bf16 v[108:111], a[144:147], a[112:115], v[108:111]
  s_add_u32 m0, s96, 0x1c800
  s_nop 0
  buffer_load_dwordx4 v15, s[36:39], s95 offen lds
  v_mfma_f32_16x16x32_bf16 v[112:115], a[144:147], a[128:131], v[112:115]
  v_add_f32 v66, v66, v67
  v_mfma_f32_16x16x32_bf16 v[116:119], v[40:43], a[84:87], v[116:119]
  v_add_f32 v68, v68, v69
  v_mfma_f32_16x16x32_bf16 v[120:123], a[84:87], a[84:87], v[120:123]
  v_cvt_pk_bf16_f32 v66, v66, v68
  v_mfma_f32_16x16x32_bf16 v[100:103], a[148:151], a[84:87], v[100:103]
  s_add_u32 m0, s96, 0x1cc00
  s_nop 0
  buffer_load_dwordx4 v16, s[36:39], s95 offen lds
  ds_write_b32 v17, v66 offset:12288
  v_mfma_f32_16x16x32_bf16 v[124:127], a[148:151], v[40:43], v[124:127]
  ds_read2st64_b32 v[66:67], v17 offset0:4 offset1:16
  v_mfma_f32_16x16x32_bf16 v[104:107], a[148:151], a[100:103], v[104:107]
  ds_read2st64_b32 v[68:69], v17 offset0:28 offset1:40
  v_mfma_f32_16x16x32_bf16 v[108:111], a[148:151], a[116:119], v[108:111]
  v_mfma_f32_16x16x32_bf16 v[112:115], a[148:151], a[132:135], v[112:115]
  s_waitcnt vmcnt(4)
  s_waitcnt lgkmcnt(0)
  s_barrier
  ds_read_b128 a[0:3], v83 offset:0
  ds_read_b64_tr_b16 a[64:65], v36 offset:0
  s_lshl_b32 s88, s95, 9
  s_add_u32 m0, s96, 0x18000
  s_nop 0
  buffer_load_dwordx4 v18, s[40:43], s88 offen lds
  v_mfma_f32_16x16x32_bf16 v[116:119], v[40:43], a[88:91], v[116:119]
  ds_read_b64_tr_b16 a[66:67], v36 offset:512
  ds_read_b128 a[16:19], v87 offset:0
  v_mfma_f32_16x16x32_bf16 v[120:123], a[88:91], a[88:91], v[120:123]
  ds_read_b128 a[32:35], v91 offset:0
  ds_read_b128 a[48:51], v95 offset:0
  v_mfma_f32_16x16x32_bf16 v[100:103], a[152:155], a[88:91], v[100:103]
  ds_read_b128 a[4:7], v84 offset:0
  ds_read_b64_tr_b16 a[68:69], v36 offset:4096
  v_mfma_f32_16x16x32_bf16 v[124:127], a[152:155], v[40:43], v[124:127]
  ds_read_b64_tr_b16 a[70:71], v36 offset:4608
  ds_read_b128 a[20:23], v88 offset:0
  buffer_load_dwordx4 v19, s[40:43], s88 offen offset:1024 lds
  v_mfma_f32_16x16x32_bf16 v[104:107], a[152:155], a[104:107], v[104:107]
  ds_read_b128 a[36:39], v92 offset:0
  ds_read_b128 a[52:55], v96 offset:0
  v_mfma_f32_16x16x32_bf16 v[108:111], a[152:155], a[120:123], v[108:111]
  ds_read_b128 a[8:11], v85 offset:0
  ds_read_b64_tr_b16 a[72:73], v36 offset:8192
  v_mfma_f32_16x16x32_bf16 v[112:115], a[152:155], a[136:139], v[112:115]
  ds_read_b64_tr_b16 a[74:75], v36 offset:8704
  ds_read_b128 a[24:27], v89 offset:0
  v_mfma_f32_16x16x32_bf16 v[116:119], v[40:43], a[92:95], v[116:119]
  ds_read_b128 a[40:43], v93 offset:0
  ds_read_b128 a[56:59], v97 offset:0
  buffer_load_dwordx4 v20, s[40:43], s88 offen offset:2048 lds
  v_mfma_f32_16x16x32_bf16 v[120:123], a[92:95], a[92:95], v[120:123]
  ds_read_b128 a[12:15], v86 offset:0
  v_mfma_f32_16x16x32_bf16 v[100:103], a[156:159], a[92:95], v[100:103]
  ds_read_b64_tr_b16 a[76:77], v36 offset:12288
  v_mfma_f32_16x16x32_bf16 v[124:127], a[156:159], v[40:43], v[124:127]
  ds_read_b64_tr_b16 a[78:79], v36 offset:12800
  v_mfma_f32_16x16x32_bf16 v[104:107], a[156:159], a[108:111], v[104:107]
  ds_read_b128 a[28:31], v90 offset:0
  buffer_load_dwordx4 v21, s[40:43], s88 offen offset:3072 lds
  v_mfma_f32_16x16x32_bf16 v[108:111], a[156:159], a[124:127], v[108:111]
  ds_read_b128 a[44:47], v94 offset:0
  v_mfma_f32_16x16x32_bf16 v[112:115], a[156:159], a[140:143], v[112:115]
  ds_read_b128 a[60:63], v98 offset:0
  s_waitcnt lgkmcnt(15)
  v_mfma_f32_16x16x32_bf16 v[116:119], v[40:43], a[0:3], v[116:119]
  v_mfma_f32_16x16x32_bf16 v[120:123], a[0:3], a[0:3], v[120:123]
  s_lshl_b32 s81, s34, 7
  s_add_u32 s81, s81, 0x7000
  v_lshl_add_u32 v12, v4, 2, s81
  buffer_load_dword v12, v12, s[60:63], 0 offen sc1
  v_add_f32 v66, v66, v67
  v_mfma_f32_16x16x32_bf16 v[100:103], a[64:67], a[0:3], v[100:103]
  v_add_f32 v68, v68, v69
  v_mfma_f32_16x16x32_bf16 v[124:127], a[64:67], v[40:43], v[124:127]
  v_cvt_pk_bf16_f32 v66, v66, v68
  v_mfma_f32_16x16x32_bf16 v[104:107], a[64:67], a[16:19], v[104:107]
  s_waitcnt lgkmcnt(0)
  s_cmp_lg_u32 s19, 2
  s_cbranch_scc1 L_cap_3
  ds_read_b64 v[128:129], v52
  ds_read_b64 v[130:131], v22
  ds_read_b64 v[132:133], v23
  ds_read_b64 v[134:135], v24
L_cap_3:
  ds_write_b32 v17, v66 offset:13312
  v_mfma_f32_16x16x32_bf16 v[108:111], a[64:67], a[32:35], v[108:111]
  s_add_u32 s88, s76, 0
  s_and_b32 s88, s88, 3
  s_lshl_b32 s88, s88, 17
  s_add_u32 m0, s96, 0x0
  s_nop 0
  buffer_load_dwordx4 v18, s[44:47], s88 offen lds
  ds_read2st64_b32 v[66:67], v17 offset0:8 offset1:20
  v_mfma_f32_16x16x32_bf16 v[112:115], a[64:67], a[48:51], v[112:115]
  ds_read2st64_b32 v[68:69], v17 offset0:32 offset1:44
  v_mfma_f32_16x16x32_bf16 v[116:119], v[40:43], a[4:7], v[116:119]
  v_mfma_f32_16x16x32_bf16 v[120:123], a[4:7], a[4:7], v[120:123]
  v_mfma_f32_16x16x32_bf16 v[100:103], a[68:71], a[4:7], v[100:103]
  buffer_load_dwordx4 v19, s[44:47], s88 offen offset:1024 lds
  s_waitcnt lgkmcnt(0)
  v_add_f32 v66, v66, v67
  v_mfma_f32_16x16x32_bf16 v[124:127], a[68:71], v[40:43], v[124:127]
  v_add_f32 v68, v68, v69
  v_mfma_f32_16x16x32_bf16 v[104:107], a[68:71], a[20:23], v[104:107]
  v_cvt_pk_bf16_f32 v66, v66, v68
  v_mfma_f32_16x16x32_bf16 v[108:111], a[68:71], a[36:39], v[108:111]
  ds_write_b32 v17, v66 offset:14336
  v_mfma_f32_16x16x32_bf16 v[112:115], a[68:71], a[52:55], v[112:115]
  s_waitcnt vmcnt(3)
  s_waitcnt lgkmcnt(0)
  s_barrier
  ds_read_b128 a[80:83], v83 offset:32768
  ds_read_b128 a[84:87], v84 offset:32768
  buffer_load_dwordx4 v20, s[44:47], s88 offen offset:2048 lds
  v_mfma_f32_16x16x32_bf16 v[116:119], v[40:43], a[8:11], v[116:119]
  ds_read_b128 a[88:91], v85 offset:32768
  ds_read_b128 a[92:95], v86 offset:32768
  v_mfma_f32_16x16x32_bf16 v[120:123], a[8:11], a[8:11], v[120:123]
  ds_read_b64_tr_b16 a[144:145], v36 offset:32768
  ds_read_b64_tr_b16 a[146:147], v36 offset:33280
  v_mfma_f32_16x16x32_bf16 v[100:103], a[72:75], a[8:11], v[100:103]
  ds_read_b128 a[96:99], v87 offset:32768
  ds_read_b128 a[112:115], v91 offset:32768
  v_mfma_f32_16x16x32_bf16 v[124:127], a[72:75], v[40:43], v[124:127]
  ds_read_b128 a[128:131], v95 offset:32768
  ds_read_b64_tr_b16 a[148:149], v36 offset:36864
  buffer_load_dwordx4 v21, s[44:47], s88 offen offset:3072 lds
  v_mfma_f32_16x16x32_bf16 v[104:107], a[72:75], a[24:27], v[104:107]
  ds_read_b64_tr_b16 a[150:151], v36 offset:37376
  ds_read_b128 a[100:103], v88 offset:32768
  v_mfma_f32_16x16x32_bf16 v[108:111], a[72:75], a[40:43], v[108:111]
  ds_read_b128 a[116:119], v92 offset:32768
  ds_read_b128 a[132:135], v96 offset:32768
  v_mfma_f32_16x16x32_bf16 v[112:115], a[72:75], a[56:59], v[112:115]
  ds_read_b64_tr_b16 a[152:153], v36 offset:40960
  ds_read_b64_tr_b16 a[154:155], v36 offset:41472
  v_mfma_f32_16x16x32_bf16 v[116:119], v[40:43], a[12:15], v[116:119]
  ds_read_b128 a[104:107], v89 offset:32768
  ds_read_b128 a[120:123], v93 offset:32768
  s_add_u32 s88, s76, 1
  s_and_b32 s88, s88, 3
  s_lshl_b32 s88, s88, 17
  s_add_u32 m0, s96, 0x4000
  s_nop 0
  buffer_load_dwordx4 v18, s[44:47], s88 offen lds
  v_mfma_f32_16x16x32_bf16 v[120:123], a[12:15], a[12:15], v[120:123]
  ds_read_b128 a[136:139], v97 offset:32768
  v_mfma_f32_16x16x32_bf16 v[100:103], a[76:79], a[12:15], v[100:103]
  ds_read_b64_tr_b16 a[156:157], v36 offset:45056
  v_mfma_f32_16x16x32_bf16 v[124:127], a[76:79], v[40:43], v[124:127]
  ds_read_b64_tr_b16 a[158:159], v36 offset:45568
  v_mfma_f32_16x16x32_bf16 v[104:107], a[76:79], a[28:31], v[104:107]
  ds_read_b128 a[108:111], v90 offset:32768
  buffer_load_dwordx4 v19, s[44:47], s88 offen offset:1024 lds
  v_mfma_f32_16x16x32_bf16 v[108:111], a[76:79], a[44:47], v[108:111]
  ds_read_b128 a[124:127], v94 offset:32768
  v_mfma_f32_16x16x32_bf16 v[112:115], a[76:79], a[60:63], v[112:115]
  ds_read_b128 a[140:143], v98 offset:32768
  ds_read_b128 v[136:139], v45 offset:0
  ds_read_b128 v[140:143], v45 offset:1024
  s_waitcnt lgkmcnt(15)
  v_mfma_f32_16x16x32_bf16 v[116:119], v[40:43], a[80:83], v[116:119]
  v_mfma_f32_16x16x32_bf16 v[120:123], a[80:83], a[80:83], v[120:123]
  v_mfma_f32_16x16x32_bf16 v[116:119], v[40:43], a[84:87], v[116:119]
  v_mfma_f32_16x16x32_bf16 v[120:123], a[84:87], a[84:87], v[120:123]
  v_mfma_f32_16x16x32_bf16 v[116:119], v[40:43], a[88:91], v[116:119]
  v_mfma_f32_16x16x32_bf16 v[120:123], a[88:91], a[88:91], v[120:123]
  v_mfma_f32_16x16x32_bf16 v[116:119], v[40:43], a[92:95], v[116:119]
  v_mfma_f32_16x16x32_bf16 v[120:123], a[92:95], a[92:95], v[120:123]
  s_waitcnt lgkmcnt(0)
  s_cmp_lg_u32 s19, 3
  s_cbranch_scc1 L_cap_4
  ds_read_b64 v[128:129], v52
  ds_read_b64 v[130:131], v22
  ds_read_b64 v[132:133], v23
  ds_read_b64 v[134:135], v24
L_cap_4:
  v_mfma_f32_16x16x32_bf16 v[100:103], a[144:147], a[80:83], v[100:103]
  v_mov_b32 v15, 0
  v_mov_b32 v16, 0
  v_dot2_f32_bf16 v15, v136, v40, v15
  v_dot2_f32_bf16 v16, v136, v136, v16
  v_mfma_f32_16x16x32_bf16 v[124:127], a[144:147], v[40:43], v[124:127]
  v_dot2_f32_bf16 v15, v137, v40, v15
  v_dot2_f32_bf16 v16, v137, v137, v16
  v_dot2_f32_bf16 v15, v138, v40, v15
  v_dot2_f32_bf16 v16, v138, v138, v16
  buffer_load_dwordx4 v20, s[44:47], s88 offen offset:2048 lds
  v_mfma_f32_16x16x32_bf16 v[104:107], a[144:147], a[96:99], v[104:107]
  v_dot2_f32_bf16 v15, v139, v40, v15
  v_dot2_f32_bf16 v16, v139, v139, v16
  v_dot2_f32_bf16 v15, v140, v40, v15
  v_dot2_f32_bf16 v16, v140, v140, v16
  v_mfma_f32_16x16x32_bf16 v[108:111], a[144:147], a[112:115], v[108:111]
  v_dot2_f32_bf16 v15, v141, v40, v15
  v_dot2_f32_bf16 v16, v141, v141, v16
  v_dot2_f32_bf16 v15, v142, v40, v15
  v_dot2_f32_bf16 v16, v142, v142, v16
  v_mfma_f32_16x16x32_bf16 v[112:115], a[144:147], a[128:131], v[112:115]
  v_dot2_f32_bf16 v15, v143, v40, v15
  v_dot2_f32_bf16 v16, v143, v143, v16
  s_nop 1
  v_add_f32_dpp v15, v15, v15 row_ror:8 row_mask:0xf bank_mask:0xf
  v_add_f32_dpp v16, v16, v16 row_ror:8 row_mask:0xf bank_mask:0xf
  v_mfma_f32_16x16x32_bf16 v[100:103], a[148:151], a[84:87], v[100:103]
  v_add_f32_dpp v15, v15, v15 row_ror:4 row_mask:0xf bank_mask:0xf
  v_add_f32_dpp v16, v16, v16 row_ror:4 row_mask:0xf bank_mask:0xf
  s_nop 0
  v_add_f32_dpp v15, v15, v15 row_ror:2 row_mask:0xf bank_mask:0xf
  v_add_f32_dpp v16, v16, v16 row_ror:2 row_mask:0xf bank_mask:0xf
  buffer_load_dwordx4 v21, s[44:47], s88 offen offset:3072 lds
  v_mfma_f32_16x16x32_bf16 v[124:127], a[148:151], v[40:43], v[124:127]
  v_add_f32_dpp v15, v15, v15 row_ror:1 row_mask:0xf bank_mask:0xf
  v_add_f32_dpp v16, v16, v16 row_ror:1 row_mask:0xf bank_mask:0xf
  v_mov_b32 v13, v15
  v_mov_b32 v14, v16
  v_mfma_f32_16x16x32_bf16 v[104:107], a[148:151], a[100:103], v[104:107]
  v_cndmask_b32 v120, v120, v121, s[66:67]
  v_permlane32_swap_b32 v15, v13
  v_permlane32_swap_b32 v16, v14
  v_cndmask_b32 v120, v120, v122, s[68:69]
  v_mfma_f32_16x16x32_bf16 v[108:111], a[148:151], a[116:119], v[108:111]
  v_add_f32 v15, v15, v13
  v_add_f32 v16, v16, v14
  v_cndmask_b32 v120, v120, v123, s[70:71]
  s_mov_b32 s64, 0x10010
  v_mfma_f32_16x16x32_bf16 v[112:115], a[148:151], a[132:135], v[112:115]
  s_mov_b32 s65, 0
  v_cndmask_b32 v116, v116, v15, s[64:65]
  v_cndmask_b32 v120, v120, v16, s[64:65]
  v_mul_f32 v13, 0x3b000000, v116
  s_add_u32 s88, s76, 2
  s_and_b32 s88, s88, 3
  s_lshl_b32 s88, s88, 17
  s_add_u32 m0, s96, 0x8000
  s_nop 0
  buffer_load_dwordx4 v18, s[44:47], s88 offen lds
  v_mfma_f32_16x16x32_bf16 v[100:103], a[152:155], a[88:91], v[100:103]
  v_mul_f32 v16, 0x3b000000, v120
  v_fma_f32 v14, -v13, v13, v16
  v_max_f32 v14, 0, v14
  v_cvt_pk_bf16_f32 v146, v14, v14
  v_mfma_f32_16x16x32_bf16 v[124:127], a[152:155], v[40:43], v[124:127]
  v_and_b32 v146, 0xffff0000, v146
  v_add_f32 v146, 0x3727c5ac, v146
  v_cvt_pk_bf16_f32 v146, v146, v146
  v_and_b32 v146, 0xffff0000, v146
  v_mfma_f32_16x16x32_bf16 v[104:107], a[152:155], a[104:107], v[104:107]
  v_sqrt_f32 v146, v146
  s_nop 0
  v_cvt_pk_bf16_f32 v146, v146, v146
  v_and_b32 v146, 0xffff0000, v146
  v_rcp_f32 v146, v146
  v_mfma_f32_16x16x32_bf16 v[108:111], a[152:155], a[120:123], v[108:111]
  v_sub_f32 v144, 0, v13
  v_mul_f32 v14, v14, v146
  v_cvt_pk_bf16_f32 v13, v144, v144
  v_and_b32 v13, 0xffff0000, v13
  buffer_load_dwordx4 v19, s[44:47], s88 offen offset:1024 lds
  v_mfma_f32_16x16x32_bf16 v[112:115], a[152:155], a[136:139], v[112:115]
  v_mul_f32 v14, v14, v146
  v_mul_f32 v147, v13, v146
  v_cvt_pk_bf16_f32 v15, v14, v14
  v_and_b32 v15, 0xffff0000, v15
  v_mfma_f32_16x16x32_bf16 v[100:103], a[156:159], a[92:95], v[100:103]
  v_add_f32 v15, 0x3727c5ac, v15
  v_cvt_pk_bf16_f32 v15, v15, v15
  v_and_b32 v15, 0xffff0000, v15
  v_sqrt_f32 v15, v15
  v_mfma_f32_16x16x32_bf16 v[124:127], a[156:159], v[40:43], v[124:127]
  v_cvt_pk_bf16_f32 v15, v15, v15
  v_and_b32 v15, 0xffff0000, v15
  v_rcp_f32 v15, v15
  s_sub_u32 s81, s91, s79
  v_mfma_f32_16x16x32_bf16 v[104:107], a[156:159], a[108:111], v[104:107]
  v_add_u32 v16, s81, v2
  v_mul_f32 v14, 0xbeeff558, v146
  v_cmp_gt_u32 vcc, 0x800, v16
  v_mul_f32 v15, v15, v14
  buffer_load_dwordx4 v20, s[44:47], s88 offen offset:2048 lds
  v_mfma_f32_16x16x32_bf16 v[108:111], a[156:159], a[124:127], v[108:111]
  v_cndmask_b32 v145, 0, v15, vcc
  v_mfma_f32_16x16x32_bf16 v[112:115], a[156:159], a[140:143], v[112:115]
  s_mov_b32 exec_lo, 0x00f1001f
  s_mov_b32 exec_hi, 0xf0000f00
  ds_write_b128 v39, v[144:147]
  s_mov_b64 exec, -1
  s_waitcnt lgkmcnt(0)
  s_barrier
  s_lshl_b32 s81, s3, 8
  v_xor_b32 v6, s81, v44
  ds_read_b64 v[66:67], v6
  v_xor_b32 v7, 0x100, v6
  ds_read_b64 v[68:69], v7
  v_xor_b32 v7, 0x200, v6
  ds_read_b64 v[70:71], v7
  v_xor_b32 v7, 0x300, v6
  ds_read_b64 v[72:73], v7
  ds_read_b64 v[14:15], v53
  s_waitcnt lgkmcnt(4)
  v_pk_fma_f32 v[100:101], v[66:67], v[124:125], v[100:101] op_sel_hi:[0,1,1]
  v_pk_fma_f32 v[102:103], v[66:67], v[126:127], v[102:103] op_sel_hi:[0,1,1]
  s_waitcnt lgkmcnt(3)
  v_pk_fma_f32 v[104:105], v[68:69], v[124:125], v[104:105] op_sel_hi:[0,1,1]
  v_pk_fma_f32 v[106:107], v[68:69], v[126:127], v[106:107] op_sel_hi:[0,1,1]
  s_waitcnt lgkmcnt(2)
  v_pk_fma_f32 v[108:109], v[70:71], v[124:125], v[108:109] op_sel_hi:[0,1,1]
  v_pk_fma_f32 v[110:111], v[70:71], v[126:127], v[110:111] op_sel_hi:[0,1,1]
  s_waitcnt lgkmcnt(1)
  v_pk_fma_f32 v[112:113], v[72:73], v[124:125], v[112:113] op_sel_hi:[0,1,1]
  v_pk_fma_f32 v[114:115], v[72:73], v[126:127], v[114:115] op_sel_hi:[0,1,1]
  v_pk_mul_f32 v[100:101], v[100:101], v[66:67] op_sel:[0,1]
  v_pk_mul_f32 v[102:103], v[102:103], v[66:67] op_sel:[0,1]
  v_pk_mul_f32 v[104:105], v[104:105], v[68:69] op_sel:[0,1]
  v_pk_mul_f32 v[106:107], v[106:107], v[68:69] op_sel:[0,1]
  v_pk_mul_f32 v[108:109], v[108:109], v[70:71] op_sel:[0,1]
  v_pk_mul_f32 v[110:111], v[110:111], v[70:71] op_sel:[0,1]
  v_pk_mul_f32 v[112:113], v[112:113], v[72:73] op_sel:[0,1]
  v_pk_mul_f32 v[114:115], v[114:115], v[72:73] op_sel:[0,1]
  v_pk_fma_f32 v[74:75], v[100:101], v[100:101], s[72:73]
  buffer_load_dwordx4 v21, s[44:47], s88 offen offset:3072 lds
  v_pk_fma_f32 v[76:77], v[102:103], v[102:103], s[72:73]
  v_pk_fma_f32 v[78:79], v[104:105], v[104:105], s[72:73]
  v_pk_fma_f32 v[80:81], v[106:107], v[106:107], s[72:73]
  v_pk_fma_f32 v[82:83], v[108:109], v[108:109], s[72:73]
  v_pk_fma_f32 v[84:85], v[110:111], v[110:111], s[72:73]
  v_pk_fma_f32 v[86:87], v[112:113], v[112:113], s[72:73]
  v_pk_fma_f32 v[88:89], v[114:115], v[114:115], s[72:73]
  v_pk_mul_f32 v[74:75], v[74:75], v[100:101]
  s_add_u32 s88, s76, 3
  s_and_b32 s88, s88, 3
  s_lshl_b32 s88, s88, 17
  s_add_u32 m0, s96, 0xc000
  s_nop 0
  buffer_load_dwordx4 v18, s[44:47], s88 offen lds
  v_pk_mul_f32 v[76:77], v[76:77], v[102:103]
  v_pk_mul_f32 v[78:79], v[78:79], v[104:105]
  v_pk_mul_f32 v[80:81], v[80:81], v[106:107]
  v_pk_mul_f32 v[82:83], v[82:83], v[108:109]
  v_pk_mul_f32 v[84:85], v[84:85], v[110:111]
  v_pk_mul_f32 v[86:87], v[86:87], v[112:113]
  v_pk_mul_f32 v[88:89], v[88:89], v[114:115]
  v_exp_f32 v74, v74
  buffer_load_dwordx4 v19, s[44:47], s88 offen offset:1024 lds
  v_exp_f32 v75, v75
  v_exp_f32 v76, v76
  v_exp_f32 v77, v77
  v_exp_f32 v78, v78
  v_exp_f32 v79, v79
  v_exp_f32 v80, v80
  v_exp_f32 v81, v81
  v_exp_f32 v82, v82
  buffer_load_dwordx4 v20, s[44:47], s88 offen offset:2048 lds
  v_exp_f32 v83, v83
  v_exp_f32 v84, v84
  v_exp_f32 v85, v85
  v_exp_f32 v86, v86
  v_exp_f32 v87, v87
  v_exp_f32 v88, v88
  v_exp_f32 v89, v89
  v_pk_fma_f32 v[74:75], v[74:75], s[74:75], s[74:75]
  buffer_load_dwordx4 v21, s[44:47], s88 offen offset:3072 lds
  v_pk_fma_f32 v[76:77], v[76:77], s[74:75], s[74:75]
  v_pk_fma_f32 v[78:79], v[78:79], s[74:75], s[74:75]
  v_pk_fma_f32 v[80:81], v[80:81], s[74:75], s[74:75]
  v_pk_fma_f32 v[82:83], v[82:83], s[74:75], s[74:75]
  v_pk_fma_f32 v[84:85], v[84:85], s[74:75], s[74:75]
  v_pk_fma_f32 v[86:87], v[86:87], s[74:75], s[74:75]
  v_pk_fma_f32 v[88:89], v[88:89], s[74:75], s[74:75]
  v_rcp_f32 v74, v74
  v_rcp_f32 v75, v75
  v_rcp_f32 v76, v76
  v_rcp_f32 v77, v77
  v_rcp_f32 v78, v78
  v_rcp_f32 v79, v79
  v_rcp_f32 v80, v80
  v_rcp_f32 v81, v81
  v_rcp_f32 v82, v82
  v_rcp_f32 v83, v83
  v_rcp_f32 v84, v84
  v_rcp_f32 v85, v85
  v_rcp_f32 v86, v86
  v_rcp_f32 v87, v87
  v_rcp_f32 v88, v88
  v_rcp_f32 v89, v89
  v_pk_mul_f32 v[74:75], v[74:75], v[100:101]
  v_pk_mul_f32 v[76:77], v[76:77], v[102:103]
  v_pk_mul_f32 v[78:79], v[78:79], v[104:105]
  v_pk_mul_f32 v[80:81], v[80:81], v[106:107]
  v_pk_mul_f32 v[82:83], v[82:83], v[108:109]
  v_pk_mul_f32 v[84:85], v[84:85], v[110:111]
  v_pk_mul_f32 v[86:87], v[86:87], v[112:113]
  v_pk_mul_f32 v[88:89], v[88:89], v[114:115]
  v_cvt_pk_bf16_f32 v92, v74, v75
  v_cvt_pk_bf16_f32 v93, v76, v77
  v_cvt_pk_bf16_f32 v94, v78, v79
  v_cvt_pk_bf16_f32 v95, v80, v81
  v_cvt_pk_bf16_f32 v96, v82, v83
  v_cvt_pk_bf16_f32 v97, v84, v85
  v_cvt_pk_bf16_f32 v98, v86, v87
  v_cvt_pk_bf16_f32 v99, v88, v89
  v_xor_b32 v6, 0x200, v46
  v_permlane16_swap_b32 v92, v94
  v_permlane16_swap_b32 v93, v95
  v_permlane16_swap_b32 v96, v98
  v_permlane16_swap_b32 v97, v99
  s_waitcnt vmcnt(16)
  v_cmp_ne_u32 vcc, s21, v12
  s_cbranch_vccnz L_slow
  buffer_store_dwordx4 v[92:95], v46, s[60:63], s9 offen sc1
  buffer_store_dwordx4 v[96:99], v6, s[60:63], s9 offen sc1
  s_lshl_b32 s23, s3, 13
  s_waitcnt lgkmcnt(0)
  v_lshlrev_b32 v16, 16, v128
  v_and_b32 v17, 0xffff0000, v128
  v_pk_fma_f32 v[16:17], v[16:17], v[14:15], v[14:15] op_sel:[0,0,1] op_sel_hi:[1,0,1]
  v_cvt_pk_bf16_f32 v88, v16, v17
  v_lshlrev_b32 v12, 16, v129
  v_and_b32 v13, 0xffff0000, v129
  v_pk_fma_f32 v[12:13], v[12:13], v[14:15], v[14:15] op_sel:[0,0,1] op_sel_hi:[1,0,1]
  v_cvt_pk_bf16_f32 v89, v12, v13
  v_lshlrev_b32 v16, 16, v130
  v_and_b32 v17, 0xffff0000, v130
  v_pk_fma_f32 v[16:17], v[16:17], v[14:15], v[14:15] op_sel:[0,0,1] op_sel_hi:[1,0,1]
  v_cvt_pk_bf16_f32 v90, v16, v17
  v_lshlrev_b32 v12, 16, v131
  v_and_b32 v13, 0xffff0000, v131
  v_pk_fma_f32 v[12:13], v[12:13], v[14:15], v[14:15] op_sel:[0,0,1] op_sel_hi:[1,0,1]
  v_cvt_pk_bf16_f32 v91, v12, v13
  v_lshlrev_b32 v16, 16, v132
  v_and_b32 v17, 0xffff0000, v132
  v_pk_fma_f32 v[16:17], v[16:17], v[14:15], v[14:15] op_sel:[0,0,1] op_sel_hi:[1,0,1]
  v_cvt_pk_bf16_f32 v92, v16, v17
  v_lshlrev_b32 v12, 16, v133
  v_and_b32 v13, 0xffff0000, v133
  v_pk_fma_f32 v[12:13], v[12:13], v[14:15], v[14:15] op_sel:[0,0,1] op_sel_hi:[1,0,1]
  v_cvt_pk_bf16_f32 v93, v12, v13
  v_lshlrev_b32 v16, 16, v134
  v_and_b32 v17, 0xffff0000, v134
  v_pk_fma_f32 v[16:17], v[16:17], v[14:15], v[14:15] op_sel:[0,0,1] op_sel_hi:[1,0,1]
  v_cvt_pk_bf16_f32 v94, v16, v17
  v_lshlrev_b32 v12, 16, v135
  v_and_b32 v13, 0xffff0000, v135
  v_pk_fma_f32 v[12:13], v[12:13], v[14:15], v[14:15] op_sel:[0,0,1] op_sel_hi:[1,0,1]
  v_cvt_pk_bf16_f32 v95, v12, v13
  s_add_u32 s81, s23, 0x10000
  v_and_b32 v6, 3, v2
  v_lshlrev_b32 v6, 5, v6
  v_lshl_add_u32 v6, v2, 7, v6
  v_lshl_add_u32 v6, v3, 3, v6
  v_add_u32 v6, s81, v6
  ds_write_b64 v6, v[88:89]
  v_xor_b32 v7, 32, v6
  ds_write_b64 v7, v[90:91]
  v_xor_b32 v7, 64, v6
  ds_write_b64 v7, v[92:93]
  v_xor_b32 v7, 96, v6
  ds_write_b64 v7, v[94:95]
  v_bfe_u32 v7, v1, 2, 2
  v_xor_b32 v8, v7, v3
  v_lshlrev_b32 v8, 5, v8
  v_lshl_add_u32 v8, v7, 7, v8
  v_and_b32 v7, 3, v1
  v_lshl_add_u32 v8, v7, 3, v8
  v_add_u32 v20, s81, v8
  ds_read_b64_tr_b16 v[68:69], v20 offset:0
  ds_read_b64_tr_b16 v[72:73], v20 offset:512
  ds_read_b64_tr_b16 v[76:77], v20 offset:1024
  ds_read_b64_tr_b16 v[18:19], v20 offset:1536
  ds_read_b32 v96, v54
  ds_read_b32 v97, v55
  ds_read_b32 v98, v56
  ds_read_b32 v99, v57
  ds_read_b32 v100, v58
  ds_read_b32 v101, v59
  ds_read_b32 v102, v60
  ds_read_b32 v103, v61
  ds_read_b32 v104, v62
  ds_read_b32 v105, v63
  ds_read_b32 v106, v64
  v_mov_b32 v7, 0x24000
  ds_read_b128 v[108:111], v7 offset:0
  ds_read_b128 v[112:115], v7 offset:3072
  ds_read_b128 v[116:119], v7 offset:6144
  ds_read_b128 v[120:123], v7 offset:9216
  s_waitcnt vmcnt(0)
  s_mov_b64 exec, 1
  buffer_store_dword v10, v9, s[60:63], s4 offen
  s_mov_b64 exec, -1
  s_lshr_b32 s83, s78, 6
  s_lshl_b32 s81, s83, 7
  s_add_u32 s81, s81, 0x1000
  v_lshl_add_u32 v14, v4, 2, s81
  s_lshl_b32 s81, s3, 11
  s_add_u32 s81, s81, 0x21800
  v_add_u32 v21, s81, v37
  v_mov_b32 v71, v10
  v_mov_b32 v75, v10
  v_mov_b32 v78, v10
  v_mov_b32 v79, v10
  v_lshrrev_b32 v6, 1, v0
  v_and_b32 v7, 1, v0
  v_mul_u32_u24 v8, 0x600, v6
  v_add_lshl_u32 v15, v8, v7, 4
  s_and_b32 s81, s87, 0x1fe
  s_lshl_b32 s24, s81, 4
  s_add_u32 s24, s24, 0x1600000
  s_add_u32 s25, s24, 0x2000
  s_add_u32 s26, s24, 0x4000
  s_waitcnt lgkmcnt(15)
  v_mov_b32 v70, v18
  v_mov_b32 v74, v19
  ds_read_b64_tr_b16 v[80:81], v21 offset:0
  ds_read_b64_tr_b16 v[82:83], v21 offset:512
  ds_read_b64_tr_b16 v[84:85], v21 offset:1024
  ds_read_b64_tr_b16 v[86:87], v21 offset:1536
  buffer_store_dwordx4 v[68:71], v38, s[60:63], s12 offen sc1
  s_add_u32 s12, s12, 0x2000
  buffer_store_dwordx4 v[72:75], v38, s[60:63], s12 offen sc1
  s_add_u32 s12, s12, 0x2000
  buffer_store_dwordx4 v[76:79], v38, s[60:63], s12 offen sc1
  s_waitcnt lgkmcnt(0)
  buffer_store_dwordx4 v[80:83], v38, s[60:63], s20 offen sc1
  buffer_store_dwordx4 v[84:87], v38, s[60:63], s20 offen offset:2048 sc1
  buffer_load_dword v18, v14, s[60:63], 0 offen sc1
  s_mov_b32 s82, 0x05040100
  s_mov_b32 s83, 0x07060302
  s_barrier
  ds_read_b64_tr_b16 a[0:1], v48 offset:0
  v_lshlrev_b32 v19, 4, v0
  ds_read_b64_tr_b16 a[2:3], v48 offset:512
  v_sub_u32 v19, 0x19020, v19
  ds_read_b64_tr_b16 a[4:5], v49 offset:0
  ds_read_b64_tr_b16 a[6:7], v49 offset:512
  v_perm_b32 v20, v102, v103, s82
  ds_read_b64_tr_b16 a[8:9], v50 offset:0
  v_perm_b32 v21, v100, v101, s82
  ds_read_b64_tr_b16 a[10:11], v50 offset:512
  v_perm_b32 v22, v98, v99, s82
  ds_read_b64_tr_b16 a[12:13], v51 offset:0
  v_perm_b32 v23, v96, v97, s82
  ds_read_b64_tr_b16 a[14:15], v51 offset:512
  ds_write_b128 v19, v[20:23] offset:0
  ds_read_b64_tr_b16 a[16:17], v48 offset:4096
  v_perm_b32 v32, v103, v104, s82
  ds_read_b64_tr_b16 a[18:19], v48 offset:4608
  v_perm_b32 v33, v101, v102, s82
  ds_read_b64_tr_b16 a[20:21], v49 offset:4096
  v_perm_b32 v34, v99, v100, s82
  ds_read_b64_tr_b16 a[22:23], v49 offset:4608
  v_perm_b32 v35, v97, v98, s82
  ds_read_b64_tr_b16 a[24:25], v50 offset:4096
  ds_write_b128 v19, v[32:35] offset:4416
  ds_read_b64_tr_b16 a[26:27], v50 offset:4608
  v_perm_b32 v20, v104, v105, s82
  ds_read_b64_tr_b16 a[28:29], v51 offset:4096
  v_perm_b32 v21, v102, v103, s82
  ds_read_b64_tr_b16 a[30:31], v51 offset:4608
  v_perm_b32 v22, v100, v101, s82
  ds_read_b64_tr_b16 a[32:33], v48 offset:8192
  v_perm_b32 v23, v98, v99, s82
  ds_read_b64_tr_b16 a[34:35], v48 offset:8704
  ds_write_b128 v19, v[20:23] offset:8832
  ds_read_b64_tr_b16 a[36:37], v49 offset:8192
  v_perm_b32 v32, v105, v106, s82
  ds_read_b64_tr_b16 a[38:39], v49 offset:8704
  v_perm_b32 v33, v103, v104, s82
  ds_read_b64_tr_b16 a[40:41], v50 offset:8192
  v_perm_b32 v34, v101, v102, s82
  ds_read_b64_tr_b16 a[42:43], v50 offset:8704
  v_perm_b32 v35, v99, v100, s82
  ds_read_b64_tr_b16 a[44:45], v51 offset:8192
  ds_write_b128 v19, v[32:35] offset:13248
  ds_read_b64_tr_b16 a[46:47], v51 offset:8704
  v_perm_b32 v20, v102, v103, s83
  ds_read_b64_tr_b16 a[48:49], v48 offset:12288
  v_perm_b32 v21, v100, v101, s83
  ds_read_b64_tr_b16 a[50:51], v48 offset:12800
  v_perm_b32 v22, v98, v99, s83
  ds_read_b64_tr_b16 a[52:53], v49 offset:12288
  v_perm_b32 v23, v96, v97, s83
  ds_read_b64_tr_b16 a[54:55], v49 offset:12800
  ds_write_b128 v19, v[20:23] offset:17456
  ds_read_b64_tr_b16 a[56:57], v50 offset:12288
  v_perm_b32 v32, v103, v104, s83
  ds_read_b64_tr_b16 a[58:59], v50 offset:12800
  v_perm_b32 v33, v101, v102, s83
  ds_read_b64_tr_b16 a[60:61], v51 offset:12288
  v_perm_b32 v34, v99, v100, s83
  ds_read_b64_tr_b16 a[62:63], v51 offset:12800
  v_perm_b32 v35, v97, v98, s83
  ds_read_b64_tr_b16 a[64:65], v48 offset:16384
  ds_write_b128 v19, v[32:35] offset:21872
  ds_read_b64_tr_b16 a[66:67], v48 offset:16896
  v_perm_b32 v20, v104, v105, s83
  ds_read_b64_tr_b16 a[68:69], v49 offset:16384
  v_perm_b32 v21, v102, v103, s83
  ds_read_b64_tr_b16 a[70:71], v49 offset:16896
  v_perm_b32 v22, v100, v101, s83
  ds_read_b64_tr_b16 a[72:73], v50 offset:16384
  v_perm_b32 v23, v98, v99, s83
  ds_read_b64_tr_b16 a[74:75], v50 offset:16896
  ds_write_b128 v19, v[20:23] offset:26288
  ds_read_b64_tr_b16 a[76:77], v51 offset:16384
  v_perm_b32 v32, v105, v106, s83
  ds_read_b64_tr_b16 a[78:79], v51 offset:16896
  v_perm_b32 v33, v103, v104, s83
  ds_read_b64_tr_b16 a[80:81], v48 offset:20480
  v_perm_b32 v34, v101, v102, s83
  ds_read_b64_tr_b16 a[82:83], v48 offset:20992
  v_perm_b32 v35, v99, v100, s83
  ds_read_b64_tr_b16 a[84:85], v49 offset:20480
  ds_write_b128 v19, v[32:35] offset:30704
  ds_read_b64_tr_b16 a[86:87], v49 offset:20992
  ds_read_b64_tr_b16 a[88:89], v50 offset:20480
  ds_read_b64_tr_b16 a[90:91], v50 offset:20992
  ds_read_b64_tr_b16 a[92:93], v51 offset:20480
  ds_read_b64_tr_b16 a[94:95], v51 offset:20992
  ds_read_b64_tr_b16 a[96:97], v48 offset:24576
  ds_read_b64_tr_b16 a[98:99], v48 offset:25088
  ds_read_b64_tr_b16 a[100:101], v49 offset:24576
  ds_read_b64_tr_b16 a[102:103], v49 offset:25088
  ds_read_b64_tr_b16 a[104:105], v50 offset:24576
  ds_read_b64_tr_b16 a[106:107], v50 offset:25088
  ds_read_b64_tr_b16 a[108:109], v51 offset:24576
  ds_read_b64_tr_b16 a[110:111], v51 offset:25088
  ds_read_b64_tr_b16 a[112:113], v48 offset:28672
  ds_read_b64_tr_b16 a[114:115], v48 offset:29184
  ds_read_b64_tr_b16 a[116:117], v49 offset:28672
  ds_read_b64_tr_b16 a[118:119], v49 offset:29184
  ds_read_b64_tr_b16 a[120:121], v50 offset:28672
  ds_read_b64_tr_b16 a[122:123], v50 offset:29184
  ds_read_b64_tr_b16 a[124:125], v51 offset:28672
  ds_read_b64_tr_b16 a[126:127], v51 offset:29184
  s_waitcnt vmcnt(0)
  v_cmp_ne_u32 vcc, s80, v18
  s_cbranch_vccz L_pd_6
  s_mov_b32 s86, 0x100000
L_poll_5:
  buffer_load_dword v18, v14, s[60:63], 0 offen sc1
  s_waitcnt vmcnt(0)
  v_cmp_ne_u32 vcc, s80, v18
  s_cbranch_vccz L_pd_6
  s_sub_u32 s86, s86, 1
  s_cbranch_scc0 L_poll_5
L_pd_6:
  s_add_u32 s27, s76, 0
  s_and_b32 s27, s27, 3
  s_lshl_b32 s27, s27, 19
  s_add_u32 s27, s27, 0x100000
  buffer_load_dwordx4 v[136:139], v47, s[60:63], s27 offen sc1
  s_add_u32 s27, s27, 0x20000
  buffer_load_dwordx4 v[140:143], v47, s[60:63], s27 offen sc1
  s_add_u32 s27, s27, 0x20000
  buffer_load_dwordx4 v[144:147], v47, s[60:63], s27 offen sc1
  s_add_u32 s27, s27, 0x20000
  buffer_load_dwordx4 v[148:151], v47, s[60:63], s27 offen sc1
  s_add_u32 s27, s76, 1
  s_and_b32 s27, s27, 3
  s_lshl_b32 s27, s27, 19
  s_add_u32 s27, s27, 0x100000
  buffer_load_dwordx4 v[152:155], v47, s[60:63], s27 offen sc1
  s_add_u32 s27, s27, 0x20000
  buffer_load_dwordx4 v[156:159], v47, s[60:63], s27 offen sc1
  s_add_u32 s27, s27, 0x20000
  buffer_load_dwordx4 v[160:163], v47, s[60:63], s27 offen sc1
  s_add_u32 s27, s27, 0x20000
  buffer_load_dwordx4 v[164:167], v47, s[60:63], s27 offen sc1
  ds_read_b64_tr_b16 a[128:129], v48 offset:32768
  ds_read_b64_tr_b16 a[130:131], v48 offset:33280
  v_add_f32 v108, v108, v112
  ds_read_b64_tr_b16 a[132:133], v49 offset:32768
  s_add_u32 s27, s76, 2
  s_and_b32 s27, s27, 3
  s_lshl_b32 s27, s27, 19
  s_add_u32 s27, s27, 0x100000
  buffer_load_dwordx4 v[168:171], v47, s[60:63], s27 offen sc1
  v_add_f32 v116, v116, v120
  ds_read_b64_tr_b16 a[134:135], v49 offset:33280
  v_add_f32 v109, v109, v113
  ds_read_b64_tr_b16 a[136:137], v50 offset:32768
  s_add_u32 s27, s27, 0x20000
  buffer_load_dwordx4 v[172:175], v47, s[60:63], s27 offen sc1
  v_add_f32 v117, v117, v121
  ds_read_b64_tr_b16 a[138:139], v50 offset:33280
  v_add_f32 v110, v110, v114
  ds_read_b64_tr_b16 a[140:141], v51 offset:32768
  s_add_u32 s27, s27, 0x20000
  buffer_load_dwordx4 v[176:179], v47, s[60:63], s27 offen sc1
  v_add_f32 v118, v118, v122
  ds_read_b64_tr_b16 a[142:143], v51 offset:33280
  v_add_f32 v111, v111, v115
  ds_read_b64_tr_b16 a[144:145], v48 offset:36864
  s_add_u32 s27, s27, 0x20000
  buffer_load_dwordx4 v[180:183], v47, s[60:63], s27 offen sc1
  v_add_f32 v119, v119, v123
  ds_read_b64_tr_b16 a[146:147], v48 offset:37376
  v_cmp_lt_u32 vcc, 3, v1
  ds_read_b64_tr_b16 a[148:149], v49 offset:36864
  s_add_u32 s27, s76, 3
  s_and_b32 s27, s27, 3
  s_lshl_b32 s27, s27, 19
  s_add_u32 s27, s27, 0x100000
  buffer_load_dwordx4 v[184:187], v47, s[60:63], s27 offen sc1
  v_cndmask_b32 v108, v108, v116, vcc
  ds_read_b64_tr_b16 a[150:151], v49 offset:37376
  v_cndmask_b32 v109, v109, v117, vcc
  ds_read_b64_tr_b16 a[152:153], v50 offset:36864
  s_add_u32 s27, s27, 0x20000
  buffer_load_dwordx4 v[188:191], v47, s[60:63], s27 offen sc1
  v_cndmask_b32 v110, v110, v118, vcc
  ds_read_b64_tr_b16 a[154:155], v50 offset:37376
  v_cndmask_b32 v111, v111, v119, vcc
  ds_read_b64_tr_b16 a[156:157], v51 offset:36864
  s_add_u32 s27, s27, 0x20000
  buffer_load_dwordx4 v[192:195], v47, s[60:63], s27 offen sc1
  v_cvt_pk_bf16_f32 v20, v108, 0
  ds_read_b64_tr_b16 a[158:159], v51 offset:37376
  v_cvt_pk_bf16_f32 v32, v109, v108
  ds_read_b64_tr_b16 a[160:161], v48 offset:40960
  s_add_u32 s27, s27, 0x20000
  buffer_load_dwordx4 v[196:199], v47, s[60:63], s27 offen sc1
  v_cvt_pk_bf16_f32 v33, v110, v109
  ds_read_b64_tr_b16 a[162:163], v48 offset:41472
  v_cvt_pk_bf16_f32 v34, v111, v110
  ds_read_b64_tr_b16 a[164:165], v49 offset:40960
  v_cndmask_b32 v21, 0, v20, s[68:69]
  ds_read_b64_tr_b16 a[166:167], v49 offset:41472
  v_cndmask_b32 v21, v21, v32, s[70:71]
  ds_read_b64_tr_b16 a[168:169], v50 offset:40960
  v_cndmask_b32 v20, v20, v32, s[66:67]
  ds_read_b64_tr_b16 a[170:171], v50 offset:41472
  v_cndmask_b32 v20, v20, v33, s[68:69]
  ds_read_b64_tr_b16 a[172:173], v51 offset:40960
  v_cndmask_b32 v20, v20, v34, s[70:71]
  ds_read_b64_tr_b16 a[174:175], v51 offset:41472
  v_mov_b32 v22, 0
  ds_read_b64_tr_b16 a[176:177], v48 offset:45056
  v_mov_b32 v23, 0
  ds_read_b64_tr_b16 a[178:179], v48 offset:45568
  v_and_b32 v6, 3, v1
  ds_read_b64_tr_b16 a[180:181], v49 offset:45056
  v_mul_u32_u24 v6, 4416, v6
  ds_read_b64_tr_b16 a[182:183], v49 offset:45568
  v_bfe_u32 v7, v1, 2, 1
  ds_read_b64_tr_b16 a[184:185], v50 offset:45056
  v_mul_u32_u24 v7, 17456, v7
  ds_read_b64_tr_b16 a[186:187], v50 offset:45568
  s_mov_b32 s82, 0x19030
  ds_read_b64_tr_b16 a[188:189], v51 offset:45056
  v_add3_u32 v6, v6, v7, s82
  ds_read_b64_tr_b16 a[190:191], v51 offset:45568
  s_mov_b64 exec, 0xff
  ds_write_b128 v6, v[20:23]
  s_mov_b64 exec, -1
  ds_read_b64_tr_b16 a[192:193], v48 offset:49152
  v_mov_b32 v32, 0
  ds_read_b64_tr_b16 a[194:195], v48 offset:49664
  v_mov_b32 v33, 0
  ds_read_b64_tr_b16 a[196:197], v49 offset:49152
  v_mov_b32 v34, 0
  ds_read_b64_tr_b16 a[198:199], v49 offset:49664
  v_mov_b32 v35, 0
  ds_read_b64_tr_b16 a[200:201], v50 offset:49152
  v_and_b32 v6, 7, v1
  ds_read_b64_tr_b16 a[202:203], v50 offset:49664
  v_min_u32 v6, 5, v6
  ds_read_b64_tr_b16 a[204:205], v51 offset:49152
  v_add_u32 v7, 257, v6
  ds_read_b64_tr_b16 a[206:207], v51 offset:49664
  v_cmp_gt_u32 vcc, 3, v6
  ds_read_b64_tr_b16 a[208:209], v48 offset:53248
  v_mul_u32_u24 v8, 17456, v5
  ds_read_b64_tr_b16 a[210:211], v48 offset:53760
  v_cndmask_b32 v6, v7, v6, vcc
  ds_read_b64_tr_b16 a[212:213], v49 offset:53248
  v_bfe_u32 v7, v1, 3, 2
  ds_read_b64_tr_b16 a[214:215], v49 offset:53760
  v_mul_u32_u24 v7, 4416, v7
  ds_read_b64_tr_b16 a[216:217], v50 offset:53248
  v_lshl_add_u32 v6, v6, 4, v7
  ds_read_b64_tr_b16 a[218:219], v50 offset:53760
  s_mov_b32 s82, 0x18000
  ds_read_b64_tr_b16 a[220:221], v51 offset:53248
  v_add3_u32 v6, v6, v8, s82
  ds_read_b64_tr_b16 a[222:223], v51 offset:53760
  ds_write_b128 v6, v[32:35]
  ds_read_b64_tr_b16 a[224:225], v48 offset:57344
  ds_read_b64_tr_b16 a[226:227], v48 offset:57856
  ds_read_b64_tr_b16 a[228:229], v49 offset:57344
  ds_read_b64_tr_b16 a[230:231], v49 offset:57856
  ds_read_b64_tr_b16 a[232:233], v50 offset:57344
  ds_read_b64_tr_b16 a[234:235], v50 offset:57856
  ds_read_b64_tr_b16 a[236:237], v51 offset:57344
  ds_read_b64_tr_b16 a[238:239], v51 offset:57856
  ds_read_b64_tr_b16 a[240:241], v48 offset:61440
  ds_read_b64_tr_b16 a[242:243], v48 offset:61952
  ds_read_b64_tr_b16 a[244:245], v49 offset:61440
  ds_read_b64_tr_b16 a[246:247], v49 offset:61952
  ds_read_b64_tr_b16 a[248:249], v50 offset:61440
  ds_read_b64_tr_b16 a[250:251], v50 offset:61952
  ds_read_b64_tr_b16 a[252:253], v51 offset:61440
  ds_read_b64_tr_b16 a[254:255], v51 offset:61952
  s_waitcnt lgkmcnt(0)
  s_barrier
  s_waitcnt vmcnt(15)
  v_mfma_f32_16x16x32_bf16 v[96:99], a[0:3], v[136:139], 0
  buffer_load_dwordx4 v[52:55], v15, s[60:63], s24 offen sc1
  buffer_load_dwordx4 v[56:59], v15, s[60:63], s25 offen sc1
  buffer_load_dwordx4 v[60:63], v15, s[60:63], s26 offen sc1
  s_mov_b64 exec, 1
  buffer_store_dword v10, v9, s[60:63], s8 offen sc1
  s_mov_b64 exec, -1
  v_lshrrev_b32 v6, 2, v1
  v_mul_u32_u24 v6, 3584, v6
  v_mfma_f32_16x16x32_bf16 v[100:103], a[4:7], v[136:139], 0
  v_and_b32 v7, 3, v1
  v_lshl_add_u32 v6, v7, 4, v6
  v_mfma_f32_16x16x32_bf16 v[104:107], a[8:11], v[136:139], 0
  s_lshl_b32 s82, s15, 6
  v_add_u32 v64, s82, v6
  v_mfma_f32_16x16x32_bf16 v[108:111], a[12:15], v[136:139], 0
  v_add_u32 v65, 0xdc00, v64
  v_add_u32 v66, 0x1b800, v64
  s_waitcnt vmcnt(18)
  v_mfma_f32_16x16x32_bf16 v[96:99], a[16:19], v[140:143], v[96:99]
  v_add_u32 v67, 0x29400, v64
  s_bfe_u32 s22, s14, 0x10007
  v_mfma_f32_16x16x32_bf16 v[100:103], a[20:23], v[140:143], v[100:103]
  s_lshl_b32 s22, s22, 1
  s_add_u32 s22, s22, s34
  s_add_u32 s27, s22, 0
  s_and_b32 s27, s27, 3
  s_mul_i32 s27, s27, 458752
  s_add_u32 m0, s23, 0x10000
  s_nop 0
  buffer_load_dwordx4 v64, s[48:51], s27 offen lds
  v_mfma_f32_16x16x32_bf16 v[104:107], a[24:27], v[140:143], v[104:107]
  s_mul_i32 s82, s3, 2176
  s_add_u32 s82, s82, 0x24000
  v_mfma_f32_16x16x32_bf16 v[108:111], a[28:31], v[140:143], v[108:111]
  v_mul_u32_u24 v6, 136, v2
  v_lshl_add_u32 v6, v3, 3, v6
  s_waitcnt vmcnt(18)
  v_mfma_f32_16x16x32_bf16 v[96:99], a[32:35], v[144:147], v[96:99]
  v_add_u32 v6, s82, v6
  ds_write_b64 v6, v[128:129] offset:0
  v_mfma_f32_16x16x32_bf16 v[100:103], a[36:39], v[144:147], v[100:103]
  ds_write_b64 v6, v[130:131] offset:32
  ds_write_b64 v6, v[132:133] offset:64
  v_mfma_f32_16x16x32_bf16 v[104:107], a[40:43], v[144:147], v[104:107]
  ds_write_b64 v6, v[134:135] offset:96
  v_subrev_u32 v6, 48, v1
  buffer_load_dwordx4 v65, s[48:51], s27 offen offset:1024 lds
  v_mfma_f32_16x16x32_bf16 v[108:111], a[44:47], v[144:147], v[108:111]
  v_min_u32 v7, 5, v6
  v_add_u32 v7, 432, v7
  s_waitcnt vmcnt(18)
  v_mfma_f32_16x16x32_bf16 v[96:99], a[48:51], v[148:151], v[96:99]
  v_cmp_gt_u32 vcc, 48, v1
  s_mul_i32 s82, s90, 7008
  v_mfma_f32_16x16x32_bf16 v[100:103], a[52:55], v[148:151], v[100:103]
  s_add_u32 s82, s82, 0x20860
  v_cndmask_b32 v6, v7, v1, vcc
  v_mfma_f32_16x16x32_bf16 v[104:107], a[56:59], v[148:151], v[104:107]
  v_lshl_add_u32 v6, v6, 4, s82
  ds_write_b128 v6, v[32:35]
  v_mfma_f32_16x16x32_bf16 v[108:111], a[60:63], v[148:151], v[108:111]
  s_mul_i32 s82, s89, 17456
  s_add_u32 s82, s82, 0x18030
  buffer_load_dwordx4 v66, s[48:51], s27 offen offset:2048 lds
  s_waitcnt vmcnt(18)
  v_mfma_f32_16x16x32_bf16 v[96:99], a[64:67], v[152:155], v[96:99]
  s_lshl_b32 s84, s90, 8
  s_sub_u32 s82, s82, s84
  v_mfma_f32_16x16x32_bf16 v[100:103], a[68:71], v[152:155], v[100:103]
  v_and_b32 v6, 3, v2
  v_mul_u32_u24 v6, 4416, v6
  v_mfma_f32_16x16x32_bf16 v[104:107], a[72:75], v[152:155], v[104:107]
  v_lshrrev_b32 v8, 2, v2
  v_sub_u32 v8, v3, v8
  v_mfma_f32_16x16x32_bf16 v[108:111], a[76:79], v[152:155], v[108:111]
  v_lshl_add_u32 v6, v8, 4, v6
  v_add_u32 v11, s82, v6
  s_waitcnt vmcnt(17)
  v_mfma_f32_16x16x32_bf16 v[96:99], a[80:83], v[156:159], v[96:99]
  s_mul_i32 s83, s89, 7008
  s_add_u32 s83, s83, 0x20860
  buffer_load_dwordx4 v67, s[48:51], s27 offen offset:3072 lds
  v_mfma_f32_16x16x32_bf16 v[100:103], a[84:87], v[156:159], v[100:103]
  s_mul_i32 s84, s90, 384
  s_sub_u32 s83, s83, s84
  v_mfma_f32_16x16x32_bf16 v[104:107], a[88:91], v[156:159], v[104:107]
  v_lshrrev_b32 v6, 1, v2
  v_mul_u32_u24 v6, 96, v6
  v_mfma_f32_16x16x32_bf16 v[108:111], a[92:95], v[156:159], v[108:111]
  v_and_b32 v8, 1, v2
  v_lshl_add_u32 v6, v8, 3, v6
  s_waitcnt vmcnt(17)
  v_mfma_f32_16x16x32_bf16 v[96:99], a[96:99], v[160:163], v[96:99]
  v_lshl_add_u32 v6, v3, 4, v6
  v_add_u32 v18, s83, v6
  v_mfma_f32_16x16x32_bf16 v[100:103], a[100:103], v[160:163], v[100:103]
  v_lshl_add_u32 v8, v3, 1, v8
  v_cmp_eq_u32 vcc, 7, v8
  s_add_u32 s27, s27, 0x38000
  s_add_u32 m0, s23, 0x11000
  s_nop 0
  buffer_load_dwordx4 v64, s[48:51], s27 offen lds
  v_mfma_f32_16x16x32_bf16 v[104:107], a[104:107], v[160:163], v[104:107]
  v_cndmask_b32 v8, 8, 40, vcc
  v_add_u32 v19, v18, v8
  v_mfma_f32_16x16x32_bf16 v[108:111], a[108:111], v[160:163], v[108:111]
  v_lshrrev_b32 v6, 1, v0
  v_and_b32 v7, 1, v0
  s_waitcnt vmcnt(17)
  v_mfma_f32_16x16x32_bf16 v[96:99], a[112:115], v[164:167], v[96:99]
  v_and_b32 v6, 1, v6
  v_mul_u32_u24 v7, 7008, v7
  v_mfma_f32_16x16x32_bf16 v[100:103], a[116:119], v[164:167], v[100:103]
  v_lshl_add_u32 v7, v6, 5, v7
  v_lshrrev_b32 v6, 2, v0
  v_mfma_f32_16x16x32_bf16 v[104:107], a[120:123], v[164:167], v[104:107]
  v_mul_u32_u24 v6, 96, v6
  s_mov_b32 s82, 0x20b60
  buffer_load_dwordx4 v65, s[48:51], s27 offen offset:1024 lds
  v_mfma_f32_16x16x32_bf16 v[108:111], a[124:127], v[164:167], v[108:111]
  v_add3_u32 v24, v6, v7, s82
  s_waitcnt vmcnt(17)
  v_mfma_f32_16x16x32_bf16 v[96:99], a[128:131], v[168:171], v[96:99]
  v_mfma_f32_16x16x32_bf16 v[100:103], a[132:135], v[168:171], v[100:103]
  v_mfma_f32_16x16x32_bf16 v[104:107], a[136:139], v[168:171], v[104:107]
  v_mfma_f32_16x16x32_bf16 v[108:111], a[140:143], v[168:171], v[108:111]
  buffer_load_dwordx4 v66, s[48:51], s27 offen offset:2048 lds
  s_waitcnt vmcnt(17)
  v_mfma_f32_16x16x32_bf16 v[96:99], a[144:147], v[172:175], v[96:99]
  v_mfma_f32_16x16x32_bf16 v[100:103], a[148:151], v[172:175], v[100:103]
  v_mfma_f32_16x16x32_bf16 v[104:107], a[152:155], v[172:175], v[104:107]
  v_mfma_f32_16x16x32_bf16 v[108:111], a[156:159], v[172:175], v[108:111]
  s_waitcnt vmcnt(16)
  v_mfma_f32_16x16x32_bf16 v[96:99], a[160:163], v[176:179], v[96:99]
  buffer_load_dwordx4 v67, s[48:51], s27 offen offset:3072 lds
  v_mfma_f32_16x16x32_bf16 v[100:103], a[164:167], v[176:179], v[100:103]
  v_mfma_f32_16x16x32_bf16 v[104:107], a[168:171], v[176:179], v[104:107]
  v_mfma_f32_16x16x32_bf16 v[108:111], a[172:175], v[176:179], v[108:111]
  s_waitcnt vmcnt(16)
  v_mfma_f32_16x16x32_bf16 v[96:99], a[176:179], v[180:183], v[96:99]
  v_mfma_f32_16x16x32_bf16 v[100:103], a[180:183], v[180:183], v[100:103]
  s_add_u32 s27, s22, 1
  s_and_b32 s27, s27, 3
  s_mul_i32 s27, s27, 458752
  s_add_u32 m0, s23, 0x0
  s_nop 0
  buffer_load_dwordx4 v64, s[48:51], s27 offen lds
  v_mfma_f32_16x16x32_bf16 v[104:107], a[184:187], v[180:183], v[104:107]
  v_mfma_f32_16x16x32_bf16 v[108:111], a[188:191], v[180:183], v[108:111]
  s_waitcnt vmcnt(16)
  v_mfma_f32_16x16x32_bf16 v[96:99], a[192:195], v[184:187], v[96:99]
  v_mfma_f32_16x16x32_bf16 v[100:103], a[196:199], v[184:187], v[100:103]
  v_mfma_f32_16x16x32_bf16 v[104:107], a[200:203], v[184:187], v[104:107]
  buffer_load_dwordx4 v65, s[48:51], s27 offen offset:1024 lds
  v_mfma_f32_16x16x32_bf16 v[108:111], a[204:207], v[184:187], v[108:111]
  s_waitcnt vmcnt(16)
  v_mfma_f32_16x16x32_bf16 v[96:99], a[208:211], v[188:191], v[96:99]
  v_mfma_f32_16x16x32_bf16 v[100:103], a[212:215], v[188:191], v[100:103]
  v_mfma_f32_16x16x32_bf16 v[104:107], a[216:219], v[188:191], v[104:107]
  v_mfma_f32_16x16x32_bf16 v[108:111], a[220:223], v[188:191], v[108:111]
  buffer_load_dwordx4 v66, s[48:51], s27 offen offset:2048 lds
  s_waitcnt vmcnt(16)
  v_mfma_f32_16x16x32_bf16 v[96:99], a[224:227], v[192:195], v[96:99]
  v_mfma_f32_16x16x32_bf16 v[100:103], a[228:231], v[192:195], v[100:103]
  v_mfma_f32_16x16x32_bf16 v[104:107], a[232:235], v[192:195], v[104:107]
  v_mfma_f32_16x16x32_bf16 v[108:111], a[236:239], v[192:195], v[108:111]
  s_waitcnt vmcnt(15)
  v_mfma_f32_16x16x32_bf16 v[96:99], a[240:243], v[196:199], v[96:99]
  buffer_load_dwordx4 v67, s[48:51], s27 offen offset:3072 lds
  v_mfma_f32_16x16x32_bf16 v[100:103], a[244:247], v[196:199], v[100:103]
  v_mfma_f32_16x16x32_bf16 v[104:107], a[248:251], v[196:199], v[104:107]
  v_mfma_f32_16x16x32_bf16 v[108:111], a[252:255], v[196:199], v[108:111]
  s_add_u32 s82, s10, 0x20000
  v_lshlrev_b32 v16, 16, v88
  v_and_b32 v17, 0xffff0000, v88
  s_nop 0
  v_pk_add_f32 v[16:17], v[16:17], v[96:97]
  v_cvt_pk_bf16_f32 v68, v16, v17
  v_lshlrev_b32 v12, 16, v89
  v_and_b32 v13, 0xffff0000, v89
  v_pk_add_f32 v[12:13], v[12:13], v[98:99]
  v_cvt_pk_bf16_f32 v69, v12, v13
  v_lshlrev_b32 v16, 16, v90
  v_and_b32 v17, 0xffff0000, v90
  v_pk_add_f32 v[16:17], v[16:17], v[100:101]
  v_cvt_pk_bf16_f32 v70, v16, v17
  v_lshlrev_b32 v12, 16, v91
  v_and_b32 v13, 0xffff0000, v91
  v_pk_add_f32 v[12:13], v[12:13], v[102:103]
  v_cvt_pk_bf16_f32 v71, v12, v13
  buffer_store_dwordx4 v[68:71], v47, s[60:63], s10 offen sc1
  v_lshlrev_b32 v16, 16, v92
  v_and_b32 v17, 0xffff0000, v92
  v_pk_add_f32 v[16:17], v[16:17], v[104:105]
  v_cvt_pk_bf16_f32 v72, v16, v17
  v_lshlrev_b32 v12, 16, v93
  v_and_b32 v13, 0xffff0000, v93
  v_pk_add_f32 v[12:13], v[12:13], v[106:107]
  v_cvt_pk_bf16_f32 v73, v12, v13
  v_lshlrev_b32 v16, 16, v94
  v_and_b32 v17, 0xffff0000, v94
  v_pk_add_f32 v[16:17], v[16:17], v[108:109]
  v_cvt_pk_bf16_f32 v74, v16, v17
  v_lshlrev_b32 v12, 16, v95
  v_and_b32 v13, 0xffff0000, v95
  v_pk_add_f32 v[12:13], v[12:13], v[110:111]
  v_cvt_pk_bf16_f32 v75, v12, v13
  buffer_store_dwordx4 v[72:75], v47, s[60:63], s82 offen sc1
  v_mov_b32 v12, 0
  v_mov_b32 v16, 0
  v_dot2_f32_bf16 v12, v68, v40, v12
  v_dot2_f32_bf16 v16, v68, v68, v16
  v_dot2_f32_bf16 v12, v69, v40, v12
  v_dot2_f32_bf16 v16, v69, v69, v16
  v_dot2_f32_bf16 v12, v70, v40, v12
  v_dot2_f32_bf16 v16, v70, v70, v16
  v_dot2_f32_bf16 v12, v71, v40, v12
  v_dot2_f32_bf16 v16, v71, v71, v16
  v_dot2_f32_bf16 v12, v72, v40, v12
  v_dot2_f32_bf16 v16, v72, v72, v16
  v_dot2_f32_bf16 v12, v73, v40, v12
  v_dot2_f32_bf16 v16, v73, v73, v16
  v_dot2_f32_bf16 v12, v74, v40, v12
  v_dot2_f32_bf16 v16, v74, v74, v16
  v_dot2_f32_bf16 v12, v75, v40, v12
  v_dot2_f32_bf16 v16, v75, v75, v16
  v_lshlrev_b32 v6, 6, v5
  v_lshl_add_u32 v6, v2, 2, v6
  s_nop 0
  v_permlane32_swap_b32 v12, v16
  v_add_f32 v12, v12, v16
  v_mov_b32 v16, v12
  s_nop 1
  v_permlane16_swap_b32 v12, v16
  v_add_f32 v12, v12, v16
  buffer_store_dword v12, v6, s[60:63], s11 offen
  v_add_u32 v12, s23, v37
  v_add_u32 v13, 0x10000, v12
  s_lshl_b32 s81, s77, 9
  s_mul_i32 s85, s3, 112
  s_add_u32 s81, s81, s85
  s_add_u32 s81, s81, 0x6000
  v_min_u32 v14, 27, v1
  v_lshl_add_u32 v14, v14, 2, s81
  s_waitcnt vmcnt(16)
  v_xor_b32 v6, s80, v55
  v_xor_b32 v7, s80, v59
  v_xor_b32 v8, s80, v63
  v_or3_b32 v6, v6, v7, v8
  v_cmp_ne_u32 vcc, 0, v6
  s_nop 1
  s_cbranch_vccz L_ud_8
  s_mov_b32 s86, 0x100000
L_u_7:
  buffer_load_dwordx4 v[52:55], v15, s[60:63], s24 offen sc1
  buffer_load_dwordx4 v[56:59], v15, s[60:63], s25 offen sc1
  buffer_load_dwordx4 v[60:63], v15, s[60:63], s26 offen sc1
  s_waitcnt vmcnt(0)
  v_xor_b32 v6, s80, v55
  v_xor_b32 v7, s80, v59
  v_xor_b32 v8, s80, v63
  v_or3_b32 v6, v6, v7, v8
  v_cmp_ne_u32 vcc, 0, v6
  s_nop 1
  s_cbranch_vccz L_ud_8
  s_sub_u32 s86, s86, 1
  s_cbranch_scc0 L_u_7
L_ud_8:
  ds_write_b64 v24, v[52:53] offset:0
  ds_write_b64 v24, v[56:57] offset:8
  ds_write_b64 v24, v[60:61] offset:16
  ds_write2_b32 v24, v54, v58 offset0:6 offset1:7
  s_add_u32 s27, s27, 0x38000
  s_add_u32 m0, s23, 0x1000
  s_nop 0
  buffer_load_dwordx4 v64, s[48:51], s27 offen lds
  buffer_load_dwordx4 v65, s[48:51], s27 offen offset:1024 lds
  s_waitcnt lgkmcnt(0)
  s_barrier
  s_lshl_b32 s81, s89, 8
  v_xor_b32 v6, s81, v38
  s_lshl_b32 s81, s90, 10
  v_add_u32 v15, s81, v6
  v_xor_b32 v16, 0x400, v15
  s_and_b32 s81, s76, 1
  s_mul_i32 s81, s81, 28672
  s_mul_i32 s82, s77, 229376
  s_mul_i32 s85, s3, 57344
  s_add_u32 s82, s82, s85
  s_add_u32 s82, s82, 0x1200000
  s_add_u32 s4, s82, s81
  s_sub_u32 s9, s82, s81
  s_add_u32 s9, s9, 28672
  ds_read_b64 a[180:181], v18 offset:768
  ds_read_b64 a[182:183], v19 offset:768
  ds_read_b128 a[144:147], v11 offset:4096
  ds_read_b64 a[184:185], v18 offset:1536
  ds_read_b64 a[186:187], v19 offset:1536
  ds_read_b128 a[148:151], v11 offset:3584
  ds_read_b64 a[188:189], v18 offset:2304
  ds_read_b64 a[190:191], v19 offset:2304
  ds_read_b128 a[152:155], v11 offset:3072
  ds_read_b64 a[192:193], v18 offset:3072
  ds_read_b64 a[194:195], v19 offset:3072
  ds_read_b128 a[156:159], v11 offset:2560
  ds_read_b64 a[196:197], v18 offset:3840
  ds_read_b64 a[198:199], v19 offset:3840
  ds_read_b128 a[160:163], v11 offset:2048
  ds_read_b64 a[200:201], v18 offset:4608
  ds_read_b64 a[202:203], v19 offset:4608
  ds_read_b128 a[164:167], v11 offset:1536
  ds_read_b64 a[204:205], v18 offset:5376
  ds_read_b64 a[206:207], v19 offset:5376
  ds_read_b128 a[168:171], v11 offset:1024
  ds_read_b64 a[208:209], v18 offset:6144
  ds_read_b64 a[210:211], v19 offset:6144
  ds_read_b128 a[172:175], v11 offset:512
  s_waitcnt lgkmcnt(15)
  v_mfma_f32_16x16x32_bf16 a[224:227], a[144:147], a[180:183], 0
  buffer_load_dwordx4 v66, s[48:51], s27 offen offset:2048 lds
  v_mfma_f32_16x16x32_bf16 a[228:231], a[144:147], a[184:187], 0
  v_mfma_f32_16x16x32_bf16 a[228:231], a[148:151], a[180:183], a[228:231]
  v_mfma_f32_16x16x32_bf16 a[232:235], a[148:151], a[184:187], 0
  v_mfma_f32_16x16x32_bf16 a[232:235], a[144:147], a[188:191], a[232:235]
  s_waitcnt vmcnt(16)
  ds_read_b64_tr_b16 v[128:129], v13 offset:0
  ds_read_b64_tr_b16 v[130:131], v13 offset:1024
  buffer_load_dwordx4 v67, s[48:51], s27 offen offset:3072 lds
  v_mfma_f32_16x16x32_bf16 a[236:239], a[148:151], a[188:191], 0
  ds_read_b64_tr_b16 v[132:133], v13 offset:512
  ds_read_b64_tr_b16 v[134:135], v13 offset:1536
  v_mfma_f32_16x16x32_bf16 a[232:235], a[152:155], a[180:183], a[232:235]
  ds_read_b64 v[68:69], v18 offset:672
  ds_read_b64 v[70:71], v19 offset:672
  s_waitcnt vmcnt(15)
  ds_read_b64_tr_b16 v[136:137], v13 offset:2048
  ds_read_b64_tr_b16 v[138:139], v13 offset:3072
  v_mfma_f32_16x16x32_bf16 a[236:239], a[152:155], a[184:187], a[236:239]
  ds_read_b128 v[20:23], v11 offset:4032
  ds_read_b64_tr_b16 v[140:141], v13 offset:2560
  ds_read_b64_tr_b16 v[142:143], v13 offset:3584
  v_mfma_f32_16x16x32_bf16 a[240:243], a[152:155], a[188:191], 0
  ds_read_b64 v[72:73], v18 offset:1440
  ds_read_b64 v[74:75], v19 offset:1440
  s_waitcnt vmcnt(13)
  ds_read_b64_tr_b16 v[144:145], v13 offset:4096
  ds_read_b64_tr_b16 v[146:147], v13 offset:5120
  s_add_u32 s27, s22, 2
  s_and_b32 s27, s27, 3
  s_mul_i32 s27, s27, 458752
  s_add_u32 m0, s23, 0x8000
  s_nop 0
  buffer_load_dwordx4 v64, s[48:51], s27 offen lds
  s_waitcnt vmcnt(5)
  s_mov_b64 exec, 1
  buffer_store_dword v10, v9, s[60:63], s5 offen
  s_mov_b64 exec, -1
  s_waitcnt lgkmcnt(15)
  v_mfma_f32_16x16x32_bf16 a[236:239], a[144:147], a[192:195], a[236:239]
  ds_read_b128 v[28:31], v11 offset:3520
  ds_read_b64_tr_b16 v[148:149], v13 offset:4608
  ds_read_b64_tr_b16 v[150:151], v13 offset:5632
  v_mfma_f32_16x16x32_bf16 a[240:243], a[148:151], a[192:195], a[240:243]
  ds_read_b64 v[76:77], v18 offset:2208
  ds_read_b64 v[78:79], v19 offset:2208
  ds_read_b64_tr_b16 v[152:153], v13 offset:6144
  ds_read_b64_tr_b16 v[154:155], v13 offset:7168
  v_mfma_f32_16x16x32_bf16 a[244:247], a[152:155], a[192:195], 0
  ds_read_b128 v[32:35], v11 offset:3008
  ds_read_b64_tr_b16 v[156:157], v13 offset:6656
  ds_read_b64_tr_b16 v[158:159], v13 offset:7680
  v_mfma_f32_16x16x32_bf16 a[236:239], a[156:159], a[180:183], a[236:239]
  ds_read_b64 v[88:89], v18 offset:2976
  ds_read_b64 v[90:91], v19 offset:2976
  buffer_load_dwordx4 v65, s[48:51], s27 offen offset:1024 lds
  v_mfma_f32_16x16x32_bf16 a[240:243], a[156:159], a[184:187], a[240:243]
  ds_read_b128 v[44:47], v11 offset:2496
  v_mfma_f32_16x16x32_bf16 a[244:247], a[156:159], a[188:191], a[244:247]
  ds_read_b64 v[92:93], v18 offset:3744
  ds_read_b64 v[94:95], v19 offset:3744
  v_mfma_f32_16x16x32_bf16 a[248:251], a[156:159], a[192:195], 0
  ds_read_b128 v[48:51], v11 offset:1984
  v_mfma_f32_16x16x32_bf16 a[240:243], a[144:147], a[196:199], a[240:243]
  ds_read_b64 v[96:97], v18 offset:4512
  ds_read_b64 v[98:99], v19 offset:4512
  buffer_load_dwordx4 v66, s[48:51], s27 offen offset:2048 lds
  v_mfma_f32_16x16x32_bf16 a[244:247], a[148:151], a[196:199], a[244:247]
  ds_read_b128 v[52:55], v11 offset:1472
  v_mfma_f32_16x16x32_bf16 a[248:251], a[152:155], a[196:199], a[248:251]
  ds_read_b64 v[100:101], v18 offset:5280
  ds_read_b64 v[102:103], v19 offset:5280
  v_mfma_f32_16x16x32_bf16 a[252:255], a[156:159], a[196:199], 0
  ds_read_b128 v[56:59], v11 offset:960
  v_mfma_f32_16x16x32_bf16 a[240:243], a[160:163], a[180:183], a[240:243]
  ds_read_b64 v[104:105], v18 offset:6048
  ds_read_b64 v[106:107], v19 offset:6048
  buffer_load_dwordx4 v67, s[48:51], s27 offen offset:3072 lds
  v_mfma_f32_16x16x32_bf16 a[244:247], a[160:163], a[184:187], a[244:247]
  ds_read_b128 v[60:63], v11 offset:448
  v_mfma_f32_16x16x32_bf16 a[248:251], a[160:163], a[188:191], a[248:251]
  v_mfma_f32_16x16x32_bf16 a[252:255], a[160:163], a[192:195], a[252:255]
  v_mfma_f32_16x16x32_bf16 a[244:247], a[144:147], a[200:203], a[244:247]
  s_add_u32 s27, s27, 0x38000
  s_add_u32 m0, s23, 0x9000
  s_nop 0
  buffer_load_dwordx4 v64, s[48:51], s27 offen lds
  v_mfma_f32_16x16x32_bf16 a[248:251], a[148:151], a[200:203], a[248:251]
  v_mfma_f32_16x16x32_bf16 a[252:255], a[152:155], a[200:203], a[252:255]
  v_mfma_f32_16x16x32_bf16 a[244:247], a[164:167], a[180:183], a[244:247]
  v_mfma_f32_16x16x32_bf16 a[248:251], a[164:167], a[184:187], a[248:251]
  buffer_load_dwordx4 v65, s[48:51], s27 offen offset:1024 lds
  v_mfma_f32_16x16x32_bf16 a[252:255], a[164:167], a[188:191], a[252:255]
  v_mfma_f32_16x16x32_bf16 a[248:251], a[144:147], a[204:207], a[248:251]
  v_mfma_f32_16x16x32_bf16 a[252:255], a[148:151], a[204:207], a[252:255]
  v_mfma_f32_16x16x32_bf16 a[248:251], a[168:171], a[180:183], a[248:251]
  buffer_load_dwordx4 v66, s[48:51], s27 offen offset:2048 lds
  v_mfma_f32_16x16x32_bf16 a[252:255], a[168:171], a[184:187], a[252:255]
  v_mfma_f32_16x16x32_bf16 a[252:255], a[144:147], a[208:211], a[252:255]
  v_mfma_f32_16x16x32_bf16 a[252:255], a[172:175], a[180:183], a[252:255]
  s_waitcnt lgkmcnt(0)
  s_cmp_lg_u32 s90, 0
  s_cbranch_scc1 L_cx_9
  ds_read_b128 a[176:179], v11 offset:0
  ds_read_b64 a[212:213], v18 offset:0
  ds_read_b64 a[214:215], v19 offset:0
  s_waitcnt lgkmcnt(0)
  v_mfma_f32_16x16x32_bf16 a[224:227], a[148:151], a[212:215], a[224:227]
  v_mfma_f32_16x16x32_bf16 a[228:231], a[152:155], a[212:215], a[228:231]
  v_mfma_f32_16x16x32_bf16 a[232:235], a[156:159], a[212:215], a[232:235]
  v_mfma_f32_16x16x32_bf16 a[236:239], a[160:163], a[212:215], a[236:239]
  v_mfma_f32_16x16x32_bf16 a[240:243], a[164:167], a[212:215], a[240:243]
  v_mfma_f32_16x16x32_bf16 a[244:247], a[168:171], a[212:215], a[244:247]
  v_mfma_f32_16x16x32_bf16 a[248:251], a[172:175], a[212:215], a[248:251]
  v_mfma_f32_16x16x32_bf16 a[252:255], a[176:179], a[212:215], a[252:255]
L_cx_9:
  s_lshl_b32 s81, s14, 1
  s_add_u32 s81, s81, 0x3000
  v_lshl_add_u32 v17, v1, 2, s81
  v_mfma_f32_16x16x32_bf16 a[224:227], v[20:23], v[68:71], a[224:227]
  buffer_load_dwordx4 v67, s[48:51], s27 offen offset:3072 lds
  v_mfma_f32_16x16x32_bf16 a[228:231], v[20:23], v[72:75], a[228:231]
  v_mfma_f32_16x16x32_bf16 a[228:231], v[28:31], v[68:71], a[228:231]
  ds_read_b64 a[180:181], v18 offset:576
  ds_read_b64 a[182:183], v19 offset:576
  v_mfma_f32_16x16x32_bf16 a[232:235], v[28:31], v[72:75], a[232:235]
  ds_read_b128 a[144:147], v11 offset:3968
  v_mfma_f32_16x16x32_bf16 a[232:235], v[20:23], v[76:79], a[232:235]
  ds_read_b64 a[184:185], v18 offset:1344
  ds_read_b64 a[186:187], v19 offset:1344
  v_mfma_f32_16x16x32_bf16 a[236:239], v[28:31], v[76:79], a[236:239]
  ds_read_b128 a[148:151], v11 offset:3456
  v_mfma_f32_16x16x32_bf16 a[232:235], v[32:35], v[68:71], a[232:235]
  ds_read_b64 a[188:189], v18 offset:2112
  ds_read_b64 a[190:191], v19 offset:2112
  v_mfma_f32_16x16x32_bf16 a[236:239], v[32:35], v[72:75], a[236:239]
  ds_read_b128 a[152:155], v11 offset:2944
  v_mfma_f32_16x16x32_bf16 a[240:243], v[32:35], v[76:79], a[240:243]
  ds_read_b64 a[192:193], v18 offset:2880
  ds_read_b64 a[194:195], v19 offset:2880
  s_add_u32 s27, s22, 3
  s_and_b32 s27, s27, 3
  s_mul_i32 s27, s27, 458752
  s_add_u32 m0, s23, 0x10000
  s_nop 0
  buffer_load_dwordx4 v64, s[48:51], s27 offen lds
  v_mfma_f32_16x16x32_bf16 a[236:239], v[20:23], v[88:91], a[236:239]
  ds_read_b128 a[156:159], v11 offset:2432
  v_mfma_f32_16x16x32_bf16 a[240:243], v[28:31], v[88:91], a[240:243]
  ds_read_b64 a[196:197], v18 offset:3648
  ds_read_b64 a[198:199], v19 offset:3648
  ds_read_b64_tr_b16 v[160:161], v12 offset:0
  ds_read_b64_tr_b16 v[162:163], v12 offset:1024
  v_mfma_f32_16x16x32_bf16 a[244:247], v[32:35], v[88:91], a[244:247]
  ds_read_b128 a[160:163], v11 offset:1920
  ds_read_b64_tr_b16 v[164:165], v12 offset:512
  ds_read_b64_tr_b16 v[166:167], v12 offset:1536
  v_mfma_f32_16x16x32_bf16 a[236:239], v[44:47], v[68:71], a[236:239]
  ds_read_b64 a[200:201], v18 offset:4416
  ds_read_b64 a[202:203], v19 offset:4416
  buffer_load_dwordx4 v65, s[48:51], s27 offen offset:1024 lds
  ds_read_b64_tr_b16 v[168:169], v12 offset:2048
  ds_read_b64_tr_b16 v[170:171], v12 offset:3072
  v_mfma_f32_16x16x32_bf16 a[240:243], v[44:47], v[72:75], a[240:243]
  ds_read_b128 a[164:167], v11 offset:1408
  ds_read_b64_tr_b16 v[172:173], v12 offset:2560
  ds_read_b64_tr_b16 v[174:175], v12 offset:3584
  v_mfma_f32_16x16x32_bf16 a[244:247], v[44:47], v[76:79], a[244:247]
  ds_read_b64 a[204:205], v18 offset:5184
  ds_read_b64 a[206:207], v19 offset:5184
  s_waitcnt vmcnt(13)
  ds_read_b64_tr_b16 v[176:177], v12 offset:4096
  ds_read_b64_tr_b16 v[178:179], v12 offset:5120
  v_mfma_f32_16x16x32_bf16 a[248:251], v[44:47], v[88:91], a[248:251]
  ds_read_b128 a[168:171], v11 offset:896
  ds_read_b64_tr_b16 v[180:181], v12 offset:4608
  ds_read_b64_tr_b16 v[182:183], v12 offset:5632
  v_mfma_f32_16x16x32_bf16 a[240:243], v[20:23], v[92:95], a[240:243]
  ds_read_b64 a[208:209], v18 offset:5952
  ds_read_b64 a[210:211], v19 offset:5952
  buffer_load_dwordx4 v66, s[48:51], s27 offen offset:2048 lds
  s_waitcnt vmcnt(12)
  ds_read_b64_tr_b16 v[184:185], v12 offset:6144
  ds_read_b64_tr_b16 v[186:187], v12 offset:7168
  v_mfma_f32_16x16x32_bf16 a[244:247], v[28:31], v[92:95], a[244:247]
  ds_read_b128 a[172:175], v11 offset:384
  ds_read_b64_tr_b16 v[188:189], v12 offset:6656
  ds_read_b64_tr_b16 v[190:191], v12 offset:7680
  v_mfma_f32_16x16x32_bf16 a[248:251], v[32:35], v[92:95], a[248:251]
  v_mfma_f32_16x16x32_bf16 a[252:255], v[44:47], v[92:95], a[252:255]
  v_mfma_f32_16x16x32_bf16 a[240:243], v[48:51], v[68:71], a[240:243]
  buffer_load_dwordx4 v67, s[48:51], s27 offen offset:3072 lds
  v_mfma_f32_16x16x32_bf16 a[244:247], v[48:51], v[72:75], a[244:247]
  v_mfma_f32_16x16x32_bf16 a[248:251], v[48:51], v[76:79], a[248:251]
  v_mfma_f32_16x16x32_bf16 a[252:255], v[48:51], v[88:91], a[252:255]
  v_mfma_f32_16x16x32_bf16 a[244:247], v[20:23], v[96:99], a[244:247]
  s_add_u32 s27, s27, 0x38000
  s_add_u32 m0, s23, 0x11000
  s_nop 0
  buffer_load_dwordx4 v64, s[48:51], s27 offen lds
  v_mfma_f32_16x16x32_bf16 a[248:251], v[28:31], v[96:99], a[248:251]
  v_mfma_f32_16x16x32_bf16 a[252:255], v[32:35], v[96:99], a[252:255]
  v_mfma_f32_16x16x32_bf16 a[244:247], v[52:55], v[68:71], a[244:247]
  v_mfma_f32_16x16x32_bf16 a[248:251], v[52:55], v[72:75], a[248:251]
  buffer_load_dwordx4 v65, s[48:51], s27 offen offset:1024 lds
  v_mfma_f32_16x16x32_bf16 a[252:255], v[52:55], v[76:79], a[252:255]
  v_mfma_f32_16x16x32_bf16 a[248:251], v[20:23], v[100:103], a[248:251]
  buffer_load_dword v24, v17, s[60:63], 0 offen sc1
  v_mfma_f32_16x16x32_bf16 a[252:255], v[28:31], v[100:103], a[252:255]
  buffer_load_dword v25, v14, s[60:63], 0 offen sc1
  v_mfma_f32_16x16x32_bf16 a[248:251], v[56:59], v[68:71], a[248:251]
  buffer_load_dwordx4 v66, s[48:51], s27 offen offset:2048 lds
  v_mfma_f32_16x16x32_bf16 a[252:255], v[56:59], v[72:75], a[252:255]
  v_mfma_f32_16x16x32_bf16 a[252:255], v[20:23], v[104:107], a[252:255]
  v_mfma_f32_16x16x32_bf16 a[252:255], v[60:63], v[68:71], a[252:255]
  buffer_load_dwordx4 v67, s[48:51], s27 offen offset:3072 lds
  s_waitcnt lgkmcnt(15)
  v_mfma_f32_16x16x32_bf16 a[224:227], a[144:147], a[180:183], a[224:227]
  ds_read_b64 v[68:69], v18 offset:480
  ds_read_b64 v[70:71], v19 offset:480
  v_and_b32 v6, 1, v3
  v_mfma_f32_16x16x32_bf16 a[228:231], a[144:147], a[184:187], a[228:231]
  ds_read_b128 v[20:23], v11 offset:3904
  v_lshlrev_b32 v6, 10, v6
  v_mfma_f32_16x16x32_bf16 a[228:231], a[148:151], a[180:183], a[228:231]
  ds_read_b64 v[72:73], v18 offset:1248
  ds_read_b64 v[74:75], v19 offset:1248
  v_lshl_add_u32 v6, v5, 6, v6
  s_waitcnt vmcnt(16)
  ds_read_b64_tr_b16 v[192:193], v12 offset:32768
  ds_read_b64_tr_b16 v[194:195], v12 offset:33792
  v_mfma_f32_16x16x32_bf16 a[232:235], a[148:151], a[184:187], a[232:235]
  ds_read_b128 v[28:31], v11 offset:3392
  v_lshl_add_u32 v6, v2, 2, v6
  ds_read_b64_tr_b16 v[196:197], v12 offset:33280
  ds_read_b64_tr_b16 v[198:199], v12 offset:34304
  v_mfma_f32_16x16x32_bf16 a[232:235], a[144:147], a[188:191], a[232:235]
  ds_read_b64 v[76:77], v18 offset:2016
  ds_read_b64 v[78:79], v19 offset:2016
  s_mul_i32 s82, s16, 3
  s_waitcnt vmcnt(14)
  ds_read_b64_tr_b16 v[200:201], v12 offset:34816
  ds_read_b64_tr_b16 v[202:203], v12 offset:35840
  v_mfma_f32_16x16x32_bf16 a[236:239], a[148:151], a[188:191], a[236:239]
  ds_read_b128 v[32:35], v11 offset:2880
  s_xor_b32 s81, s82, s3
  ds_read_b64_tr_b16 v[204:205], v12 offset:35328
  ds_read_b64_tr_b16 v[206:207], v12 offset:36352
  v_mfma_f32_16x16x32_bf16 a[232:235], a[152:155], a[180:183], a[232:235]
  ds_read_b64 v[88:89], v18 offset:2784
  ds_read_b64 v[90:91], v19 offset:2784
  s_lshl_b32 s83, s14, 6
  s_waitcnt vmcnt(12)
  ds_read_b64_tr_b16 v[208:209], v12 offset:36864
  ds_read_b64_tr_b16 v[210:211], v12 offset:37888
  v_mfma_f32_16x16x32_bf16 a[236:239], a[152:155], a[184:187], a[236:239]
  ds_read_b128 v[44:47], v11 offset:2368
  s_lshl_b32 s85, s81, 11
  ds_read_b64_tr_b16 v[212:213], v12 offset:37376
  ds_read_b64_tr_b16 v[214:215], v12 offset:38400
  v_mfma_f32_16x16x32_bf16 a[240:243], a[152:155], a[188:191], a[240:243]
  ds_read_b64 v[92:93], v18 offset:3552
  ds_read_b64 v[94:95], v19 offset:3552
  s_add_u32 s83, s83, s85
  s_waitcnt vmcnt(10)
  ds_read_b64_tr_b16 v[216:217], v12 offset:38912
  ds_read_b64_tr_b16 v[218:219], v12 offset:39936
  v_mfma_f32_16x16x32_bf16 a[236:239], a[144:147], a[192:195], a[236:239]
  ds_read_b128 v[48:51], v11 offset:1856
  s_add_u32 s83, s83, 0x500000
  ds_read_b64_tr_b16 v[220:221], v12 offset:39424
  ds_read_b64_tr_b16 v[222:223], v12 offset:40448
  v_mfma_f32_16x16x32_bf16 a[240:243], a[148:151], a[192:195], a[240:243]
  ds_read_b64 v[96:97], v18 offset:4320
  ds_read_b64 v[98:99], v19 offset:4320
  v_add_u32 v26, s83, v6
  v_mfma_f32_16x16x32_bf16 a[244:247], a[152:155], a[192:195], a[244:247]
  ds_read_b128 v[52:55], v11 offset:1344
  v_lshlrev_b32 v6, 11, v5
  v_mfma_f32_16x16x32_bf16 a[236:239], a[156:159], a[180:183], a[236:239]
  ds_read_b64 v[100:101], v18 offset:5088
  ds_read_b64 v[102:103], v19 offset:5088
  v_add3_u32 v6, v6, v4, s14
  v_mfma_f32_16x16x32_bf16 a[240:243], a[156:159], a[184:187], a[240:243]
  ds_read_b128 v[56:59], v11 offset:832
  v_lshlrev_b32 v64, 4, v6
  ds_read_b64 v[104:105], v18 offset:5856
  ds_read_b64 v[106:107], v19 offset:5856
  ds_read_b128 v[60:63], v11 offset:320
  v_add_u32 v65, 0xfc00, v64
  v_add_u32 v66, 0x1f800, v64
  v_add_u32 v67, 0x2f400, v64
  s_add_u32 s81, s3, s22
  s_and_b32 s81, s81, 3
  s_lshl_b32 s8, s81, 19
  s_lshl_b32 s85, s82, 9
  s_add_u32 s8, s8, s85
  s_add_u32 s8, s8, 0x300000
  s_lshl_b32 s81, s16, 10
  s_sub_u32 s12, 0x200, s81
  s_waitcnt vmcnt(2)
  v_cmp_ne_u32 vcc, s80, v25
  s_cbranch_vccz L_pd_11
  s_mov_b32 s86, 0x100000
L_poll_10:
  buffer_load_dword v25, v14, s[60:63], 0 offen sc1
  s_waitcnt vmcnt(0)
  v_cmp_ne_u32 vcc, s80, v25
  s_cbranch_vccz L_pd_11
  s_sub_u32 s86, s86, 1
  s_cbranch_scc0 L_poll_10
L_pd_11:
  v_cmp_ne_u32 vcc, s80, v24
  s_cbranch_vccz L_pd_13
  s_mov_b32 s86, 0x100000
L_poll_12:
  buffer_load_dword v24, v17, s[60:63], 0 offen sc1
  s_waitcnt vmcnt(0)
  v_cmp_ne_u32 vcc, s80, v24
  s_cbranch_vccz L_pd_13
  s_sub_u32 s86, s86, 1
  s_cbranch_scc0 L_poll_12
L_pd_13:
  s_waitcnt lgkmcnt(9)
  s_barrier
  v_xor_b32 v6, v3, v2
  v_and_b32 v6, 1, v6
  v_cmp_eq_u32 vcc, 0, v6
  s_nop 1
  v_cndmask_b32 v108, 0, v40, vcc
  v_cndmask_b32 v109, 0, v40, vcc
  v_cndmask_b32 v110, 0, v40, vcc
  v_cndmask_b32 v111, 0, v40, vcc
  s_add_u32 s88, s8, 0x0
  s_add_u32 m0, s23, 0x0
  s_nop 0
  buffer_load_dwordx4 v64, s[60:63], s88 offen sc1 lds
  buffer_load_dwordx4 v65, s[60:63], s88 offen offset:1024 sc1 lds
  buffer_load_dwordx4 v66, s[60:63], s88 offen offset:2048 sc1 lds
  v_mfma_f32_16x16x32_bf16 a[244:247], a[156:159], a[188:191], a[244:247]
  buffer_load_dwordx4 v67, s[60:63], s88 offen offset:3072 sc1 lds
  v_mfma_f32_16x16x32_bf16 a[248:251], a[156:159], a[192:195], a[248:251]
  v_mfma_f32_16x16x32_bf16 a[240:243], a[144:147], a[196:199], a[240:243]
  v_mfma_f32_16x16x32_bf16 a[244:247], a[148:151], a[196:199], a[244:247]
  s_add_u32 s88, s8, 0x40000
  s_add_u32 m0, s23, 0x1000
  s_nop 0
  buffer_load_dwordx4 v64, s[60:63], s88 offen sc1 lds
  v_mfma_f32_16x16x32_bf16 a[248:251], a[152:155], a[196:199], a[248:251]
  v_mfma_f32_16x16x32_bf16 a[252:255], a[156:159], a[196:199], a[252:255]
  v_mfma_f32_16x16x32_bf16 a[240:243], a[160:163], a[180:183], a[240:243]
  buffer_load_dwordx4 v65, s[60:63], s88 offen offset:1024 sc1 lds
  v_mfma_f32_16x16x32_bf16 a[244:247], a[160:163], a[184:187], a[244:247]
  v_mfma_f32_16x16x32_bf16 a[248:251], a[160:163], a[188:191], a[248:251]
  v_mfma_f32_16x16x32_bf16 a[252:255], a[160:163], a[192:195], a[252:255]
  buffer_load_dwordx4 v66, s[60:63], s88 offen offset:2048 sc1 lds
  v_mfma_f32_16x16x32_bf16 a[244:247], a[144:147], a[200:203], a[244:247]
  v_mfma_f32_16x16x32_bf16 a[248:251], a[148:151], a[200:203], a[248:251]
  v_mfma_f32_16x16x32_bf16 a[252:255], a[152:155], a[200:203], a[252:255]
  buffer_load_dwordx4 v67, s[60:63], s88 offen offset:3072 sc1 lds
  v_mfma_f32_16x16x32_bf16 a[244:247], a[164:167], a[180:183], a[244:247]
  v_mfma_f32_16x16x32_bf16 a[248:251], a[164:167], a[184:187], a[248:251]
  v_mfma_f32_16x16x32_bf16 a[252:255], a[164:167], a[188:191], a[252:255]
  buffer_load_dword v80, v26, s[60:63], 0 offen offset:0 sc1
  v_mfma_f32_16x16x32_bf16 a[248:251], a[144:147], a[204:207], a[248:251]
  v_mfma_f32_16x16x32_bf16 a[252:255], a[148:151], a[204:207], a[252:255]
  v_mfma_f32_16x16x32_bf16 a[248:251], a[168:171], a[180:183], a[248:251]
  buffer_load_dword v81, v26, s[60:63], 0 offen offset:128 sc1
  v_mfma_f32_16x16x32_bf16 a[252:255], a[168:171], a[184:187], a[252:255]
  v_mfma_f32_16x16x32_bf16 a[252:255], a[144:147], a[208:211], a[252:255]
  ds_read_b64_tr_b16 v[224:225], v13 offset:0
  ds_read_b64_tr_b16 v[226:227], v13 offset:1024
  v_mfma_f32_16x16x32_bf16 a[252:255], a[172:175], a[180:183], a[252:255]
  buffer_load_dword v82, v26, s[60:63], 0 offen offset:256 sc1
  v_mfma_f32_16x16x32_bf16 a[224:227], v[20:23], v[68:71], a[224:227]
  ds_read_b64_tr_b16 v[228:229], v13 offset:512
  ds_read_b64_tr_b16 v[230:231], v13 offset:1536
  v_mfma_f32_16x16x32_bf16 a[228:231], v[20:23], v[72:75], a[228:231]
  v_mfma_f32_16x16x32_bf16 a[228:231], v[28:31], v[68:71], a[228:231]
  buffer_load_dword v83, v26, s[60:63], 0 offen offset:384 sc1
  ds_read_b64_tr_b16 v[232:233], v13 offset:2048
  ds_read_b64_tr_b16 v[234:235], v13 offset:3072
  v_mfma_f32_16x16x32_bf16 a[232:235], v[28:31], v[72:75], a[232:235]
  v_mfma_f32_16x16x32_bf16 a[232:235], v[20:23], v[76:79], a[232:235]
  ds_read_b64_tr_b16 v[236:237], v13 offset:2560
  ds_read_b64_tr_b16 v[238:239], v13 offset:3584
  v_mfma_f32_16x16x32_bf16 a[236:239], v[28:31], v[76:79], a[236:239]
  buffer_load_dword v84, v26, s[60:63], 0 offen offset:512 sc1
  v_mfma_f32_16x16x32_bf16 a[232:235], v[32:35], v[68:71], a[232:235]
  ds_read_b64_tr_b16 v[240:241], v13 offset:4096
  ds_read_b64_tr_b16 v[242:243], v13 offset:5120
  v_mfma_f32_16x16x32_bf16 a[236:239], v[32:35], v[72:75], a[236:239]
  v_mfma_f32_16x16x32_bf16 a[240:243], v[32:35], v[76:79], a[240:243]
  buffer_load_dword v85, v26, s[60:63], 0 offen offset:640 sc1
  ds_read_b64_tr_b16 v[244:245], v13 offset:4608
  ds_read_b64_tr_b16 v[246:247], v13 offset:5632
  v_mfma_f32_16x16x32_bf16 a[236:239], v[20:23], v[88:91], a[236:239]
  v_mfma_f32_16x16x32_bf16 a[240:243], v[28:31], v[88:91], a[240:243]
  s_waitcnt vmcnt(14)
  ds_read_b64_tr_b16 v[248:249], v13 offset:6144
  ds_read_b64_tr_b16 v[250:251], v13 offset:7168
  v_mfma_f32_16x16x32_bf16 a[244:247], v[32:35], v[88:91], a[244:247]
  buffer_load_dword v86, v26, s[60:63], 0 offen offset:768 sc1
  v_mfma_f32_16x16x32_bf16 a[236:239], v[44:47], v[68:71], a[236:239]
  ds_read_b64_tr_b16 v[252:253], v13 offset:6656
  ds_read_b64_tr_b16 v[254:255], v13 offset:7680
  v_mfma_f32_16x16x32_bf16 a[240:243], v[44:47], v[72:75], a[240:243]
  v_mfma_f32_16x16x32_bf16 a[244:247], v[44:47], v[76:79], a[244:247]
  buffer_load_dword v87, v26, s[60:63], 0 offen offset:896 sc1
  v_mfma_f32_16x16x32_bf16 a[248:251], v[44:47], v[88:91], a[248:251]
  v_mfma_f32_16x16x32_bf16 a[240:243], v[20:23], v[92:95], a[240:243]
  v_mfma_f32_16x16x32_bf16 a[244:247], v[28:31], v[92:95], a[244:247]
  s_add_u32 s8, s8, s12
  s_add_u32 s88, s8, 0x0
  s_add_u32 m0, s23, 0x8000
  s_nop 0
  buffer_load_dwordx4 v64, s[60:63], s88 offen sc1 lds
  v_mfma_f32_16x16x32_bf16 a[248:251], v[32:35], v[92:95], a[248:251]
  v_mfma_f32_16x16x32_bf16 a[252:255], v[44:47], v[92:95], a[252:255]
  v_mfma_f32_16x16x32_bf16 a[240:243], v[48:51], v[68:71], a[240:243]
  buffer_load_dwordx4 v65, s[60:63], s88 offen offset:1024 sc1 lds
  v_mfma_f32_16x16x32_bf16 a[244:247], v[48:51], v[72:75], a[244:247]
  v_mfma_f32_16x16x32_bf16 a[248:251], v[48:51], v[76:79], a[248:251]
  v_mfma_f32_16x16x32_bf16 a[252:255], v[48:51], v[88:91], a[252:255]
  buffer_load_dwordx4 v66, s[60:63], s88 offen offset:2048 sc1 lds
  s_waitcnt lgkmcnt(15)
  v_mfma_f32_16x16x32_bf16 a[244:247], v[20:23], v[96:99], a[244:247]
  v_mfma_f32_16x16x32_bf16 a[248:251], v[28:31], v[96:99], a[248:251]
  v_mfma_f32_16x16x32_bf16 a[252:255], v[32:35], v[96:99], a[252:255]
  buffer_load_dwordx4 v67, s[60:63], s88 offen offset:3072 sc1 lds
  v_mfma_f32_16x16x32_bf16 a[244:247], v[52:55], v[68:71], a[244:247]
  v_mfma_f32_16x16x32_bf16 a[248:251], v[52:55], v[72:75], a[248:251]
  v_mfma_f32_16x16x32_bf16 a[252:255], v[52:55], v[76:79], a[252:255]
  s_add_u32 s88, s8, 0x40000
  s_add_u32 m0, s23, 0x9000
  s_nop 0
  buffer_load_dwordx4 v64, s[60:63], s88 offen sc1 lds
  v_mfma_f32_16x16x32_bf16 a[248:251], v[20:23], v[100:103], a[248:251]
  v_mfma_f32_16x16x32_bf16 a[252:255], v[28:31], v[100:103], a[252:255]
  v_mfma_f32_16x16x32_bf16 a[248:251], v[56:59], v[68:71], a[248:251]
  v_mfma_f32_16x16x32_bf16 a[252:255], v[56:59], v[72:75], a[252:255]
  v_mfma_f32_16x16x32_bf16 a[252:255], v[20:23], v[104:107], a[252:255]
  v_mfma_f32_16x16x32_bf16 a[252:255], v[60:63], v[68:71], a[252:255]
  s_add_u32 s81, s23, 0x10000
  v_add_u32 v7, s81, v38
  v_mfma_f32_16x16x32_bf16 v[112:115], v[108:111], v[128:131], 0
  buffer_load_dwordx4 v65, s[60:63], s88 offen offset:1024 sc1 lds
  v_mfma_f32_16x16x32_bf16 v[112:115], v[108:111], v[132:135], v[112:115]
  s_waitcnt lgkmcnt(0)
  v_mfma_f32_16x16x32_bf16 v[112:115], v[108:111], v[136:139], v[112:115]
  ds_write_b128 v7, a[224:227] offset:0
  v_mfma_f32_16x16x32_bf16 v[112:115], v[108:111], v[140:143], v[112:115]
  ds_write_b128 v7, a[228:231] offset:1024
  v_mfma_f32_16x16x32_bf16 v[112:115], v[108:111], v[144:147], v[112:115]
  ds_write_b128 v7, a[232:235] offset:2048
  buffer_load_dwordx4 v66, s[60:63], s88 offen offset:2048 sc1 lds
  v_mfma_f32_16x16x32_bf16 v[112:115], v[108:111], v[148:151], v[112:115]
  ds_write_b128 v7, a[236:239] offset:3072
  v_mfma_f32_16x16x32_bf16 v[112:115], v[108:111], v[152:155], v[112:115]
  ds_write_b128 v7, a[240:243] offset:4096
  v_mfma_f32_16x16x32_bf16 v[112:115], v[108:111], v[156:159], v[112:115]
  ds_write_b128 v7, a[244:247] offset:5120
  v_mfma_f32_16x16x32_bf16 v[112:115], v[108:111], v[160:163], v[112:115]
  ds_write_b128 v7, a[248:251] offset:6144
  buffer_load_dwordx4 v67, s[60:63], s88 offen offset:3072 sc1 lds
  v_mfma_f32_16x16x32_bf16 v[112:115], v[108:111], v[164:167], v[112:115]
  ds_write_b128 v7, a[252:255] offset:7168
  v_mfma_f32_16x16x32_bf16 v[112:115], v[108:111], v[168:171], v[112:115]
  s_waitcnt vmcnt(8)
  v_mfma_f32_16x16x32_bf16 v[112:115], v[108:111], v[172:175], v[112:115]
  v_add_f32 v80, v80, v84
  v_mfma_f32_16x16x32_bf16 v[112:115], v[108:111], v[176:179], v[112:115]
  v_add_f32 v81, v81, v85
  buffer_load_dwordx4 a[0:3], v15, s[60:63], s4 offen sc1
  v_mfma_f32_16x16x32_bf16 v[112:115], v[108:111], v[180:183], v[112:115]
  v_add_f32 v82, v82, v86
  v_mfma_f32_16x16x32_bf16 v[112:115], v[108:111], v[184:187], v[112:115]
  v_add_f32 v83, v83, v87
  v_mfma_f32_16x16x32_bf16 v[112:115], v[108:111], v[188:191], v[112:115]
  v_add_f32 v80, v80, v82
  v_mfma_f32_16x16x32_bf16 v[112:115], v[108:111], v[192:195], v[112:115]
  v_add_f32 v81, v81, v83
  buffer_load_dwordx4 a[4:7], v16, s[60:63], s4 offen sc1
  v_mfma_f32_16x16x32_bf16 v[112:115], v[108:111], v[196:199], v[112:115]
  v_add_f32 v80, v80, v81
  v_mfma_f32_16x16x32_bf16 v[112:115], v[108:111], v[200:203], v[112:115]
  v_mov_b32 v81, v80
  v_mfma_f32_16x16x32_bf16 v[112:115], v[108:111], v[204:207], v[112:115]
  s_nop 0
  v_permlane32_swap_b32 v80, v81
  v_mfma_f32_16x16x32_bf16 v[112:115], v[108:111], v[208:211], v[112:115]
  v_mul_f32 v82, 0xbb000000, v80
  buffer_load_dwordx4 a[8:11], v15, s[60:63], s4 offen offset:2048 sc1
  v_mfma_f32_16x16x32_bf16 v[112:115], v[108:111], v[212:215], v[112:115]
  v_mul_f32 v81, 0x3b000000, v81
  v_mfma_f32_16x16x32_bf16 v[112:115], v[108:111], v[216:219], v[112:115]
  v_fma_f32 v81, -v82, v82, v81
  v_mfma_f32_16x16x32_bf16 v[112:115], v[108:111], v[220:223], v[112:115]
  v_max_f32 v81, 0, v81
  v_mfma_f32_16x16x32_bf16 v[112:115], v[108:111], v[224:227], v[112:115]
  v_cvt_pk_bf16_f32 v20, v82, v82
  buffer_load_dwordx4 a[12:15], v16, s[60:63], s4 offen offset:2048 sc1
  v_mfma_f32_16x16x32_bf16 v[112:115], v[108:111], v[228:231], v[112:115]
  v_cvt_pk_bf16_f32 v21, v82, 0
  v_mfma_f32_16x16x32_bf16 v[112:115], v[108:111], v[232:235], v[112:115]
  v_cvt_pk_bf16_f32 v81, v81, v81
  v_mfma_f32_16x16x32_bf16 v[112:115], v[108:111], v[236:239], v[112:115]
  v_and_b32 v81, 0xffff0000, v81
  v_mfma_f32_16x16x32_bf16 v[112:115], v[108:111], v[240:243], v[112:115]
  v_add_f32 v81, 0x3727c5ac, v81
  s_add_u32 s4, s4, 0x1000
  buffer_load_dwordx4 a[16:19], v15, s[60:63], s4 offen sc1
  v_mfma_f32_16x16x32_bf16 v[112:115], v[108:111], v[244:247], v[112:115]
  v_cvt_pk_bf16_f32 v81, v81, v81
  v_mfma_f32_16x16x32_bf16 v[112:115], v[108:111], v[248:251], v[112:115]
  v_and_b32 v81, 0xffff0000, v81
  v_mfma_f32_16x16x32_bf16 v[112:115], v[108:111], v[252:255], v[112:115]
  v_sqrt_f32 v81, v81
  s_nop 0
  v_cvt_pk_bf16_f32 v81, v81, v81
  v_and_b32 v81, 0xffff0000, v81
  v_rcp_f32 v81, v81
  v_mov_b32 v23, 0
  s_lshl_b32 s81, s3, 9
  s_add_u32 s81, s81, 0x27000
  v_lshl_add_u32 v11, v4, 4, s81
  v_mul_f32 v22, 0xbeeff558, v81
  v_and_b32 v22, 0xffffff7f, v22
  ds_write_b128 v11, v[20:23]
  s_waitcnt lgkmcnt(0)
  s_barrier
  s_and_b32 s81, s3, 2
  s_lshl_b32 s82, s81, 13
  s_lshl_b32 s85, s90, 12
  s_add_u32 s82, s82, s85
  s_add_u32 s82, s82, 0x10000
  v_add_u32 v6, s82, v38
  s_mul_i32 s83, s90, 3456
  v_add_u32 v18, s83, v18
  ds_read_b128 v[68:71], v6 offset:0
  ds_read_b128 v[84:87], v6 offset:8192
  ds_read_b64 v[28:29], v18 offset:768
  ds_read_b128 v[72:75], v6 offset:1024
  ds_read_b128 v[88:91], v6 offset:9216
  ds_read_b64 v[30:31], v18 offset:1536
  ds_read_b128 v[76:79], v6 offset:2048
  ds_read_b128 v[92:95], v6 offset:10240
  ds_read_b64 v[32:33], v18 offset:2304
  ds_read_b128 v[80:83], v6 offset:3072
  ds_read_b128 v[96:99], v6 offset:11264
  ds_read_b64 v[34:35], v18 offset:3072
  v_and_b32 v7, 1, v3
  v_cmp_eq_u32 vcc, 1, v7
  v_lshrrev_b32 v8, 1, v2
  s_nop 0
  v_cndmask_b32 v112, v112, v113, vcc
  v_cmp_eq_u32 vcc, 0, v5
  v_lshlrev_b32 v8, 6, v8
  s_nop 0
  v_cndmask_b32 v112, 0, v112, vcc
  v_cvt_pk_bf16_f32 v113, v112, v112
  v_and_b32 v113, 0xffff0000, v113
  v_sub_f32 v112, v112, v113
  v_cvt_pk_bf16_f32 v114, v112, v112
  v_and_b32 v114, 0xffff0000, v114
  v_sub_f32 v112, v112, v114
  v_cvt_pk_bf16_f32 v116, v113, v114
  v_cvt_pk_bf16_f32 v117, v112, 0
  v_mov_b32 v118, 0
  v_mov_b32 v119, 0
  buffer_load_dwordx4 a[20:23], v16, s[60:63], s4 offen sc1
  buffer_load_dwordx4 a[24:27], v15, s[60:63], s4 offen offset:2048 sc1
  v_and_b32 v7, 1, v2
  v_lshl_add_u32 v8, v7, 3, v8
  v_lshl_add_u32 v7, v3, 4, v8
  s_lshl_b32 s82, s87, 12
  s_lshl_b32 s85, s90, 11
  s_add_u32 s82, s82, s85
  s_add_u32 s82, s82, 0x1000000
  s_waitcnt lgkmcnt(9)
  v_lshlrev_b32 v20, 16, v28
  v_and_b32 v21, 0xffff0000, v28
  v_lshlrev_b32 v22, 16, v29
  v_and_b32 v23, 0xffff0000, v29
  v_pk_add_f32 v[68:69], v[68:69], v[84:85]
  v_pk_add_f32 v[70:71], v[70:71], v[86:87]
  v_fma_f32 v68, v20, v27, v68
  v_fma_f32 v69, v21, v27, v69
  v_fma_f32 v70, v22, v27, v70
  v_fma_f32 v71, v23, v27, v71
  v_cvt_pk_bf16_f32 v28, v68, v69
  v_cvt_pk_bf16_f32 v29, v70, v71
  buffer_store_dwordx2 v[28:29], v7, s[60:63], s82 offen offset:0 sc1
  buffer_load_dwordx4 a[28:31], v16, s[60:63], s4 offen offset:2048 sc1
  s_waitcnt lgkmcnt(6)
  v_lshlrev_b32 v20, 16, v30
  v_and_b32 v21, 0xffff0000, v30
  v_lshlrev_b32 v22, 16, v31
  v_and_b32 v23, 0xffff0000, v31
  v_pk_add_f32 v[72:73], v[72:73], v[88:89]
  v_pk_add_f32 v[74:75], v[74:75], v[90:91]
  v_fma_f32 v72, v20, v27, v72
  v_fma_f32 v73, v21, v27, v73
  v_fma_f32 v74, v22, v27, v74
  v_fma_f32 v75, v23, v27, v75
  v_cvt_pk_bf16_f32 v30, v72, v73
  v_cvt_pk_bf16_f32 v31, v74, v75
  buffer_store_dwordx2 v[30:31], v7, s[60:63], s82 offen offset:512 sc1
  s_add_u32 s4, s4, 0x1000
  buffer_load_dwordx4 a[32:35], v15, s[60:63], s4 offen sc1
  s_waitcnt lgkmcnt(3)
  v_lshlrev_b32 v20, 16, v32
  v_and_b32 v21, 0xffff0000, v32
  v_lshlrev_b32 v22, 16, v33
  v_and_b32 v23, 0xffff0000, v33
  v_pk_add_f32 v[76:77], v[76:77], v[92:93]
  v_pk_add_f32 v[78:79], v[78:79], v[94:95]
  v_fma_f32 v76, v20, v27, v76
  v_fma_f32 v77, v21, v27, v77
  v_fma_f32 v78, v22, v27, v78
  v_fma_f32 v79, v23, v27, v79
  v_cvt_pk_bf16_f32 v32, v76, v77
  v_cvt_pk_bf16_f32 v33, v78, v79
  buffer_store_dwordx2 v[32:33], v7, s[60:63], s82 offen offset:1024 sc1
  buffer_load_dwordx4 a[36:39], v16, s[60:63], s4 offen sc1
  s_waitcnt lgkmcnt(0)
  v_lshlrev_b32 v20, 16, v34
  v_and_b32 v21, 0xffff0000, v34
  v_lshlrev_b32 v22, 16, v35
  v_and_b32 v23, 0xffff0000, v35
  v_pk_add_f32 v[80:81], v[80:81], v[96:97]
  v_pk_add_f32 v[82:83], v[82:83], v[98:99]
  v_fma_f32 v80, v20, v27, v80
  v_fma_f32 v81, v21, v27, v81
  v_fma_f32 v82, v22, v27, v82
  v_fma_f32 v83, v23, v27, v83
  v_cvt_pk_bf16_f32 v34, v80, v81
  v_cvt_pk_bf16_f32 v35, v82, v83
  buffer_store_dwordx2 v[34:35], v7, s[60:63], s82 offen offset:1536 sc1
  buffer_load_dwordx4 a[40:43], v15, s[60:63], s4 offen offset:2048 sc1
  s_cmp_ge_u32 s35, 28
  s_cbranch_scc1 L_p3skip_14
  v_lshlrev_b32 v22, 4, v4
  v_add_u32 v22, 0x27000, v22
  v_add_u32 v23, 0x10000, v38
  s_barrier
  ds_read_b128 v[24:27], v22 offset:0
  ds_read_b128 v[84:87], v38 offset:0
  ds_read_b128 v[88:91], v38 offset:1024
  ds_read_b128 v[92:95], v38 offset:2048
  ds_read_b128 v[96:99], v38 offset:3072
  ds_read_b128 v[100:103], v38 offset:4096
  s_waitcnt lgkmcnt(5)
  v_mfma_f32_32x32x16_bf16 v[40:55], v[116:119], v[24:27], 0
  ds_read_b128 v[104:107], v38 offset:5120
  s_waitcnt lgkmcnt(4)
  v_mfma_f32_32x32x16_bf16 v[40:55], v[128:131], v[84:87], v[40:55]
  buffer_load_dwordx4 a[44:47], v16, s[60:63], s4 offen offset:2048 sc1
  s_and_b32 s82, s76, 1
  s_xor_b32 s83, s82, 1
  s_lshl_b32 s66, s82, 5
  s_lshl_b32 s67, s83, 5
  ds_read_b128 v[84:87], v38 offset:6144
  v_mfma_f32_32x32x16_bf16 v[40:55], v[132:135], v[88:91], v[40:55]
  s_lshr_b32 s81, s78, 5
  s_mul_i32 s84, s81, 114688
  s_mul_i32 s85, s3, 28672
  ds_read_b128 v[88:91], v38 offset:7168
  s_waitcnt lgkmcnt(4)
  v_mfma_f32_32x32x16_bf16 v[40:55], v[136:139], v[92:95], v[40:55]
  s_add_u32 s8, s8, s12
  s_add_u32 s88, s8, 0x0
  s_add_u32 m0, s23, 0x10000
  s_nop 0
  buffer_load_dwordx4 v64, s[60:63], s88 offen sc1 lds
  s_add_u32 s84, s84, s85
  s_add_u32 s84, s84, 0x600000
  s_mul_i32 s24, s82, 129024
  ds_read_b128 v[92:95], v38 offset:8192
  v_mfma_f32_32x32x16_bf16 v[40:55], v[140:143], v[96:99], v[40:55]
  s_add_u32 s24, s24, s84
  s_mul_i32 s25, s83, 114688
  s_mul_i32 s85, s82, 14336
  s_add_u32 s25, s25, s85
  ds_read_b128 v[96:99], v38 offset:9216
  s_waitcnt lgkmcnt(4)
  v_mfma_f32_32x32x16_bf16 v[40:55], v[144:147], v[100:103], v[40:55]
  buffer_load_dwordx4 v65, s[60:63], s88 offen offset:1024 sc1 lds
  s_add_u32 s25, s25, s84
  s_mul_i32 s26, s83, 129024
  s_add_u32 s26, s26, s84
  ds_read_b128 v[100:103], v38 offset:10240
  v_mfma_f32_32x32x16_bf16 v[40:55], v[148:151], v[104:107], v[40:55]
  s_mul_i32 s27, s82, 114688
  s_mul_i32 s85, s83, 14336
  s_add_u32 s27, s27, s85
  ds_read_b128 v[104:107], v38 offset:11264
  s_waitcnt lgkmcnt(4)
  v_mfma_f32_32x32x16_bf16 v[40:55], v[152:155], v[84:87], v[40:55]
  buffer_load_dwordx4 v66, s[60:63], s88 offen offset:2048 sc1 lds
  s_add_u32 s27, s27, s84
  s_lshr_b32 s81, s78, 7
  s_lshl_b32 s84, s81, 10
  s_lshl_b32 s85, s3, 5
  ds_read_b128 v[84:87], v38 offset:12288
  v_mfma_f32_32x32x16_bf16 v[40:55], v[156:159], v[88:91], v[40:55]
  s_add_u32 s84, s84, s85
  s_add_u32 s84, s84, 0x8000
  v_min_u32 v6, 6, v1
  ds_read_b128 v[88:91], v38 offset:13312
  s_waitcnt lgkmcnt(4)
  v_mfma_f32_32x32x16_bf16 v[40:55], v[160:163], v[92:95], v[40:55]
  buffer_load_dwordx4 v67, s[60:63], s88 offen offset:3072 sc1 lds
  v_lshl_add_u32 v14, v6, 2, s84
  s_mul_i32 s19, s82, 896
  s_mul_i32 s20, s82, 384
  ds_read_b128 v[92:95], v38 offset:14336
  v_mfma_f32_32x32x16_bf16 v[40:55], v[164:167], v[96:99], v[40:55]
  s_add_u32 s20, s20, 0x100
  s_lshl_b32 s21, s82, 7
  s_add_u32 s21, s21, 0x180
  s_mul_i32 s22, s82, 640
  ds_read_b128 v[96:99], v38 offset:15360
  s_waitcnt lgkmcnt(4)
  v_mfma_f32_32x32x16_bf16 v[40:55], v[168:171], v[100:103], v[40:55]
  s_add_u32 s88, s8, 0x40000
  s_add_u32 m0, s23, 0x11000
  s_nop 0
  buffer_load_dwordx4 v64, s[60:63], s88 offen sc1 lds
  s_add_u32 s22, s22, 0x80
  s_lshl_b32 s81, s78, 10
  s_lshl_b32 s85, s77, 7
  ds_read_b128 v[100:103], v38 offset:16384
  v_mfma_f32_32x32x16_bf16 v[40:55], v[172:175], v[104:107], v[40:55]
  s_add_u32 s81, s81, s85
  s_lshl_b32 s85, s90, 6
  s_add_u32 s81, s81, s85
  ds_read_b128 v[104:107], v38 offset:17408
  s_waitcnt lgkmcnt(4)
  v_mfma_f32_32x32x16_bf16 v[40:55], v[176:179], v[84:87], v[40:55]
  buffer_load_dwordx4 v65, s[60:63], s88 offen offset:1024 sc1 lds
  s_lshl_b32 s85, s89, 5
  s_add_u32 s81, s81, s85
  v_lshlrev_b32 v6, 10, v4
  v_add_u32 v6, s81, v6
  ds_read_b128 v[84:87], v38 offset:18432
  v_mfma_f32_32x32x16_bf16 v[40:55], v[180:183], v[88:91], v[40:55]
  v_lshl_add_u32 v3, v5, 4, v6
  s_lshl_b32 s81, s90, 6
  s_lshl_b32 s85, s89, 5
  ds_read_b128 v[88:91], v38 offset:19456
  s_waitcnt lgkmcnt(4)
  v_mfma_f32_32x32x16_bf16 v[40:55], v[184:187], v[92:95], v[40:55]
  buffer_load_dwordx4 v66, s[60:63], s88 offen offset:2048 sc1 lds
  s_add_u32 s81, s81, s85
  s_add_u32 s81, s81, 0x24000
  v_mul_u32_u24 v11, 136, v4
  ds_read_b128 v[92:95], v38 offset:20480
  v_mfma_f32_32x32x16_bf16 v[40:55], v[188:191], v[96:99], v[40:55]
  s_waitcnt vmcnt(9)
  s_mov_b64 exec, 1
  buffer_store_dword v10, v9, s[60:63], s7 offen sc1
  s_mov_b64 exec, -1
  v_lshl_add_u32 v11, v5, 3, v11
  v_add_u32 v11, s81, v11
  s_lshl_b32 s81, s77, 18
  ds_read_b128 v[96:99], v38 offset:21504
  s_waitcnt lgkmcnt(4)
  v_mfma_f32_32x32x16_bf16 v[40:55], v[192:195], v[100:103], v[40:55]
  buffer_load_dwordx4 v67, s[60:63], s88 offen offset:3072 sc1 lds
  s_lshl_b32 s85, s90, 17
  s_add_u32 s81, s81, s85
  s_lshl_b32 s85, s89, 3
  s_add_u32 s81, s81, s85
  ds_read_b128 v[100:103], v38 offset:22528
  v_mfma_f32_32x32x16_bf16 v[40:55], v[196:199], v[104:107], v[40:55]
  s_lshl_b32 s85, s78, 4
  s_add_u32 s81, s81, s85
  s_add_u32 s81, s81, 0x300000
  ds_read_b128 v[104:107], v38 offset:23552
  s_waitcnt lgkmcnt(4)
  v_mfma_f32_32x32x16_bf16 v[40:55], v[200:203], v[84:87], v[40:55]
  s_add_u32 s8, s8, s12
  s_add_u32 s88, s8, 0x0
  s_add_u32 m0, s23, 0x18000
  s_nop 0
  buffer_load_dwordx4 v64, s[60:63], s88 offen sc1 lds
  v_lshl_add_u32 v6, v5, 11, v4
  v_lshl_add_u32 v12, v6, 4, s81
  s_lshl_b32 s81, s77, 18
  ds_read_b128 v[84:87], v38 offset:24576
  v_mfma_f32_32x32x16_bf16 v[40:55], v[204:207], v[88:91], v[40:55]
  s_lshl_b32 s85, s90, 17
  s_add_u32 s81, s81, s85
  s_lshl_b32 s85, s89, 16
  s_add_u32 s81, s81, s85
  ds_read_b128 v[88:91], v38 offset:25600
  s_waitcnt lgkmcnt(4)
  v_mfma_f32_32x32x16_bf16 v[40:55], v[208:211], v[92:95], v[40:55]
  buffer_load_dwordx4 v65, s[60:63], s88 offen offset:1024 sc1 lds
  s_lshl_b32 s85, s78, 1
  s_add_u32 s81, s81, s85
  s_add_u32 s81, s81, 0x1000000
  ds_read_b128 v[92:95], v38 offset:26624
  v_mfma_f32_32x32x16_bf16 v[40:55], v[212:215], v[96:99], v[40:55]
  v_lshrrev_b32 v6, 2, v1
  v_lshlrev_b32 v6, 12, v6
  v_and_b32 v7, 3, v1
  ds_read_b128 v[96:99], v38 offset:27648
  s_waitcnt lgkmcnt(4)
  v_mfma_f32_32x32x16_bf16 v[40:55], v[216:219], v[100:103], v[40:55]
  buffer_load_dwordx4 v66, s[60:63], s88 offen offset:2048 sc1 lds
  v_lshl_add_u32 v6, v7, 4, v6
  v_add_u32 v13, s81, v6
  s_lshl_b32 s81, s3, 11
  s_add_u32 s81, s81, 0xc000
  ds_read_b128 v[100:103], v38 offset:28672
  v_mfma_f32_32x32x16_bf16 v[40:55], v[220:223], v[104:107], v[40:55]
  v_add_u32 v17, s81, v37
  s_xor_b32 s81, s3, 1
  s_mul_i32 s82, s81, 6144
  ds_read_b128 v[104:107], v38 offset:29696
  s_waitcnt lgkmcnt(4)
  v_mfma_f32_32x32x16_bf16 v[40:55], v[224:227], v[84:87], v[40:55]
  buffer_load_dwordx4 v67, s[60:63], s88 offen offset:3072 sc1 lds
  v_add_u32 v18, s82, v38
  s_xor_b32 s81, s3, 2
  s_mul_i32 s82, s81, 6144
  ds_read_b128 v[84:87], v38 offset:30720
  v_mfma_f32_32x32x16_bf16 v[40:55], v[228:231], v[88:91], v[40:55]
  s_add_u32 s82, s82, 0x800
  v_add_u32 v19, s82, v38
  s_xor_b32 s81, s3, 3
  s_mul_i32 s82, s81, 6144
  ds_read_b128 v[88:91], v38 offset:31744
  s_waitcnt lgkmcnt(4)
  v_mfma_f32_32x32x16_bf16 v[40:55], v[232:235], v[92:95], v[40:55]
  s_add_u32 s88, s8, 0x40000
  s_add_u32 m0, s23, 0x19000
  s_nop 0
  buffer_load_dwordx4 v64, s[60:63], s88 offen sc1 lds
  s_add_u32 s82, s82, 0x1000
  v_add_u32 v20, s82, v38
  s_mul_i32 s81, s3, 6144
  v_mfma_f32_32x32x16_bf16 v[40:55], v[236:239], v[96:99], v[40:55]
  v_add_u32 v21, s81, v38
  s_lshr_b32 s82, s34, 2
  s_lshl_b32 s81, s77, 9
  s_waitcnt lgkmcnt(2)
  v_mfma_f32_32x32x16_bf16 v[40:55], v[240:243], v[100:103], v[40:55]
  buffer_load_dwordx4 v65, s[60:63], s88 offen offset:1024 sc1 lds
  s_lshl_b32 s85, s82, 8
  s_add_u32 s81, s81, s85
  s_lshl_b32 s85, s90, 6
  s_add_u32 s81, s81, s85
  v_mfma_f32_32x32x16_bf16 v[40:55], v[244:247], v[104:107], v[40:55]
  s_lshl_b32 s85, s89, 5
  s_add_u32 s81, s81, s85
  s_add_u32 s81, s81, 0x5000
  s_waitcnt lgkmcnt(0)
  v_mfma_f32_32x32x16_bf16 v[40:55], v[248:251], v[84:87], v[40:55]
  buffer_load_dwordx4 v66, s[60:63], s88 offen offset:2048 sc1 lds
  v_bfe_u32 v6, v1, 3, 1
  v_and_b32 v7, 7, v1
  v_lshl_add_u32 v6, v6, 5, v7
  v_mfma_f32_32x32x16_bf16 v[40:55], v[252:255], v[88:91], v[40:55]
  v_lshl_add_u32 v2, v6, 2, s81
  s_mov_b32 s64, 0xbfb8aa3b
  s_mov_b32 s65, 0xbfb8aa3b
  s_barrier
  ds_read_b128 v[28:31], v22 offset:512
  ds_read_b128 v[84:87], v38 offset:32768
  ds_read_b128 v[88:91], v38 offset:33792
  ds_read_b128 v[92:95], v38 offset:34816
  ds_read_b128 v[96:99], v38 offset:35840
  ds_read_b128 v[100:103], v38 offset:36864
  s_waitcnt lgkmcnt(5)
  v_mfma_f32_32x32x16_bf16 v[68:83], v[116:119], v[28:31], 0
  ds_read_b128 v[104:107], v38 offset:37888
  s_waitcnt lgkmcnt(4)
  v_mfma_f32_32x32x16_bf16 v[68:83], v[128:131], v[84:87], v[68:83]
  buffer_load_dwordx4 v67, s[60:63], s88 offen offset:3072 sc1 lds
  v_mul_f32 v40, v40, v26
  v_mul_f32 v41, v41, v26
  v_mul_f32 v42, v42, v26
  v_mul_f32 v43, v43, v26
  ds_read_b128 v[84:87], v38 offset:38912
  v_mfma_f32_32x32x16_bf16 v[68:83], v[132:135], v[88:91], v[68:83]
  v_fma_f32 v36, v40, v40, s72
  v_fma_f32 v39, v41, v41, s72
  v_fma_f32 v120, v42, v42, s72
  v_fma_f32 v121, v43, v43, s72
  ds_read_b128 v[88:91], v38 offset:39936
  s_waitcnt lgkmcnt(4)
  v_mfma_f32_32x32x16_bf16 v[68:83], v[136:139], v[92:95], v[68:83]
  s_add_u32 s4, s4, 0x1000
  buffer_load_dwordx4 a[48:51], v15, s[60:63], s4 offen sc1
  v_mul_f32 v36, v36, v40
  v_mul_f32 v39, v39, v41
  v_mul_f32 v120, v120, v42
  v_mul_f32 v121, v121, v43
  ds_read_b128 v[92:95], v38 offset:40960
  v_mfma_f32_32x32x16_bf16 v[68:83], v[140:143], v[96:99], v[68:83]
  v_exp_f32 v36, v36
  v_exp_f32 v39, v39
  v_exp_f32 v120, v120
  v_exp_f32 v121, v121
  ds_read_b128 v[96:99], v38 offset:41984
  s_waitcnt lgkmcnt(4)
  v_mfma_f32_32x32x16_bf16 v[68:83], v[144:147], v[100:103], v[68:83]
  buffer_load_dwordx4 a[52:55], v16, s[60:63], s4 offen sc1
  v_fma_f32 v36, v36, s74, s74
  v_fma_f32 v39, v39, s74, s74
  v_fma_f32 v120, v120, s74, s74
  v_fma_f32 v121, v121, s74, s74
  ds_read_b128 v[100:103], v38 offset:43008
  v_mfma_f32_32x32x16_bf16 v[68:83], v[148:151], v[104:107], v[68:83]
  v_rcp_f32 v36, v36
  v_rcp_f32 v39, v39
  v_rcp_f32 v120, v120
  ds_read_b128 v[104:107], v38 offset:44032
  s_waitcnt lgkmcnt(4)
  v_mfma_f32_32x32x16_bf16 v[68:83], v[152:155], v[84:87], v[68:83]
  buffer_load_dwordx4 a[56:59], v15, s[60:63], s4 offen offset:2048 sc1
  v_rcp_f32 v121, v121
  v_mul_f32 v36, v36, v40
  v_mul_f32 v39, v39, v41
  v_mul_f32 v120, v120, v42
  ds_read_b128 v[84:87], v38 offset:45056
  v_mfma_f32_32x32x16_bf16 v[68:83], v[156:159], v[88:91], v[68:83]
  v_mul_f32 v121, v121, v43
  v_cvt_pk_bf16_f32 v56, v36, v39
  v_cvt_pk_bf16_f32 v57, v120, v121
  v_mul_f32 v44, v44, v26
  ds_read_b128 v[88:91], v38 offset:46080
  s_waitcnt lgkmcnt(4)
  v_mfma_f32_32x32x16_bf16 v[68:83], v[160:163], v[92:95], v[68:83]
  buffer_load_dwordx4 a[60:63], v16, s[60:63], s4 offen offset:2048 sc1
  v_mul_f32 v45, v45, v26
  v_mul_f32 v46, v46, v26
  v_mul_f32 v47, v47, v26
  v_fma_f32 v36, v44, v44, s72
  ds_read_b128 v[92:95], v38 offset:47104
  v_mfma_f32_32x32x16_bf16 v[68:83], v[164:167], v[96:99], v[68:83]
  v_fma_f32 v39, v45, v45, s72
  v_fma_f32 v120, v46, v46, s72
  v_fma_f32 v121, v47, v47, s72
  v_mul_f32 v36, v36, v44
  ds_read_b128 v[96:99], v38 offset:48128
  s_waitcnt lgkmcnt(4)
  v_mfma_f32_32x32x16_bf16 v[68:83], v[168:171], v[100:103], v[68:83]
  s_add_u32 s4, s4, 0x1000
  buffer_load_dwordx4 a[64:67], v15, s[60:63], s4 offen sc1
  v_mul_f32 v39, v39, v45
  v_mul_f32 v120, v120, v46
  v_mul_f32 v121, v121, v47
  ds_read_b128 v[100:103], v38 offset:49152
  v_mfma_f32_32x32x16_bf16 v[68:83], v[172:175], v[104:107], v[68:83]
  v_exp_f32 v36, v36
  v_exp_f32 v39, v39
  v_exp_f32 v120, v120
  v_exp_f32 v121, v121
  ds_read_b128 v[104:107], v38 offset:50176
  s_waitcnt lgkmcnt(4)
  v_mfma_f32_32x32x16_bf16 v[68:83], v[176:179], v[84:87], v[68:83]
  buffer_load_dwordx4 a[68:71], v16, s[60:63], s4 offen sc1
  v_fma_f32 v36, v36, s74, s74
  v_fma_f32 v39, v39, s74, s74
  v_fma_f32 v120, v120, s74, s74
  v_fma_f32 v121, v121, s74, s74
  ds_read_b128 v[84:87], v38 offset:51200
  v_mfma_f32_32x32x16_bf16 v[68:83], v[180:183], v[88:91], v[68:83]
  v_rcp_f32 v36, v36
  v_rcp_f32 v39, v39
  v_rcp_f32 v120, v120
  v_rcp_f32 v121, v121
  ds_read_b128 v[88:91], v38 offset:52224
  s_waitcnt lgkmcnt(4)
  v_mfma_f32_32x32x16_bf16 v[68:83], v[184:187], v[92:95], v[68:83]
  buffer_load_dwordx4 a[72:75], v15, s[60:63], s4 offen offset:2048 sc1
  v_mul_f32 v36, v36, v44
  v_mul_f32 v39, v39, v45
  v_mul_f32 v120, v120, v46
  v_mul_f32 v121, v121, v47
  ds_read_b128 v[92:95], v38 offset:53248
  v_mfma_f32_32x32x16_bf16 v[68:83], v[188:191], v[96:99], v[68:83]
  v_cvt_pk_bf16_f32 v58, v36, v39
  v_cvt_pk_bf16_f32 v59, v120, v121
  buffer_store_dwordx4 v[56:59], v38, s[60:63], s13 offen sc1
  ds_read_b128 v[96:99], v38 offset:54272
  s_waitcnt lgkmcnt(4)
  v_mfma_f32_32x32x16_bf16 v[68:83], v[192:195], v[100:103], v[68:83]
  buffer_load_dwordx4 a[76:79], v16, s[60:63], s4 offen offset:2048 sc1
  v_mul_f32 v48, v48, v26
  v_mul_f32 v49, v49, v26
  v_mul_f32 v50, v50, v26
  v_mul_f32 v51, v51, v26
  ds_read_b128 v[100:103], v38 offset:55296
  v_mfma_f32_32x32x16_bf16 v[68:83], v[196:199], v[104:107], v[68:83]
  v_fma_f32 v36, v48, v48, s72
  v_fma_f32 v39, v49, v49, s72
  v_fma_f32 v120, v50, v50, s72
  v_fma_f32 v121, v51, v51, s72
  ds_read_b128 v[104:107], v38 offset:56320
  s_waitcnt lgkmcnt(4)
  v_mfma_f32_32x32x16_bf16 v[68:83], v[200:203], v[84:87], v[68:83]
  s_add_u32 s4, s4, 0x1000
  buffer_load_dwordx4 a[80:83], v15, s[60:63], s4 offen sc1
  v_mul_f32 v36, v36, v48
  v_mul_f32 v39, v39, v49
  v_mul_f32 v120, v120, v50
  v_mul_f32 v121, v121, v51
  ds_read_b128 v[84:87], v38 offset:57344
  v_mfma_f32_32x32x16_bf16 v[68:83], v[204:207], v[88:91], v[68:83]
  v_exp_f32 v36, v36
  v_exp_f32 v39, v39
  v_exp_f32 v120, v120
  v_exp_f32 v121, v121
  ds_read_b128 v[88:91], v38 offset:58368
  s_waitcnt lgkmcnt(4)
  v_mfma_f32_32x32x16_bf16 v[68:83], v[208:211], v[92:95], v[68:83]
  buffer_load_dwordx4 a[84:87], v16, s[60:63], s4 offen sc1
  v_fma_f32 v36, v36, s74, s74
  v_fma_f32 v39, v39, s74, s74
  v_fma_f32 v120, v120, s74, s74
  v_fma_f32 v121, v121, s74, s74
  ds_read_b128 v[92:95], v38 offset:59392
  v_mfma_f32_32x32x16_bf16 v[68:83], v[212:215], v[96:99], v[68:83]
  v_rcp_f32 v36, v36
  v_rcp_f32 v39, v39
  v_rcp_f32 v120, v120
  ds_read_b128 v[96:99], v38 offset:60416
  s_waitcnt lgkmcnt(4)
  v_mfma_f32_32x32x16_bf16 v[68:83], v[216:219], v[100:103], v[68:83]
  buffer_load_dwordx4 a[88:91], v15, s[60:63], s4 offen offset:2048 sc1
  v_rcp_f32 v121, v121
  v_mul_f32 v36, v36, v48
  v_mul_f32 v39, v39, v49
  v_mul_f32 v120, v120, v50
  ds_read_b128 v[100:103], v38 offset:61440
  v_mfma_f32_32x32x16_bf16 v[68:83], v[220:223], v[104:107], v[68:83]
  v_mul_f32 v121, v121, v51
  v_cvt_pk_bf16_f32 v60, v36, v39
  v_cvt_pk_bf16_f32 v61, v120, v121
  v_mul_f32 v52, v52, v26
  ds_read_b128 v[104:107], v38 offset:62464
  s_waitcnt lgkmcnt(4)
  v_mfma_f32_32x32x16_bf16 v[68:83], v[224:227], v[84:87], v[68:83]
  buffer_load_dwordx4 a[92:95], v16, s[60:63], s4 offen offset:2048 sc1
  v_mul_f32 v53, v53, v26
  v_mul_f32 v54, v54, v26
  v_mul_f32 v55, v55, v26
  v_fma_f32 v36, v52, v52, s72
  ds_read_b128 v[84:87], v38 offset:63488
  v_mfma_f32_32x32x16_bf16 v[68:83], v[228:231], v[88:91], v[68:83]
  v_fma_f32 v39, v53, v53, s72
  v_fma_f32 v120, v54, v54, s72
  v_fma_f32 v121, v55, v55, s72
  v_mul_f32 v36, v36, v52
  ds_read_b128 v[88:91], v38 offset:64512
  s_waitcnt lgkmcnt(4)
  v_mfma_f32_32x32x16_bf16 v[68:83], v[232:235], v[92:95], v[68:83]
  s_add_u32 s4, s4, 0x1000
  buffer_load_dwordx4 a[96:99], v15, s[60:63], s4 offen sc1
  v_mul_f32 v39, v39, v53
  v_mul_f32 v120, v120, v54
  v_mul_f32 v121, v121, v55
  v_mfma_f32_32x32x16_bf16 v[68:83], v[236:239], v[96:99], v[68:83]
  v_exp_f32 v36, v36
  v_exp_f32 v39, v39
  v_exp_f32 v120, v120
  v_exp_f32 v121, v121
  s_waitcnt lgkmcnt(2)
  v_mfma_f32_32x32x16_bf16 v[68:83], v[240:243], v[100:103], v[68:83]
  buffer_load_dwordx4 a[100:103], v16, s[60:63], s4 offen sc1
  v_fma_f32 v36, v36, s74, s74
  v_fma_f32 v39, v39, s74, s74
  v_fma_f32 v120, v120, s74, s74
  v_fma_f32 v121, v121, s74, s74
  v_mfma_f32_32x32x16_bf16 v[68:83], v[244:247], v[104:107], v[68:83]
  v_rcp_f32 v36, v36
  v_rcp_f32 v39, v39
  v_rcp_f32 v120, v120
  v_rcp_f32 v121, v121
  s_waitcnt lgkmcnt(0)
  v_mfma_f32_32x32x16_bf16 v[68:83], v[248:251], v[84:87], v[68:83]
  buffer_load_dwordx4 a[104:107], v15, s[60:63], s4 offen offset:2048 sc1
  v_mul_f32 v36, v36, v52
  v_mul_f32 v39, v39, v53
  v_mul_f32 v120, v120, v54
  v_mul_f32 v121, v121, v55
  v_mfma_f32_32x32x16_bf16 v[68:83], v[252:255], v[88:91], v[68:83]
  v_cvt_pk_bf16_f32 v62, v36, v39
  v_cvt_pk_bf16_f32 v63, v120, v121
  buffer_store_dwordx4 v[60:63], v38, s[60:63], s13 offen offset:1024 sc1
  s_add_u32 s13, s13, s17
  s_waitcnt vmcnt(25)
  s_barrier
  ds_read_b128 v[24:27], v22 offset:1024
  ds_read_b128 v[84:87], v23 offset:0
  ds_read_b128 v[88:91], v23 offset:1024
  ds_read_b128 v[92:95], v23 offset:2048
  ds_read_b128 v[96:99], v23 offset:3072
  ds_read_b128 v[100:103], v23 offset:4096
  s_waitcnt lgkmcnt(5)
  v_mfma_f32_32x32x16_bf16 v[40:55], v[116:119], v[24:27], 0
  ds_read_b128 v[104:107], v23 offset:5120
  s_waitcnt lgkmcnt(4)
  v_mfma_f32_32x32x16_bf16 v[40:55], v[128:131], v[84:87], v[40:55]
  buffer_load_dwordx4 a[108:111], v16, s[60:63], s4 offen offset:2048 sc1
  v_mul_f32 v68, v68, v30
  v_mul_f32 v69, v69, v30
  v_mul_f32 v70, v70, v30
  v_mul_f32 v71, v71, v30
  ds_read_b128 v[84:87], v23 offset:6144
  v_mfma_f32_32x32x16_bf16 v[40:55], v[132:135], v[88:91], v[40:55]
  v_fma_f32 v36, v68, v68, s72
  v_fma_f32 v39, v69, v69, s72
  v_fma_f32 v120, v70, v70, s72
  v_fma_f32 v121, v71, v71, s72
  ds_read_b128 v[88:91], v23 offset:7168
  s_waitcnt lgkmcnt(4)
  v_mfma_f32_32x32x16_bf16 v[40:55], v[136:139], v[92:95], v[40:55]
  s_mov_b32 s4, s9
  buffer_load_dwordx4 a[112:115], v15, s[60:63], s4 offen sc1
  v_mul_f32 v36, v36, v68
  v_mul_f32 v39, v39, v69
  v_mul_f32 v120, v120, v70
  v_mul_f32 v121, v121, v71
  ds_read_b128 v[92:95], v23 offset:8192
  v_mfma_f32_32x32x16_bf16 v[40:55], v[140:143], v[96:99], v[40:55]
  v_exp_f32 v36, v36
  v_exp_f32 v39, v39
  v_exp_f32 v120, v120
  v_exp_f32 v121, v121
  ds_read_b128 v[96:99], v23 offset:9216
  s_waitcnt lgkmcnt(4)
  v_mfma_f32_32x32x16_bf16 v[40:55], v[144:147], v[100:103], v[40:55]
  buffer_load_dwordx4 a[116:119], v16, s[60:63], s4 offen sc1
  v_fma_f32 v36, v36, s74, s74
  v_fma_f32 v39, v39, s74, s74
  v_fma_f32 v120, v120, s74, s74
  v_fma_f32 v121, v121, s74, s74
  ds_read_b128 v[100:103], v23 offset:10240
  v_mfma_f32_32x32x16_bf16 v[40:55], v[148:151], v[104:107], v[40:55]
  v_rcp_f32 v36, v36
  v_rcp_f32 v39, v39
  v_rcp_f32 v120, v120
  ds_read_b128 v[104:107], v23 offset:11264
  s_waitcnt lgkmcnt(4)
  v_mfma_f32_32x32x16_bf16 v[40:55], v[152:155], v[84:87], v[40:55]
  buffer_load_dwordx4 a[120:123], v15, s[60:63], s4 offen offset:2048 sc1
  v_rcp_f32 v121, v121
  v_mul_f32 v36, v36, v68
  v_mul_f32 v39, v39, v69
  v_mul_f32 v120, v120, v70
  ds_read_b128 v[84:87], v23 offset:12288
  v_mfma_f32_32x32x16_bf16 v[40:55], v[156:159], v[88:91], v[40:55]
  v_mul_f32 v121, v121, v71
  v_cvt_pk_bf16_f32 v56, v36, v39
  v_cvt_pk_bf16_f32 v57, v120, v121
  v_mul_f32 v72, v72, v30
  ds_read_b128 v[88:91], v23 offset:13312
  s_waitcnt lgkmcnt(4)
  v_mfma_f32_32x32x16_bf16 v[40:55], v[160:163], v[92:95], v[40:55]
  buffer_load_dwordx4 a[124:127], v16, s[60:63], s4 offen offset:2048 sc1
  v_mul_f32 v73, v73, v30
  v_mul_f32 v74, v74, v30
  v_mul_f32 v75, v75, v30
  v_fma_f32 v36, v72, v72, s72
  ds_read_b128 v[92:95], v23 offset:14336
  v_mfma_f32_32x32x16_bf16 v[40:55], v[164:167], v[96:99], v[40:55]
  v_fma_f32 v39, v73, v73, s72
  v_fma_f32 v120, v74, v74, s72
  v_fma_f32 v121, v75, v75, s72
  v_mul_f32 v36, v36, v72
  ds_read_b128 v[96:99], v23 offset:15360
  s_waitcnt lgkmcnt(4)
  v_mfma_f32_32x32x16_bf16 v[40:55], v[168:171], v[100:103], v[40:55]
  s_add_u32 s4, s4, 0x1000
  buffer_load_dwordx4 a[128:131], v15, s[60:63], s4 offen sc1
  v_mul_f32 v39, v39, v73
  v_mul_f32 v120, v120, v74
  v_mul_f32 v121, v121, v75
  ds_read_b128 v[100:103], v23 offset:16384
  v_mfma_f32_32x32x16_bf16 v[40:55], v[172:175], v[104:107], v[40:55]
  v_exp_f32 v36, v36
  v_exp_f32 v39, v39
  v_exp_f32 v120, v120
  v_exp_f32 v121, v121
  ds_read_b128 v[104:107], v23 offset:17408
  s_waitcnt lgkmcnt(4)
  v_mfma_f32_32x32x16_bf16 v[40:55], v[176:179], v[84:87], v[40:55]
  buffer_load_dwordx4 a[132:135], v16, s[60:63], s4 offen sc1
  v_fma_f32 v36, v36, s74, s74
  v_fma_f32 v39, v39, s74, s74
  v_fma_f32 v120, v120, s74, s74
  v_fma_f32 v121, v121, s74, s74
  ds_read_b128 v[84:87], v23 offset:18432
  v_mfma_f32_32x32x16_bf16 v[40:55], v[180:183], v[88:91], v[40:55]
  v_rcp_f32 v36, v36
  v_rcp_f32 v39, v39
  v_rcp_f32 v120, v120
  v_rcp_f32 v121, v121
  ds_read_b128 v[88:91], v23 offset:19456
  s_waitcnt lgkmcnt(4)
  v_mfma_f32_32x32x16_bf16 v[40:55], v[184:187], v[92:95], v[40:55]
  buffer_load_dwordx4 a[136:139], v15, s[60:63], s4 offen offset:2048 sc1
  v_mul_f32 v36, v36, v72
  v_mul_f32 v39, v39, v73
  v_mul_f32 v120, v120, v74
  v_mul_f32 v121, v121, v75
  ds_read_b128 v[92:95], v23 offset:20480
  v_mfma_f32_32x32x16_bf16 v[40:55], v[188:191], v[96:99], v[40:55]
  v_cvt_pk_bf16_f32 v58, v36, v39
  v_cvt_pk_bf16_f32 v59, v120, v121
  buffer_store_dwordx4 v[56:59], v38, s[60:63], s13 offen sc1
  ds_read_b128 v[96:99], v23 offset:21504
  s_waitcnt lgkmcnt(4)
  v_mfma_f32_32x32x16_bf16 v[40:55], v[192:195], v[100:103], v[40:55]
  buffer_load_dwordx4 a[140:143], v16, s[60:63], s4 offen offset:2048 sc1
  v_mul_f32 v76, v76, v30
  v_mul_f32 v77, v77, v30
  v_mul_f32 v78, v78, v30
  v_mul_f32 v79, v79, v30
  ds_read_b128 v[100:103], v23 offset:22528
  v_mfma_f32_32x32x16_bf16 v[40:55], v[196:199], v[104:107], v[40:55]
  s_waitcnt vmcnt(10)
  s_mov_b64 exec, 1
  buffer_store_dword v10, v9, s[60:63], s6 offen
  s_mov_b64 exec, -1
  s_add_u32 s6, s6, s18
  v_fma_f32 v36, v76, v76, s72
  v_fma_f32 v39, v77, v77, s72
  v_fma_f32 v120, v78, v78, s72
  v_fma_f32 v121, v79, v79, s72
  ds_read_b128 v[104:107], v23 offset:23552
  s_waitcnt lgkmcnt(4)
  v_mfma_f32_32x32x16_bf16 v[40:55], v[200:203], v[84:87], v[40:55]
  s_add_u32 s4, s4, 0x1000
  buffer_load_dwordx4 a[144:147], v15, s[60:63], s4 offen sc1
  v_mul_f32 v36, v36, v76
  v_mul_f32 v39, v39, v77
  v_mul_f32 v120, v120, v78
  v_mul_f32 v121, v121, v79
  ds_read_b128 v[84:87], v23 offset:24576
  v_mfma_f32_32x32x16_bf16 v[40:55], v[204:207], v[88:91], v[40:55]
  v_exp_f32 v36, v36
  v_exp_f32 v39, v39
  v_exp_f32 v120, v120
  v_exp_f32 v121, v121
  ds_read_b128 v[88:91], v23 offset:25600
  s_waitcnt lgkmcnt(4)
  v_mfma_f32_32x32x16_bf16 v[40:55], v[208:211], v[92:95], v[40:55]
  buffer_load_dwordx4 a[148:151], v16, s[60:63], s4 offen sc1
  v_fma_f32 v36, v36, s74, s74
  v_fma_f32 v39, v39, s74, s74
  v_fma_f32 v120, v120, s74, s74
  v_fma_f32 v121, v121, s74, s74
  ds_read_b128 v[92:95], v23 offset:26624
  v_mfma_f32_32x32x16_bf16 v[40:55], v[212:215], v[96:99], v[40:55]
  v_rcp_f32 v36, v36
  v_rcp_f32 v39, v39
  v_rcp_f32 v120, v120
  ds_read_b128 v[96:99], v23 offset:27648
  s_waitcnt lgkmcnt(4)
  v_mfma_f32_32x32x16_bf16 v[40:55], v[216:219], v[100:103], v[40:55]
  buffer_load_dwordx4 a[152:155], v15, s[60:63], s4 offen offset:2048 sc1
  v_rcp_f32 v121, v121
  v_mul_f32 v36, v36, v76
  v_mul_f32 v39, v39, v77
  v_mul_f32 v120, v120, v78
  ds_read_b128 v[100:103], v23 offset:28672
  v_mfma_f32_32x32x16_bf16 v[40:55], v[220:223], v[104:107], v[40:55]
  v_mul_f32 v121, v121, v79
  v_cvt_pk_bf16_f32 v60, v36, v39
  v_cvt_pk_bf16_f32 v61, v120, v121
  v_mul_f32 v80, v80, v30
  ds_read_b128 v[104:107], v23 offset:29696
  s_waitcnt lgkmcnt(4)
  v_mfma_f32_32x32x16_bf16 v[40:55], v[224:227], v[84:87], v[40:55]
  buffer_load_dwordx4 a[156:159], v16, s[60:63], s4 offen offset:2048 sc1
  v_mul_f32 v81, v81, v30
  v_mul_f32 v82, v82, v30
  v_mul_f32 v83, v83, v30
  v_fma_f32 v36, v80, v80, s72
  ds_read_b128 v[84:87], v23 offset:30720
  v_mfma_f32_32x32x16_bf16 v[40:55], v[228:231], v[88:91], v[40:55]
  v_fma_f32 v39, v81, v81, s72
  v_fma_f32 v120, v82, v82, s72
  v_fma_f32 v121, v83, v83, s72
  v_mul_f32 v36, v36, v80
  ds_read_b128 v[88:91], v23 offset:31744
  s_waitcnt lgkmcnt(4)
  v_mfma_f32_32x32x16_bf16 v[40:55], v[232:235], v[92:95], v[40:55]
  s_add_u32 s4, s4, 0x1000
  buffer_load_dwordx4 a[160:163], v15, s[60:63], s4 offen sc1
  v_mul_f32 v39, v39, v81
  v_mul_f32 v120, v120, v82
  v_mul_f32 v121, v121, v83
  v_mfma_f32_32x32x16_bf16 v[40:55], v[236:239], v[96:99], v[40:55]
  v_exp_f32 v36, v36
  v_exp_f32 v39, v39
  v_exp_f32 v120, v120
  v_exp_f32 v121, v121
  s_waitcnt lgkmcnt(2)
  v_mfma_f32_32x32x16_bf16 v[40:55], v[240:243], v[100:103], v[40:55]
  buffer_load_dwordx4 a[164:167], v16, s[60:63], s4 offen sc1
  v_fma_f32 v36, v36, s74, s74
  v_fma_f32 v39, v39, s74, s74
  v_fma_f32 v120, v120, s74, s74
  v_fma_f32 v121, v121, s74, s74
  v_mfma_f32_32x32x16_bf16 v[40:55], v[244:247], v[104:107], v[40:55]
  v_rcp_f32 v36, v36
  v_rcp_f32 v39, v39
  v_rcp_f32 v120, v120
  v_rcp_f32 v121, v121
  s_waitcnt lgkmcnt(0)
  v_mfma_f32_32x32x16_bf16 v[40:55], v[248:251], v[84:87], v[40:55]
  buffer_load_dwordx4 a[168:171], v15, s[60:63], s4 offen offset:2048 sc1
  v_mul_f32 v36, v36, v80
  v_mul_f32 v39, v39, v81
  v_mul_f32 v120, v120, v82
  v_mul_f32 v121, v121, v83
  v_mfma_f32_32x32x16_bf16 v[40:55], v[252:255], v[88:91], v[40:55]
  v_cvt_pk_bf16_f32 v62, v36, v39
  v_cvt_pk_bf16_f32 v63, v120, v121
  buffer_store_dwordx4 v[60:63], v38, s[60:63], s13 offen offset:1024 sc1
  s_add_u32 s13, s13, s17
  s_barrier
  ds_read_b128 v[28:31], v22 offset:1536
  ds_read_b128 v[84:87], v23 offset:32768
  ds_read_b128 v[88:91], v23 offset:33792
  ds_read_b128 v[92:95], v23 offset:34816
  ds_read_b128 v[96:99], v23 offset:35840
  ds_read_b128 v[100:103], v23 offset:36864
  s_waitcnt lgkmcnt(5)
  v_mfma_f32_32x32x16_bf16 v[68:83], v[116:119], v[28:31], 0
  ds_read_b128 v[104:107], v23 offset:37888
  s_waitcnt lgkmcnt(4)
  v_mfma_f32_32x32x16_bf16 v[68:83], v[128:131], v[84:87], v[68:83]
  buffer_load_dwordx4 a[172:175], v16, s[60:63], s4 offen offset:2048 sc1
  v_mul_f32 v40, v40, v26
  v_mul_f32 v41, v41, v26
  v_mul_f32 v42, v42, v26
  v_mul_f32 v43, v43, v26
  ds_read_b128 v[84:87], v23 offset:38912
  v_mfma_f32_32x32x16_bf16 v[68:83], v[132:135], v[88:91], v[68:83]
  v_fma_f32 v36, v40, v40, s72
  v_fma_f32 v39, v41, v41, s72
  v_fma_f32 v120, v42, v42, s72
  v_fma_f32 v121, v43, v43, s72
  ds_read_b128 v[88:91], v23 offset:39936
  s_waitcnt lgkmcnt(4)
  v_mfma_f32_32x32x16_bf16 v[68:83], v[136:139], v[92:95], v[68:83]
  s_add_u32 s4, s4, 0x1000
  buffer_load_dwordx4 a[176:179], v15, s[60:63], s4 offen sc1
  v_mul_f32 v36, v36, v40
  v_mul_f32 v39, v39, v41
  v_mul_f32 v120, v120, v42
  v_mul_f32 v121, v121, v43
  ds_read_b128 v[92:95], v23 offset:40960
  v_mfma_f32_32x32x16_bf16 v[68:83], v[140:143], v[96:99], v[68:83]
  v_exp_f32 v36, v36
  v_exp_f32 v39, v39
  v_exp_f32 v120, v120
  v_exp_f32 v121, v121
  ds_read_b128 v[96:99], v23 offset:41984
  s_waitcnt lgkmcnt(4)
  v_mfma_f32_32x32x16_bf16 v[68:83], v[144:147], v[100:103], v[68:83]
  buffer_load_dwordx4 a[180:183], v16, s[60:63], s4 offen sc1
  v_fma_f32 v36, v36, s74, s74
  v_fma_f32 v39, v39, s74, s74
  v_fma_f32 v120, v120, s74, s74
  v_fma_f32 v121, v121, s74, s74
  ds_read_b128 v[100:103], v23 offset:43008
  v_mfma_f32_32x32x16_bf16 v[68:83], v[148:151], v[104:107], v[68:83]
  buffer_load_dword v7, v14, s[60:63], s19 offen sc1
  v_rcp_f32 v36, v36
  v_rcp_f32 v39, v39
  v_rcp_f32 v120, v120
  ds_read_b128 v[104:107], v23 offset:44032
  s_waitcnt lgkmcnt(4)
  v_mfma_f32_32x32x16_bf16 v[68:83], v[152:155], v[84:87], v[68:83]
  buffer_load_dwordx4 a[184:187], v15, s[60:63], s4 offen offset:2048 sc1
  v_rcp_f32 v121, v121
  v_mul_f32 v36, v36, v40
  v_mul_f32 v39, v39, v41
  v_mul_f32 v120, v120, v42
  ds_read_b128 v[84:87], v23 offset:45056
  v_mfma_f32_32x32x16_bf16 v[68:83], v[156:159], v[88:91], v[68:83]
  buffer_load_dword v8, v2, s[60:63], 0 offen sc1
  v_mul_f32 v121, v121, v43
  v_cvt_pk_bf16_f32 v56, v36, v39
  v_cvt_pk_bf16_f32 v57, v120, v121
  v_mul_f32 v44, v44, v26
  ds_read_b128 v[88:91], v23 offset:46080
  s_waitcnt lgkmcnt(4)
  v_mfma_f32_32x32x16_bf16 v[68:83], v[160:163], v[92:95], v[68:83]
  buffer_load_dwordx4 a[188:191], v16, s[60:63], s4 offen offset:2048 sc1
  v_mul_f32 v45, v45, v26
  v_mul_f32 v46, v46, v26
  v_mul_f32 v47, v47, v26
  v_fma_f32 v36, v44, v44, s72
  ds_read_b128 v[92:95], v23 offset:47104
  v_mfma_f32_32x32x16_bf16 v[68:83], v[164:167], v[96:99], v[68:83]
  s_waitcnt vmcnt(7)
  s_mov_b64 exec, 1
  buffer_store_dword v10, v9, s[60:63], s6 offen
  s_mov_b64 exec, -1
  s_add_u32 s6, s6, s18
  v_fma_f32 v39, v45, v45, s72
  v_fma_f32 v120, v46, v46, s72
  v_fma_f32 v121, v47, v47, s72
  v_mul_f32 v36, v36, v44
  ds_read_b128 v[96:99], v23 offset:48128
  s_waitcnt lgkmcnt(4)
  v_mfma_f32_32x32x16_bf16 v[68:83], v[168:171], v[100:103], v[68:83]
  s_lshl_b32 s82, s66, 10
  s_lshl_b32 s84, s66, 4
  s_add_u32 s83, s84, 0x10000
  buffer_load_dwordx2 v[108:109], v12, s[60:63], s84 offen sc1
  v_mul_f32 v39, v39, v45
  v_mul_f32 v120, v120, v46
  v_mul_f32 v121, v121, v47
  ds_read_b128 v[100:103], v23 offset:49152
  v_mfma_f32_32x32x16_bf16 v[68:83], v[172:175], v[104:107], v[68:83]
  v_exp_f32 v36, v36
  v_exp_f32 v39, v39
  v_exp_f32 v120, v120
  v_exp_f32 v121, v121
  ds_read_b128 v[104:107], v23 offset:50176
  s_waitcnt lgkmcnt(4)
  v_mfma_f32_32x32x16_bf16 v[68:83], v[176:179], v[84:87], v[68:83]
  buffer_load_dwordx2 v[110:111], v12, s[60:63], s83 offen sc1
  v_fma_f32 v36, v36, s74, s74
  v_fma_f32 v39, v39, s74, s74
  v_fma_f32 v120, v120, s74, s74
  v_fma_f32 v121, v121, s74, s74
  ds_read_b128 v[84:87], v23 offset:51200
  v_mfma_f32_32x32x16_bf16 v[68:83], v[180:183], v[88:91], v[68:83]
  v_rcp_f32 v36, v36
  v_rcp_f32 v39, v39
  v_rcp_f32 v120, v120
  v_rcp_f32 v121, v121
  ds_read_b128 v[88:91], v23 offset:52224
  s_waitcnt lgkmcnt(4)
  v_mfma_f32_32x32x16_bf16 v[68:83], v[184:187], v[92:95], v[68:83]
  s_lshl_b32 s82, s67, 10
  s_lshl_b32 s84, s67, 4
  s_add_u32 s83, s84, 0x10000
  buffer_load_dwordx2 v[112:113], v12, s[60:63], s84 offen sc1
  v_mul_f32 v36, v36, v44
  v_mul_f32 v39, v39, v45
  v_mul_f32 v120, v120, v46
  v_mul_f32 v121, v121, v47
  ds_read_b128 v[92:95], v23 offset:53248
  v_mfma_f32_32x32x16_bf16 v[68:83], v[188:191], v[96:99], v[68:83]
  v_cvt_pk_bf16_f32 v58, v36, v39
  v_cvt_pk_bf16_f32 v59, v120, v121
  buffer_store_dwordx4 v[56:59], v38, s[60:63], s13 offen sc1
  ds_read_b128 v[96:99], v23 offset:54272
  s_waitcnt lgkmcnt(4)
  v_mfma_f32_32x32x16_bf16 v[68:83], v[192:195], v[100:103], v[68:83]
  buffer_load_dwordx2 v[114:115], v12, s[60:63], s83 offen sc1
  v_mul_f32 v48, v48, v26
  v_mul_f32 v49, v49, v26
  v_mul_f32 v50, v50, v26
  v_mul_f32 v51, v51, v26
  ds_read_b128 v[100:103], v23 offset:55296
  v_mfma_f32_32x32x16_bf16 v[68:83], v[196:199], v[104:107], v[68:83]
  s_waitcnt vmcnt(9)
  v_cmp_ne_u32 vcc, s80, v7
  s_cbranch_vccz L_pd_17
  s_mov_b32 s86, 0x100000
L_poll_16:
  buffer_load_dword v7, v14, s[60:63], s19 offen sc1
  s_waitcnt vmcnt(0)
  v_cmp_ne_u32 vcc, s80, v7
  s_cbranch_vccz L_pd_17
  s_sub_u32 s86, s86, 1
  s_cbranch_scc0 L_poll_16
L_pd_17:
  s_waitcnt vmcnt(7)
  v_cmp_ne_u32 vcc, s80, v8
  s_cbranch_vccz L_pd_19
  s_mov_b32 s86, 0x100000
L_poll_18:
  buffer_load_dword v8, v2, s[60:63], 0 offen sc1
  s_waitcnt vmcnt(0)
  v_cmp_ne_u32 vcc, s80, v8
  s_cbranch_vccz L_pd_19
  s_sub_u32 s86, s86, 1
  s_cbranch_scc0 L_poll_18
L_pd_19:
  s_lshl_b32 s81, s3, 11
  s_add_u32 m0, s81, 0xc000
  s_lshl_b32 s81, s66, 1
  buffer_load_dwordx4 v13, s[60:63], s81 offen sc1 lds
  s_lshl_b32 s81, s3, 11
  s_add_u32 m0, s81, 0xc400
  s_lshl_b32 s81, s67, 1
  buffer_load_dwordx4 v13, s[60:63], s81 offen sc1 lds
  v_fma_f32 v36, v48, v48, s72
  v_fma_f32 v39, v49, v49, s72
  v_fma_f32 v120, v50, v50, s72
  v_fma_f32 v121, v51, v51, s72
  ds_read_b128 v[104:107], v23 offset:56320
  s_waitcnt lgkmcnt(4)
  v_mfma_f32_32x32x16_bf16 v[68:83], v[200:203], v[84:87], v[68:83]
  v_mul_f32 v36, v36, v48
  v_mul_f32 v39, v39, v49
  v_mul_f32 v120, v120, v50
  v_mul_f32 v121, v121, v51
  ds_read_b128 v[84:87], v23 offset:57344
  v_mfma_f32_32x32x16_bf16 v[68:83], v[204:207], v[88:91], v[68:83]
  buffer_load_dwordx4 v[128:131], v38, s[60:63], s24 offen sc1
  v_exp_f32 v36, v36
  v_exp_f32 v39, v39
  v_exp_f32 v120, v120
  v_exp_f32 v121, v121
  ds_read_b128 v[88:91], v23 offset:58368
  s_waitcnt lgkmcnt(4)
  v_mfma_f32_32x32x16_bf16 v[68:83], v[208:211], v[92:95], v[68:83]
  v_fma_f32 v36, v36, s74, s74
  v_fma_f32 v39, v39, s74, s74
  v_fma_f32 v120, v120, s74, s74
  v_fma_f32 v121, v121, s74, s74
  ds_read_b128 v[92:95], v23 offset:59392
  v_mfma_f32_32x32x16_bf16 v[68:83], v[212:215], v[96:99], v[68:83]
  buffer_load_dwordx4 v[132:135], v38, s[60:63], s24 offen offset:1024 sc1
  v_rcp_f32 v36, v36
  v_rcp_f32 v39, v39
  v_rcp_f32 v120, v120
  ds_read_b128 v[96:99], v23 offset:60416
  s_waitcnt lgkmcnt(4)
  v_mfma_f32_32x32x16_bf16 v[68:83], v[216:219], v[100:103], v[68:83]
  v_rcp_f32 v121, v121
  v_mul_f32 v36, v36, v48
  v_mul_f32 v39, v39, v49
  v_mul_f32 v120, v120, v50
  ds_read_b128 v[100:103], v23 offset:61440
  v_mfma_f32_32x32x16_bf16 v[68:83], v[220:223], v[104:107], v[68:83]
  buffer_load_dwordx4 v[136:139], v38, s[60:63], s24 offen offset:2048 sc1
  v_mul_f32 v121, v121, v51
  v_cvt_pk_bf16_f32 v60, v36, v39
  v_cvt_pk_bf16_f32 v61, v120, v121
  v_mul_f32 v52, v52, v26
  ds_read_b128 v[104:107], v23 offset:62464
  s_waitcnt lgkmcnt(4)
  v_mfma_f32_32x32x16_bf16 v[68:83], v[224:227], v[84:87], v[68:83]
  v_mul_f32 v53, v53, v26
  v_mul_f32 v54, v54, v26
  v_mul_f32 v55, v55, v26
  v_fma_f32 v36, v52, v52, s72
  ds_read_b128 v[84:87], v23 offset:63488
  v_mfma_f32_32x32x16_bf16 v[68:83], v[228:231], v[88:91], v[68:83]
  buffer_load_dwordx4 v[140:143], v38, s[60:63], s24 offen offset:3072 sc1
  v_fma_f32 v39, v53, v53, s72
  v_fma_f32 v120, v54, v54, s72
  v_fma_f32 v121, v55, v55, s72
  v_mul_f32 v36, v36, v52
  ds_read_b128 v[88:91], v23 offset:64512
  s_waitcnt lgkmcnt(4)
  v_mfma_f32_32x32x16_bf16 v[68:83], v[232:235], v[92:95], v[68:83]
  v_mul_f32 v39, v39, v53
  v_mul_f32 v120, v120, v54
  v_mul_f32 v121, v121, v55
  v_mfma_f32_32x32x16_bf16 v[68:83], v[236:239], v[96:99], v[68:83]
  s_add_u32 s24, s24, 0x1000
  buffer_load_dwordx4 v[144:147], v38, s[60:63], s24 offen sc1
  v_exp_f32 v36, v36
  v_exp_f32 v39, v39
  v_exp_f32 v120, v120
  v_exp_f32 v121, v121
  s_waitcnt lgkmcnt(2)
  v_mfma_f32_32x32x16_bf16 v[68:83], v[240:243], v[100:103], v[68:83]
  v_fma_f32 v36, v36, s74, s74
  v_fma_f32 v39, v39, s74, s74
  v_fma_f32 v120, v120, s74, s74
  v_fma_f32 v121, v121, s74, s74
  v_mfma_f32_32x32x16_bf16 v[68:83], v[244:247], v[104:107], v[68:83]
  buffer_load_dwordx4 v[148:151], v38, s[60:63], s24 offen offset:1024 sc1
  v_rcp_f32 v36, v36
  v_rcp_f32 v39, v39
  v_rcp_f32 v120, v120
  v_rcp_f32 v121, v121
  s_waitcnt lgkmcnt(0)
  v_mfma_f32_32x32x16_bf16 v[68:83], v[248:251], v[84:87], v[68:83]
  v_mul_f32 v36, v36, v52
  v_mul_f32 v39, v39, v53
  v_mul_f32 v120, v120, v54
  v_mul_f32 v121, v121, v55
  v_mfma_f32_32x32x16_bf16 v[68:83], v[252:255], v[88:91], v[68:83]
  buffer_load_dwordx4 v[152:155], v38, s[60:63], s24 offen offset:2048 sc1
  v_cvt_pk_bf16_f32 v62, v36, v39
  v_cvt_pk_bf16_f32 v63, v120, v121
  buffer_store_dwordx4 v[60:63], v38, s[60:63], s13 offen offset:1024 sc1
  s_add_u32 s13, s13, s17
L_tail_15:
  s_waitcnt vmcnt(7)
  v_mfma_f32_32x32x16_bf16 v[192:207], a[0:3], v[128:131], 0
  buffer_load_dwordx4 v[156:159], v38, s[60:63], s24 offen offset:3072 sc1
  buffer_load_dword v7, v14, s[60:63], s20 offen sc1
  s_add_u32 s4, s4, 0x1000
  buffer_load_dwordx4 a[192:195], v15, s[60:63], s4 offen sc1
  v_mfma_f32_32x32x16_bf16 v[208:223], a[4:7], v[128:131], 0
  s_add_u32 s24, s24, 0x1000
  buffer_load_dwordx4 v[160:163], v38, s[60:63], s24 offen sc1
  v_mul_f32 v68, v68, v30
  v_mul_f32 v69, v69, v30
  v_mul_f32 v70, v70, v30
  v_mul_f32 v71, v71, v30
  v_fma_f32 v36, v68, v68, s72
  v_fma_f32 v39, v69, v69, s72
  s_waitcnt vmcnt(10)
  v_mfma_f32_32x32x16_bf16 v[192:207], a[8:11], v[132:135], v[192:207]
  buffer_load_dwordx4 v[164:167], v38, s[60:63], s24 offen offset:1024 sc1
  v_fma_f32 v120, v70, v70, s72
  v_fma_f32 v121, v71, v71, s72
  v_mul_f32 v36, v36, v68
  v_mul_f32 v39, v39, v69
  v_mul_f32 v120, v120, v70
  v_mul_f32 v121, v121, v71
  v_mfma_f32_32x32x16_bf16 v[208:223], a[12:15], v[132:135], v[208:223]
  buffer_load_dwordx4 v[168:171], v38, s[60:63], s24 offen offset:2048 sc1
  v_exp_f32 v36, v36
  v_exp_f32 v39, v39
  v_exp_f32 v120, v120
  v_exp_f32 v121, v121
  v_fma_f32 v36, v36, s74, s74
  v_fma_f32 v39, v39, s74, s74
  s_waitcnt vmcnt(11)
  v_mfma_f32_32x32x16_bf16 v[192:207], a[16:19], v[136:139], v[192:207]
  buffer_load_dwordx4 v[172:175], v38, s[60:63], s24 offen offset:3072 sc1
  v_fma_f32 v120, v120, s74, s74
  v_fma_f32 v121, v121, s74, s74
  v_rcp_f32 v36, v36
  v_rcp_f32 v39, v39
  v_rcp_f32 v120, v120
  v_rcp_f32 v121, v121
  buffer_load_dwordx4 a[196:199], v16, s[60:63], s4 offen sc1
  v_mfma_f32_32x32x16_bf16 v[208:223], a[20:23], v[136:139], v[208:223]
  s_add_u32 s24, s24, 0x1000
  buffer_load_dwordx4 v[176:179], v38, s[60:63], s24 offen sc1
  v_mul_f32 v36, v36, v68
  v_mul_f32 v39, v39, v69
  v_mul_f32 v120, v120, v70
  v_mul_f32 v121, v121, v71
  v_cvt_pk_bf16_f32 v56, v36, v39
  v_cvt_pk_bf16_f32 v57, v120, v121
  s_waitcnt vmcnt(13)
  v_mfma_f32_32x32x16_bf16 v[192:207], a[24:27], v[140:143], v[192:207]
  v_mul_f32 v72, v72, v30
  v_mul_f32 v73, v73, v30
  v_mul_f32 v74, v74, v30
  v_mul_f32 v75, v75, v30
  v_fma_f32 v36, v72, v72, s72
  v_fma_f32 v39, v73, v73, s72
  v_mfma_f32_32x32x16_bf16 v[208:223], a[28:31], v[140:143], v[208:223]
  buffer_load_dwordx4 v[180:183], v38, s[60:63], s24 offen offset:1024 sc1
  v_fma_f32 v120, v74, v74, s72
  v_fma_f32 v121, v75, v75, s72
  v_mul_f32 v36, v36, v72
  v_mul_f32 v39, v39, v73
  v_mul_f32 v120, v120, v74
  v_mul_f32 v121, v121, v75
  s_waitcnt vmcnt(13)
  v_mfma_f32_32x32x16_bf16 v[192:207], a[32:35], v[144:147], v[192:207]
  v_exp_f32 v36, v36
  v_exp_f32 v39, v39
  v_exp_f32 v120, v120
  v_exp_f32 v121, v121
  v_fma_f32 v36, v36, s74, s74
  v_fma_f32 v39, v39, s74, s74
  s_waitcnt vmcnt(10)
  s_mov_b64 exec, 1
  buffer_store_dword v10, v9, s[60:63], s6 offen
  s_mov_b64 exec, -1
  s_add_u32 s6, s6, s18
  buffer_load_dwordx4 a[200:203], v15, s[60:63], s4 offen offset:2048 sc1
  v_mfma_f32_32x32x16_bf16 v[208:223], a[36:39], v[144:147], v[208:223]
  s_waitcnt vmcnt(10)
  v_cmp_ne_u32 vcc, s80, v7
  s_cbranch_vccz L_pd_21
  s_mov_b32 s86, 0x100000
L_poll_20:
  buffer_load_dword v7, v14, s[60:63], s20 offen sc1
  s_waitcnt vmcnt(0)
  v_cmp_ne_u32 vcc, s80, v7
  s_cbranch_vccz L_pd_21
  s_sub_u32 s86, s86, 1
  s_cbranch_scc0 L_poll_20
L_pd_21:
  buffer_load_dwordx4 v[184:187], v38, s[60:63], s25 offen sc1
  v_fma_f32 v120, v120, s74, s74
  v_fma_f32 v121, v121, s74, s74
  v_rcp_f32 v36, v36
  v_rcp_f32 v39, v39
  v_rcp_f32 v120, v120
  v_rcp_f32 v121, v121
  v_mfma_f32_32x32x16_bf16 v[192:207], a[40:43], v[148:151], v[192:207]
  v_mul_f32 v36, v36, v72
  v_mul_f32 v39, v39, v73
  v_mul_f32 v120, v120, v74
  v_mul_f32 v121, v121, v75
  v_cvt_pk_bf16_f32 v58, v36, v39
  v_cvt_pk_bf16_f32 v59, v120, v121
  v_mfma_f32_32x32x16_bf16 v[208:223], a[44:47], v[148:151], v[208:223]
  buffer_load_dwordx4 v[188:191], v38, s[60:63], s25 offen offset:1024 sc1
  buffer_store_dwordx4 v[56:59], v38, s[60:63], s13 offen
  v_mul_f32 v76, v76, v30
  v_mul_f32 v77, v77, v30
  v_mul_f32 v78, v78, v30
  v_mul_f32 v79, v79, v30
  v_fma_f32 v36, v76, v76, s72
  v_mfma_f32_32x32x16_bf16 v[192:207], a[48:51], v[152:155], v[192:207]
  v_fma_f32 v39, v77, v77, s72
  v_fma_f32 v120, v78, v78, s72
  v_fma_f32 v121, v79, v79, s72
  v_mul_f32 v36, v36, v76
  v_mul_f32 v39, v39, v77
  v_mul_f32 v120, v120, v78
  buffer_load_dwordx4 a[204:207], v16, s[60:63], s4 offen offset:2048 sc1
  v_mfma_f32_32x32x16_bf16 v[208:223], a[52:55], v[152:155], v[208:223]
  buffer_load_dwordx4 v[128:131], v38, s[60:63], s25 offen offset:2048 sc1
  v_mul_f32 v121, v121, v79
  v_exp_f32 v36, v36
  v_exp_f32 v39, v39
  v_exp_f32 v120, v120
  v_exp_f32 v121, v121
  v_fma_f32 v36, v36, s74, s74
  v_mfma_f32_32x32x16_bf16 v[192:207], a[56:59], v[156:159], v[192:207]
  v_fma_f32 v39, v39, s74, s74
  v_fma_f32 v120, v120, s74, s74
  v_fma_f32 v121, v121, s74, s74
  v_rcp_f32 v36, v36
  v_rcp_f32 v39, v39
  v_rcp_f32 v120, v120
  v_mfma_f32_32x32x16_bf16 v[208:223], a[60:63], v[156:159], v[208:223]
  buffer_load_dwordx4 v[132:135], v38, s[60:63], s25 offen offset:3072 sc1
  v_rcp_f32 v121, v121
  v_mul_f32 v36, v36, v76
  v_mul_f32 v39, v39, v77
  v_mul_f32 v120, v120, v78
  v_mul_f32 v121, v121, v79
  v_cvt_pk_bf16_f32 v60, v36, v39
  s_waitcnt vmcnt(14)
  v_mfma_f32_32x32x16_bf16 v[192:207], a[64:67], v[160:163], v[192:207]
  v_cvt_pk_bf16_f32 v61, v120, v121
  v_mul_f32 v80, v80, v30
  v_mul_f32 v81, v81, v30
  v_mul_f32 v82, v82, v30
  v_mul_f32 v83, v83, v30
  v_fma_f32 v36, v80, v80, s72
  s_add_u32 s4, s4, 0x1000
  buffer_load_dwordx4 a[208:211], v15, s[60:63], s4 offen sc1
  v_mfma_f32_32x32x16_bf16 v[208:223], a[68:71], v[160:163], v[208:223]
  s_add_u32 s25, s25, 0x1000
  buffer_load_dwordx4 v[136:139], v38, s[60:63], s25 offen sc1
  v_fma_f32 v39, v81, v81, s72
  v_fma_f32 v120, v82, v82, s72
  v_fma_f32 v121, v83, v83, s72
  v_mul_f32 v36, v36, v80
  v_mul_f32 v39, v39, v81
  v_mul_f32 v120, v120, v82
  s_waitcnt vmcnt(15)
  v_mfma_f32_32x32x16_bf16 v[192:207], a[72:75], v[164:167], v[192:207]
  v_mul_f32 v121, v121, v83
  v_exp_f32 v36, v36
  v_exp_f32 v39, v39
  v_exp_f32 v120, v120
  v_exp_f32 v121, v121
  v_fma_f32 v36, v36, s74, s74
  v_mfma_f32_32x32x16_bf16 v[208:223], a[76:79], v[164:167], v[208:223]
  buffer_load_dwordx4 v[140:143], v38, s[60:63], s25 offen offset:1024 sc1
  v_fma_f32 v39, v39, s74, s74
  v_fma_f32 v120, v120, s74, s74
  v_fma_f32 v121, v121, s74, s74
  v_rcp_f32 v36, v36
  v_rcp_f32 v39, v39
  v_rcp_f32 v120, v120
  s_waitcnt vmcnt(15)
  v_mfma_f32_32x32x16_bf16 v[192:207], a[80:83], v[168:171], v[192:207]
  v_rcp_f32 v121, v121
  v_mul_f32 v36, v36, v80
  v_mul_f32 v39, v39, v81
  v_mul_f32 v120, v120, v82
  v_mul_f32 v121, v121, v83
  v_cvt_pk_bf16_f32 v62, v36, v39
  buffer_load_dwordx4 a[212:215], v16, s[60:63], s4 offen sc1
  v_mfma_f32_32x32x16_bf16 v[208:223], a[84:87], v[168:171], v[208:223]
  buffer_load_dwordx4 v[144:147], v38, s[60:63], s25 offen offset:2048 sc1
  v_cvt_pk_bf16_f32 v63, v120, v121
  buffer_store_dwordx4 v[60:63], v38, s[60:63], s13 offen offset:1024
  s_waitcnt vmcnt(17)
  v_mfma_f32_32x32x16_bf16 v[192:207], a[88:91], v[172:175], v[192:207]
  v_mfma_f32_32x32x16_bf16 v[208:223], a[92:95], v[172:175], v[208:223]
  buffer_load_dwordx4 v[148:151], v38, s[60:63], s25 offen offset:3072 sc1
  s_waitcnt vmcnt(16)
  v_mfma_f32_32x32x16_bf16 v[192:207], a[96:99], v[176:179], v[192:207]
  buffer_load_dwordx4 a[216:219], v15, s[60:63], s4 offen offset:2048 sc1
  v_mfma_f32_32x32x16_bf16 v[208:223], a[100:103], v[176:179], v[208:223]
  s_add_u32 s25, s25, 0x1000
  buffer_load_dwordx4 v[152:155], v38, s[60:63], s25 offen sc1
  buffer_load_dword v8, v14, s[60:63], s21 offen sc1
  s_waitcnt vmcnt(18)
  v_mfma_f32_32x32x16_bf16 v[192:207], a[104:107], v[180:183], v[192:207]
  v_mfma_f32_32x32x16_bf16 v[208:223], a[108:111], v[180:183], v[208:223]
  buffer_load_dwordx4 v[156:159], v38, s[60:63], s25 offen offset:1024 sc1
  s_waitcnt vmcnt(16)
  v_mfma_f32_32x32x16_bf16 v[224:239], a[0:3], v[184:187], 0
  buffer_load_dwordx4 a[220:223], v16, s[60:63], s4 offen offset:2048 sc1
  v_mfma_f32_32x32x16_bf16 v[240:255], a[4:7], v[184:187], 0
  buffer_load_dwordx4 v[160:163], v38, s[60:63], s25 offen offset:2048 sc1
  s_waitcnt vmcnt(17)
  v_mfma_f32_32x32x16_bf16 v[224:239], a[8:11], v[188:191], v[224:239]
  s_waitcnt vmcnt(7)
  s_mov_b64 exec, 1
  buffer_store_dword v10, v9, s[60:63], s6 offen
  s_mov_b64 exec, -1
  s_add_u32 s6, s6, s18
  v_mfma_f32_32x32x16_bf16 v[240:255], a[12:15], v[188:191], v[240:255]
  buffer_load_dwordx4 v[164:167], v38, s[60:63], s25 offen offset:3072 sc1
  v_mfma_f32_32x32x16_bf16 v[224:239], a[16:19], v[128:131], v[224:239]
  v_mfma_f32_32x32x16_bf16 v[240:255], a[20:23], v[128:131], v[240:255]
  s_add_u32 s25, s25, 0x1000
  buffer_load_dwordx4 v[168:171], v38, s[60:63], s25 offen sc1
  v_mfma_f32_32x32x16_bf16 v[224:239], a[24:27], v[132:135], v[224:239]
  v_mfma_f32_32x32x16_bf16 v[240:255], a[28:31], v[132:135], v[240:255]
  buffer_load_dwordx4 v[172:175], v38, s[60:63], s25 offen offset:1024 sc1
  v_mfma_f32_32x32x16_bf16 v[224:239], a[32:35], v[136:139], v[224:239]
  v_mfma_f32_32x32x16_bf16 v[240:255], a[36:39], v[136:139], v[240:255]
  s_waitcnt vmcnt(7)
  v_cmp_ne_u32 vcc, s80, v8
  s_cbranch_vccz L_pd_23
  s_mov_b32 s86, 0x100000
L_poll_22:
  buffer_load_dword v8, v14, s[60:63], s21 offen sc1
  s_waitcnt vmcnt(0)
  v_cmp_ne_u32 vcc, s80, v8
  s_cbranch_vccz L_pd_23
  s_sub_u32 s86, s86, 1
  s_cbranch_scc0 L_poll_22
L_pd_23:
  buffer_load_dwordx4 v[176:179], v38, s[60:63], s26 offen sc1
  v_mfma_f32_32x32x16_bf16 v[224:239], a[40:43], v[140:143], v[224:239]
  v_mfma_f32_32x32x16_bf16 v[240:255], a[44:47], v[140:143], v[240:255]
  buffer_load_dwordx4 v[180:183], v38, s[60:63], s26 offen offset:1024 sc1
  v_mfma_f32_32x32x16_bf16 v[224:239], a[48:51], v[144:147], v[224:239]
  v_mfma_f32_32x32x16_bf16 v[240:255], a[52:55], v[144:147], v[240:255]
  buffer_load_dwordx4 v[184:187], v38, s[60:63], s26 offen offset:2048 sc1
  v_mfma_f32_32x32x16_bf16 v[224:239], a[56:59], v[148:151], v[224:239]
  v_mfma_f32_32x32x16_bf16 v[240:255], a[60:63], v[148:151], v[240:255]
  buffer_load_dwordx4 v[188:191], v38, s[60:63], s26 offen offset:3072 sc1
  v_mfma_f32_32x32x16_bf16 v[224:239], a[64:67], v[152:155], v[224:239]
  v_mfma_f32_32x32x16_bf16 v[240:255], a[68:71], v[152:155], v[240:255]
  s_add_u32 s26, s26, 0x1000
  buffer_load_dwordx4 v[128:131], v38, s[60:63], s26 offen sc1
  s_waitcnt vmcnt(11)
  v_mfma_f32_32x32x16_bf16 v[224:239], a[72:75], v[156:159], v[224:239]
  v_mfma_f32_32x32x16_bf16 v[240:255], a[76:79], v[156:159], v[240:255]
  buffer_load_dwordx4 v[132:135], v38, s[60:63], s26 offen offset:1024 sc1
  s_waitcnt vmcnt(10)
  v_mfma_f32_32x32x16_bf16 v[224:239], a[80:83], v[160:163], v[224:239]
  v_mfma_f32_32x32x16_bf16 v[240:255], a[84:87], v[160:163], v[240:255]
  buffer_load_dwordx4 v[136:139], v38, s[60:63], s26 offen offset:2048 sc1
  s_waitcnt vmcnt(9)
  v_mfma_f32_32x32x16_bf16 v[224:239], a[88:91], v[164:167], v[224:239]
  v_mfma_f32_32x32x16_bf16 v[240:255], a[92:95], v[164:167], v[240:255]
  buffer_load_dwordx4 v[140:143], v38, s[60:63], s26 offen offset:3072 sc1
  s_waitcnt vmcnt(9)
  v_mfma_f32_32x32x16_bf16 v[224:239], a[96:99], v[168:171], v[224:239]
  v_mfma_f32_32x32x16_bf16 v[240:255], a[100:103], v[168:171], v[240:255]
  s_add_u32 s26, s26, 0x1000
  buffer_load_dwordx4 v[144:147], v38, s[60:63], s26 offen sc1
  buffer_load_dword v7, v14, s[60:63], s22 offen sc1
  s_waitcnt vmcnt(10)
  v_mfma_f32_32x32x16_bf16 v[224:239], a[104:107], v[172:175], v[224:239]
  v_mfma_f32_32x32x16_bf16 v[240:255], a[108:111], v[172:175], v[240:255]
  buffer_load_dwordx4 v[148:151], v38, s[60:63], s26 offen offset:1024 sc1
  s_waitcnt vmcnt(10)
  v_mfma_f32_32x32x16_bf16 v[224:239], a[112:115], v[176:179], v[224:239]
  v_mfma_f32_32x32x16_bf16 v[240:255], a[116:119], v[176:179], v[240:255]
  buffer_load_dwordx4 v[152:155], v38, s[60:63], s26 offen offset:2048 sc1
  s_waitcnt vmcnt(10)
  v_mfma_f32_32x32x16_bf16 v[224:239], a[120:123], v[180:183], v[224:239]
  v_mfma_f32_32x32x16_bf16 v[240:255], a[124:127], v[180:183], v[240:255]
  buffer_load_dwordx4 v[156:159], v38, s[60:63], s26 offen offset:3072 sc1
  s_waitcnt vmcnt(10)
  v_mfma_f32_32x32x16_bf16 v[224:239], a[128:131], v[184:187], v[224:239]
  v_mfma_f32_32x32x16_bf16 v[240:255], a[132:135], v[184:187], v[240:255]
  s_add_u32 s26, s26, 0x1000
  buffer_load_dwordx4 v[160:163], v38, s[60:63], s26 offen sc1
  s_waitcnt vmcnt(10)
  v_mfma_f32_32x32x16_bf16 v[224:239], a[136:139], v[188:191], v[224:239]
  v_mfma_f32_32x32x16_bf16 v[240:255], a[140:143], v[188:191], v[240:255]
  buffer_load_dwordx4 v[164:167], v38, s[60:63], s26 offen offset:1024 sc1
  s_waitcnt vmcnt(10)
  v_mfma_f32_32x32x16_bf16 v[224:239], a[144:147], v[128:131], v[224:239]
  v_mfma_f32_32x32x16_bf16 v[240:255], a[148:151], v[128:131], v[240:255]
  s_waitcnt vmcnt(5)
  v_cmp_ne_u32 vcc, s80, v7
  s_cbranch_vccz L_pd_25
  s_mov_b32 s86, 0x100000
L_poll_24:
  buffer_load_dword v7, v14, s[60:63], s22 offen sc1
  s_waitcnt vmcnt(0)
  v_cmp_ne_u32 vcc, s80, v7
  s_cbranch_vccz L_pd_25
  s_sub_u32 s86, s86, 1
  s_cbranch_scc0 L_poll_24
L_pd_25:
  buffer_load_dwordx4 v[168:171], v38, s[60:63], s27 offen sc1
  v_mfma_f32_32x32x16_bf16 v[224:239], a[152:155], v[132:135], v[224:239]
  v_mfma_f32_32x32x16_bf16 v[240:255], a[156:159], v[132:135], v[240:255]
  buffer_load_dwordx4 v[172:175], v38, s[60:63], s27 offen offset:1024 sc1
  v_mfma_f32_32x32x16_bf16 v[224:239], a[160:163], v[136:139], v[224:239]
  v_mfma_f32_32x32x16_bf16 v[240:255], a[164:167], v[136:139], v[240:255]
  buffer_load_dwordx4 v[176:179], v38, s[60:63], s27 offen offset:2048 sc1
  v_mfma_f32_32x32x16_bf16 v[224:239], a[168:171], v[140:143], v[224:239]
  v_mfma_f32_32x32x16_bf16 v[240:255], a[172:175], v[140:143], v[240:255]
  buffer_load_dwordx4 v[180:183], v38, s[60:63], s27 offen offset:3072 sc1
  v_mfma_f32_32x32x16_bf16 v[224:239], a[176:179], v[144:147], v[224:239]
  v_mfma_f32_32x32x16_bf16 v[240:255], a[180:183], v[144:147], v[240:255]
  s_add_u32 s27, s27, 0x1000
  buffer_load_dwordx4 v[184:187], v38, s[60:63], s27 offen sc1
  s_waitcnt vmcnt(9)
  v_mfma_f32_32x32x16_bf16 v[224:239], a[184:187], v[148:151], v[224:239]
  v_mfma_f32_32x32x16_bf16 v[240:255], a[188:191], v[148:151], v[240:255]
  buffer_load_dwordx4 v[188:191], v38, s[60:63], s27 offen offset:1024 sc1
  s_waitcnt vmcnt(9)
  v_mfma_f32_32x32x16_bf16 v[224:239], a[192:195], v[152:155], v[224:239]
  v_mfma_f32_32x32x16_bf16 v[240:255], a[196:199], v[152:155], v[240:255]
  buffer_load_dwordx4 v[128:131], v38, s[60:63], s27 offen offset:2048 sc1
  s_waitcnt vmcnt(9)
  v_mfma_f32_32x32x16_bf16 v[224:239], a[200:203], v[156:159], v[224:239]
  v_mfma_f32_32x32x16_bf16 v[240:255], a[204:207], v[156:159], v[240:255]
  buffer_load_dwordx4 v[132:135], v38, s[60:63], s27 offen offset:3072 sc1
  s_waitcnt vmcnt(9)
  v_mfma_f32_32x32x16_bf16 v[224:239], a[208:211], v[160:163], v[224:239]
  v_mfma_f32_32x32x16_bf16 v[240:255], a[212:215], v[160:163], v[240:255]
  s_add_u32 s27, s27, 0x1000
  buffer_load_dwordx4 v[136:139], v38, s[60:63], s27 offen sc1
  s_waitcnt vmcnt(9)
  v_mfma_f32_32x32x16_bf16 v[224:239], a[216:219], v[164:167], v[224:239]
  v_mfma_f32_32x32x16_bf16 v[240:255], a[220:223], v[164:167], v[240:255]
  buffer_load_dwordx4 v[140:143], v38, s[60:63], s27 offen offset:1024 sc1
  s_waitcnt vmcnt(9)
  v_mfma_f32_32x32x16_bf16 v[192:207], a[112:115], v[168:171], v[192:207]
  v_mfma_f32_32x32x16_bf16 v[208:223], a[116:119], v[168:171], v[208:223]
  buffer_load_dwordx4 v[144:147], v38, s[60:63], s27 offen offset:2048 sc1
  s_waitcnt vmcnt(9)
  v_mfma_f32_32x32x16_bf16 v[192:207], a[120:123], v[172:175], v[192:207]
  s_nop 4
  ds_write_b128 v18, v[240:243] offset:24576
  v_mfma_f32_32x32x16_bf16 v[208:223], a[124:127], v[172:175], v[208:223]
  buffer_load_dwordx4 v[148:151], v38, s[60:63], s27 offen offset:3072 sc1
  ds_write_b128 v18, v[244:247] offset:25600
  s_waitcnt vmcnt(9)
  v_mfma_f32_32x32x16_bf16 v[192:207], a[128:131], v[176:179], v[192:207]
  ds_write_b128 v19, v[232:235] offset:24576
  v_mfma_f32_32x32x16_bf16 v[208:223], a[132:135], v[176:179], v[208:223]
  s_add_u32 s27, s27, 0x1000
  buffer_load_dwordx4 v[152:155], v38, s[60:63], s27 offen sc1
  ds_write_b128 v19, v[236:239] offset:25600
  s_waitcnt vmcnt(9)
  v_mfma_f32_32x32x16_bf16 v[192:207], a[136:139], v[180:183], v[192:207]
  ds_write_b128 v20, v[248:251] offset:24576
  v_mfma_f32_32x32x16_bf16 v[208:223], a[140:143], v[180:183], v[208:223]
  buffer_load_dwordx4 v[156:159], v38, s[60:63], s27 offen offset:1024 sc1
  ds_write_b128 v20, v[252:255] offset:25600
  s_waitcnt vmcnt(9)
  v_mfma_f32_32x32x16_bf16 v[192:207], a[144:147], v[184:187], v[192:207]
  s_waitcnt lgkmcnt(0)
  s_barrier
  v_mfma_f32_32x32x16_bf16 v[208:223], a[148:151], v[184:187], v[208:223]
  ds_read_b128 v[84:87], v21 offset:24576
  ds_read_b128 v[88:91], v21 offset:25600
  ds_read_b128 v[92:95], v21 offset:26624
  ds_read_b128 v[96:99], v21 offset:27648
  s_waitcnt vmcnt(8)
  v_mfma_f32_32x32x16_bf16 v[192:207], a[152:155], v[188:191], v[192:207]
  ds_read_b128 v[100:103], v21 offset:28672
  ds_read_b128 v[104:107], v21 offset:29696
  s_mul_i32 s81, s67, 136
  v_add_u32 v6, s81, v11
  ds_read_b64 v[32:33], v6 offset:0
  ds_read_b64 v[34:35], v6 offset:16
  ds_read_b64_tr_b16 v[22:23], v17 offset:1024
  ds_read_b64_tr_b16 v[24:25], v17 offset:1536
  v_lshlrev_b32 v68, 16, v112
  v_mfma_f32_32x32x16_bf16 v[208:223], a[156:159], v[188:191], v[208:223]
  v_and_b32 v69, 0xffff0000, v112
  v_lshlrev_b32 v70, 16, v113
  v_and_b32 v71, 0xffff0000, v113
  v_lshlrev_b32 v72, 16, v114
  s_waitcnt vmcnt(7)
  v_mfma_f32_32x32x16_bf16 v[192:207], a[160:163], v[128:131], v[192:207]
  v_and_b32 v73, 0xffff0000, v114
  v_lshlrev_b32 v74, 16, v115
  v_and_b32 v75, 0xffff0000, v115
  v_add_f32 v224, v224, v68
  v_mfma_f32_32x32x16_bf16 v[208:223], a[164:167], v[128:131], v[208:223]
  v_add_f32 v225, v225, v69
  v_add_f32 v226, v226, v70
  v_add_f32 v227, v227, v71
  v_add_f32 v228, v228, v72
  s_waitcnt vmcnt(6)
  v_mfma_f32_32x32x16_bf16 v[192:207], a[168:171], v[132:135], v[192:207]
  v_add_f32 v229, v229, v73
  v_add_f32 v230, v230, v74
  v_add_f32 v231, v231, v75
  s_waitcnt lgkmcnt(9)
  v_mfma_f32_32x32x16_bf16 v[208:223], a[172:175], v[132:135], v[208:223]
  v_add_f32 v224, v224, v84
  v_add_f32 v225, v225, v85
  v_add_f32 v226, v226, v86
  v_add_f32 v227, v227, v87
  s_waitcnt vmcnt(5)
  v_mfma_f32_32x32x16_bf16 v[192:207], a[176:179], v[136:139], v[192:207]
  s_waitcnt lgkmcnt(8)
  v_add_f32 v228, v228, v88
  v_add_f32 v229, v229, v89
  v_add_f32 v230, v230, v90
  v_mfma_f32_32x32x16_bf16 v[208:223], a[180:183], v[136:139], v[208:223]
  v_add_f32 v231, v231, v91
  s_waitcnt lgkmcnt(7)
  v_add_f32 v224, v224, v92
  v_add_f32 v225, v225, v93
  s_waitcnt vmcnt(4)
  v_mfma_f32_32x32x16_bf16 v[192:207], a[184:187], v[140:143], v[192:207]
  v_add_f32 v226, v226, v94
  v_add_f32 v227, v227, v95
  s_waitcnt lgkmcnt(6)
  v_add_f32 v228, v228, v96
  v_mfma_f32_32x32x16_bf16 v[208:223], a[188:191], v[140:143], v[208:223]
  v_add_f32 v229, v229, v97
  v_add_f32 v230, v230, v98
  v_add_f32 v231, v231, v99
  s_waitcnt lgkmcnt(5)
  s_waitcnt vmcnt(3)
  v_mfma_f32_32x32x16_bf16 v[192:207], a[192:195], v[144:147], v[192:207]
  v_add_f32 v224, v224, v100
  v_add_f32 v225, v225, v101
  v_add_f32 v226, v226, v102
  v_add_f32 v227, v227, v103
  v_mfma_f32_32x32x16_bf16 v[208:223], a[196:199], v[144:147], v[208:223]
  s_waitcnt lgkmcnt(4)
  v_add_f32 v228, v228, v104
  v_add_f32 v229, v229, v105
  v_add_f32 v230, v230, v106
  s_waitcnt vmcnt(2)
  v_mfma_f32_32x32x16_bf16 v[192:207], a[200:203], v[148:151], v[192:207]
  v_add_f32 v231, v231, v107
  v_mul_f32 v76, s64, v224
  v_mul_f32 v77, s64, v225
  v_mul_f32 v78, s64, v226
  v_mfma_f32_32x32x16_bf16 v[208:223], a[204:207], v[148:151], v[208:223]
  v_mul_f32 v79, s64, v227
  v_mul_f32 v80, s64, v228
  v_mul_f32 v81, s64, v229
  v_mul_f32 v82, s64, v230
  s_waitcnt vmcnt(1)
  v_mfma_f32_32x32x16_bf16 v[192:207], a[208:211], v[152:155], v[192:207]
  v_mul_f32 v83, s64, v231
  v_exp_f32 v76, v76
  v_exp_f32 v77, v77
  v_exp_f32 v78, v78
  v_mfma_f32_32x32x16_bf16 v[208:223], a[212:215], v[152:155], v[208:223]
  v_exp_f32 v79, v79
  v_exp_f32 v80, v80
  v_exp_f32 v81, v81
  v_exp_f32 v82, v82
  s_waitcnt vmcnt(0)
  v_mfma_f32_32x32x16_bf16 v[192:207], a[216:219], v[156:159], v[192:207]
  v_exp_f32 v83, v83
  s_waitcnt lgkmcnt(0)
  v_lshlrev_b32 v68, 16, v22
  v_and_b32 v69, 0xffff0000, v22
  v_mfma_f32_32x32x16_bf16 v[208:223], a[220:223], v[156:159], v[208:223]
  v_lshlrev_b32 v70, 16, v23
  v_and_b32 v71, 0xffff0000, v23
  v_lshlrev_b32 v72, 16, v24
  v_and_b32 v73, 0xffff0000, v24
  s_nop 7
  ds_write_b128 v18, v[208:211] offset:0
  v_lshlrev_b32 v74, 16, v25
  v_and_b32 v75, 0xffff0000, v25
  v_add_f32 v76, 1.0, v76
  v_add_f32 v77, 1.0, v77
  ds_write_b128 v18, v[212:215] offset:1024
  v_add_f32 v78, 1.0, v78
  v_add_f32 v79, 1.0, v79
  v_add_f32 v80, 1.0, v80
  v_add_f32 v81, 1.0, v81
  ds_write_b128 v19, v[200:203] offset:0
  v_add_f32 v82, 1.0, v82
  v_add_f32 v83, 1.0, v83
  v_mul_f32 v224, v224, v68
  v_mul_f32 v225, v225, v69
  ds_write_b128 v19, v[204:207] offset:1024
  v_mul_f32 v226, v226, v70
  v_mul_f32 v227, v227, v71
  v_mul_f32 v228, v228, v72
  v_mul_f32 v229, v229, v73
  ds_write_b128 v20, v[216:219] offset:0
  v_mul_f32 v230, v230, v74
  v_mul_f32 v231, v231, v75
  v_rcp_f32 v76, v76
  v_rcp_f32 v77, v77
  ds_write_b128 v20, v[220:223] offset:1024
  v_rcp_f32 v78, v78
  v_rcp_f32 v79, v79
  v_rcp_f32 v80, v80
  v_rcp_f32 v81, v81
  s_waitcnt lgkmcnt(0)
  s_barrier
  v_rcp_f32 v82, v82
  v_rcp_f32 v83, v83
  v_lshlrev_b32 v68, 16, v32
  v_and_b32 v69, 0xffff0000, v32
  v_lshlrev_b32 v70, 16, v33
  v_and_b32 v71, 0xffff0000, v33
  v_lshlrev_b32 v72, 16, v34
  v_and_b32 v73, 0xffff0000, v34
  v_lshlrev_b32 v74, 16, v35
  v_and_b32 v75, 0xffff0000, v35
  v_fma_f32 v224, v224, v76, v68
  v_fma_f32 v225, v225, v77, v69
  v_fma_f32 v226, v226, v78, v70
  v_fma_f32 v227, v227, v79, v71
  v_fma_f32 v228, v228, v80, v72
  v_fma_f32 v229, v229, v81, v73
  v_fma_f32 v230, v230, v82, v74
  v_fma_f32 v231, v231, v83, v75
  v_cvt_pk_bf16_f32 v84, v224, v225
  v_cvt_pk_bf16_f32 v85, v226, v227
  v_cvt_pk_bf16_f32 v86, v228, v229
  v_cvt_pk_bf16_f32 v87, v230, v231
  s_lshl_b32 s82, s67, 10
  v_permlane32_swap_b32 v84, v86
  v_permlane32_swap_b32 v85, v87
  buffer_store_dwordx4 v[84:87], v3, s[56:59], s82 offen
  s_nop 1
  ds_read_b128 v[84:87], v21 offset:0
  ds_read_b128 v[88:91], v21 offset:1024
  ds_read_b128 v[92:95], v21 offset:2048
  ds_read_b128 v[96:99], v21 offset:3072
  ds_read_b128 v[100:103], v21 offset:4096
  ds_read_b128 v[104:107], v21 offset:5120
  s_mul_i32 s81, s66, 136
  v_add_u32 v6, s81, v11
  ds_read_b64 v[32:33], v6 offset:0
  ds_read_b64 v[34:35], v6 offset:16
  ds_read_b64_tr_b16 v[22:23], v17 offset:0
  ds_read_b64_tr_b16 v[24:25], v17 offset:512
  v_lshlrev_b32 v68, 16, v108
  v_and_b32 v69, 0xffff0000, v108
  v_lshlrev_b32 v70, 16, v109
  v_and_b32 v71, 0xffff0000, v109
  v_lshlrev_b32 v72, 16, v110
  v_and_b32 v73, 0xffff0000, v110
  v_lshlrev_b32 v74, 16, v111
  v_and_b32 v75, 0xffff0000, v111
  v_pk_add_f32 v[192:193], v[192:193], v[68:69]
  v_pk_add_f32 v[194:195], v[194:195], v[70:71]
  v_pk_add_f32 v[196:197], v[196:197], v[72:73]
  v_pk_add_f32 v[198:199], v[198:199], v[74:75]
  s_waitcnt lgkmcnt(9)
  v_pk_add_f32 v[192:193], v[192:193], v[84:85]
  v_pk_add_f32 v[194:195], v[194:195], v[86:87]
  s_waitcnt lgkmcnt(8)
  v_pk_add_f32 v[196:197], v[196:197], v[88:89]
  v_pk_add_f32 v[198:199], v[198:199], v[90:91]
  s_waitcnt lgkmcnt(7)
  v_pk_add_f32 v[192:193], v[192:193], v[92:93]
  v_pk_add_f32 v[194:195], v[194:195], v[94:95]
  s_waitcnt lgkmcnt(6)
  v_pk_add_f32 v[196:197], v[196:197], v[96:97]
  v_pk_add_f32 v[198:199], v[198:199], v[98:99]
  s_waitcnt lgkmcnt(5)
  v_pk_add_f32 v[192:193], v[192:193], v[100:101]
  v_pk_add_f32 v[194:195], v[194:195], v[102:103]
  s_waitcnt lgkmcnt(4)
  v_pk_add_f32 v[196:197], v[196:197], v[104:105]
  v_pk_add_f32 v[198:199], v[198:199], v[106:107]
  v_pk_mul_f32 v[76:77], v[192:193], s[64:65]
  v_pk_mul_f32 v[78:79], v[194:195], s[64:65]
  v_pk_mul_f32 v[80:81], v[196:197], s[64:65]
  v_pk_mul_f32 v[82:83], v[198:199], s[64:65]
  v_exp_f32 v76, v76
  v_exp_f32 v77, v77
  v_exp_f32 v78, v78
  v_exp_f32 v79, v79
  v_exp_f32 v80, v80
  v_exp_f32 v81, v81
  v_exp_f32 v82, v82
  v_exp_f32 v83, v83
  s_waitcnt lgkmcnt(0)
  v_lshlrev_b32 v68, 16, v22
  v_and_b32 v69, 0xffff0000, v22
  v_lshlrev_b32 v70, 16, v23
  v_and_b32 v71, 0xffff0000, v23
  v_lshlrev_b32 v72, 16, v24
  v_and_b32 v73, 0xffff0000, v24
  v_lshlrev_b32 v74, 16, v25
  v_and_b32 v75, 0xffff0000, v25
  v_pk_add_f32 v[76:77], v[76:77], 1.0 op_sel_hi:[1,0]
  v_pk_add_f32 v[78:79], v[78:79], 1.0 op_sel_hi:[1,0]
  v_pk_add_f32 v[80:81], v[80:81], 1.0 op_sel_hi:[1,0]
  v_pk_add_f32 v[82:83], v[82:83], 1.0 op_sel_hi:[1,0]
  v_pk_mul_f32 v[192:193], v[192:193], v[68:69]
  v_pk_mul_f32 v[194:195], v[194:195], v[70:71]
  v_pk_mul_f32 v[196:197], v[196:197], v[72:73]
  v_pk_mul_f32 v[198:199], v[198:199], v[74:75]
  v_rcp_f32 v76, v76
  v_rcp_f32 v77, v77
  v_rcp_f32 v78, v78
  v_rcp_f32 v79, v79
  v_rcp_f32 v80, v80
  v_rcp_f32 v81, v81
  v_rcp_f32 v82, v82
  v_rcp_f32 v83, v83
  v_lshlrev_b32 v68, 16, v32
  v_and_b32 v69, 0xffff0000, v32
  v_lshlrev_b32 v70, 16, v33
  v_and_b32 v71, 0xffff0000, v33
  v_lshlrev_b32 v72, 16, v34
  v_and_b32 v73, 0xffff0000, v34
  v_lshlrev_b32 v74, 16, v35
  v_and_b32 v75, 0xffff0000, v35
  v_pk_fma_f32 v[192:193], v[192:193], v[76:77], v[68:69]
  v_pk_fma_f32 v[194:195], v[194:195], v[78:79], v[70:71]
  v_pk_fma_f32 v[196:197], v[196:197], v[80:81], v[72:73]
  v_pk_fma_f32 v[198:199], v[198:199], v[82:83], v[74:75]
  v_cvt_pk_bf16_f32 v84, v192, v193
  v_cvt_pk_bf16_f32 v85, v194, v195
  v_cvt_pk_bf16_f32 v86, v196, v197
  v_cvt_pk_bf16_f32 v87, v198, v199
  s_lshl_b32 s82, s66, 10
  v_permlane32_swap_b32 v84, v86
  v_permlane32_swap_b32 v85, v87
  buffer_store_dwordx4 v[84:87], v3, s[56:59], s82 offen
  s_xor_b32 s81, s2, 0
  s_or_b32 s81, s81, s3
  s_cmp_lg_u32 s81, 0
  s_cbranch_scc1 L_fin
  v_lshrrev_b32 v6, 3, v1
  v_lshlrev_b32 v6, 9, v6
  v_and_b32 v7, 7, v1
  v_lshl_add_u32 v6, v7, 4, v6
  v_add_u32 v6, 0x5000, v6
  s_mov_b32 s86, 0x100000
L_gen_26:
  buffer_load_dwordx4 v[240:243], v6, s[60:63], 0 offen sc1
  s_waitcnt vmcnt(0)
  v_xor_b32 v240, s80, v240
  v_xor_b32 v241, s80, v241
  v_xor_b32 v242, s80, v242
  v_xor_b32 v243, s80, v243
  v_or3_b32 v240, v240, v241, v242
  v_or_b32 v240, v240, v243
  v_cmp_ne_u32 vcc, 0, v240
  s_cbranch_vccz L_gend_27
  s_sub_u32 s86, s86, 1
  s_cbranch_scc0 L_gen_26
L_gend_27:
  s_mov_b64 exec, 1
  buffer_store_dword v10, v9, s[60:63], 0 offen sc1
  s_mov_b64 exec, -1
  s_branch L_fin
L_p3skip_14:
  s_waitcnt vmcnt(1)
  s_mov_b64 exec, 1
  buffer_store_dword v10, v9, s[60:63], s7 offen sc1
  s_mov_b64 exec, -1
  s_and_b32 s82, s76, 1
  s_xor_b32 s83, s82, 1
  s_lshl_b32 s66, s82, 5
  s_lshl_b32 s67, s83, 5
  s_lshr_b32 s81, s78, 5
  s_mul_i32 s84, s81, 114688
  s_mul_i32 s85, s3, 28672
  s_add_u32 s84, s84, s85
  s_add_u32 s84, s84, 0x600000
  s_mul_i32 s24, s82, 129024
  s_add_u32 s24, s24, s84
  s_mul_i32 s25, s83, 114688
  s_mul_i32 s85, s82, 14336
  s_add_u32 s25, s25, s85
  s_add_u32 s25, s25, s84
  s_mul_i32 s26, s83, 129024
  s_add_u32 s26, s26, s84
  s_mul_i32 s27, s82, 114688
  s_mul_i32 s85, s83, 14336
  s_add_u32 s27, s27, s85
  s_add_u32 s27, s27, s84
  s_lshr_b32 s81, s78, 7
  s_lshl_b32 s84, s81, 10
  s_lshl_b32 s85, s3, 5
  s_add_u32 s84, s84, s85
  s_add_u32 s84, s84, 0x8000
  v_min_u32 v6, 6, v1
  v_lshl_add_u32 v14, v6, 2, s84
  s_mul_i32 s19, s82, 896
  s_mul_i32 s20, s82, 384
  s_add_u32 s20, s20, 0x100
  s_lshl_b32 s21, s82, 7
  s_add_u32 s21, s21, 0x180
  s_mul_i32 s22, s82, 640
  s_add_u32 s22, s22, 0x80
  s_lshl_b32 s81, s78, 10
  s_lshl_b32 s85, s77, 7
  s_add_u32 s81, s81, s85
  s_lshl_b32 s85, s90, 6
  s_add_u32 s81, s81, s85
  s_lshl_b32 s85, s89, 5
  s_add_u32 s81, s81, s85
  v_lshlrev_b32 v6, 10, v4
  v_add_u32 v6, s81, v6
  v_lshl_add_u32 v3, v5, 4, v6
  s_lshl_b32 s81, s90, 6
  s_lshl_b32 s85, s89, 5
  s_add_u32 s81, s81, s85
  s_add_u32 s81, s81, 0x24000
  v_mul_u32_u24 v11, 136, v4
  v_lshl_add_u32 v11, v5, 3, v11
  v_add_u32 v11, s81, v11
  s_lshl_b32 s81, s77, 18
  s_lshl_b32 s85, s90, 17
  s_add_u32 s81, s81, s85
  s_lshl_b32 s85, s89, 3
  s_add_u32 s81, s81, s85
  s_lshl_b32 s85, s78, 4
  s_add_u32 s81, s81, s85
  s_add_u32 s81, s81, 0x300000
  v_lshl_add_u32 v6, v5, 11, v4
  v_lshl_add_u32 v12, v6, 4, s81
  s_lshl_b32 s81, s77, 18
  s_lshl_b32 s85, s90, 17
  s_add_u32 s81, s81, s85
  s_lshl_b32 s85, s89, 16
  s_add_u32 s81, s81, s85
  s_lshl_b32 s85, s78, 1
  s_add_u32 s81, s81, s85
  s_add_u32 s81, s81, 0x1000000
  v_lshrrev_b32 v6, 2, v1
  v_lshlrev_b32 v6, 12, v6
  v_and_b32 v7, 3, v1
  v_lshl_add_u32 v6, v7, 4, v6
  v_add_u32 v13, s81, v6
  s_lshl_b32 s81, s3, 11
  s_add_u32 s81, s81, 0xc000
  v_add_u32 v17, s81, v37
  s_xor_b32 s81, s3, 1
  s_mul_i32 s82, s81, 6144
  v_add_u32 v18, s82, v38
  s_xor_b32 s81, s3, 2
  s_mul_i32 s82, s81, 6144
  s_add_u32 s82, s82, 0x800
  v_add_u32 v19, s82, v38
  s_xor_b32 s81, s3, 3
  s_mul_i32 s82, s81, 6144
  s_add_u32 s82, s82, 0x1000
  v_add_u32 v20, s82, v38
  s_mul_i32 s81, s3, 6144
  v_add_u32 v21, s81, v38
  s_lshr_b32 s82, s34, 2
  s_lshl_b32 s81, s77, 9
  s_lshl_b32 s85, s82, 8
  s_add_u32 s81, s81, s85
  s_lshl_b32 s85, s90, 6
  s_add_u32 s81, s81, s85
  s_lshl_b32 s85, s89, 5
  s_add_u32 s81, s81, s85
  s_add_u32 s81, s81, 0x5000
  v_bfe_u32 v6, v1, 3, 1
  v_and_b32 v7, 7, v1
  v_lshl_add_u32 v6, v6, 5, v7
  v_lshl_add_u32 v2, v6, 2, s81
  s_mov_b32 s64, 0xbfb8aa3b
  s_mov_b32 s65, 0xbfb8aa3b
  s_waitcnt vmcnt(0) lgkmcnt(0)
  s_barrier
  buffer_load_dwordx4 a[44:47], v16, s[60:63], s4 offen offset:2048 sc1
  s_add_u32 s4, s4, 0x1000
  buffer_load_dwordx4 a[48:51], v15, s[60:63], s4 offen sc1
  buffer_load_dwordx4 a[52:55], v16, s[60:63], s4 offen sc1
  buffer_load_dwordx4 a[56:59], v15, s[60:63], s4 offen offset:2048 sc1
  buffer_load_dwordx4 a[60:63], v16, s[60:63], s4 offen offset:2048 sc1
  s_add_u32 s4, s4, 0x1000
  buffer_load_dwordx4 a[64:67], v15, s[60:63], s4 offen sc1
  buffer_load_dwordx4 a[68:71], v16, s[60:63], s4 offen sc1
  buffer_load_dwordx4 a[72:75], v15, s[60:63], s4 offen offset:2048 sc1
  buffer_load_dwordx4 a[76:79], v16, s[60:63], s4 offen offset:2048 sc1
  s_add_u32 s4, s4, 0x1000
  buffer_load_dwordx4 a[80:83], v15, s[60:63], s4 offen sc1
  buffer_load_dwordx4 a[84:87], v16, s[60:63], s4 offen sc1
  buffer_load_dwordx4 a[88:91], v15, s[60:63], s4 offen offset:2048 sc1
  buffer_load_dwordx4 a[92:95], v16, s[60:63], s4 offen offset:2048 sc1
  s_add_u32 s4, s4, 0x1000
  buffer_load_dwordx4 a[96:99], v15, s[60:63], s4 offen sc1
  buffer_load_dwordx4 a[100:103], v16, s[60:63], s4 offen sc1
  buffer_load_dwordx4 a[104:107], v15, s[60:63], s4 offen offset:2048 sc1
  buffer_load_dwordx4 a[108:111], v16, s[60:63], s4 offen offset:2048 sc1
  s_mov_b32 s4, s9
  buffer_load_dwordx4 a[112:115], v15, s[60:63], s4 offen sc1
  buffer_load_dwordx4 a[116:119], v16, s[60:63], s4 offen sc1
  buffer_load_dwordx4 a[120:123], v15, s[60:63], s4 offen offset:2048 sc1
  buffer_load_dwordx4 a[124:127], v16, s[60:63], s4 offen offset:2048 sc1
  s_add_u32 s4, s4, 0x1000
  buffer_load_dwordx4 a[128:131], v15, s[60:63], s4 offen sc1
  buffer_load_dwordx4 a[132:135], v16, s[60:63], s4 offen sc1
  buffer_load_dwordx4 a[136:139], v15, s[60:63], s4 offen offset:2048 sc1
  buffer_load_dwordx4 a[140:143], v16, s[60:63], s4 offen offset:2048 sc1
  s_add_u32 s4, s4, 0x1000
  buffer_load_dwordx4 a[144:147], v15, s[60:63], s4 offen sc1
  buffer_load_dwordx4 a[148:151], v16, s[60:63], s4 offen sc1
  buffer_load_dwordx4 a[152:155], v15, s[60:63], s4 offen offset:2048 sc1
  buffer_load_dwordx4 a[156:159], v16, s[60:63], s4 offen offset:2048 sc1
  s_add_u32 s4, s4, 0x1000
  buffer_load_dwordx4 a[160:163], v15, s[60:63], s4 offen sc1
  buffer_load_dwordx4 a[164:167], v16, s[60:63], s4 offen sc1
  buffer_load_dwordx4 a[168:171], v15, s[60:63], s4 offen offset:2048 sc1
  buffer_load_dwordx4 a[172:175], v16, s[60:63], s4 offen offset:2048 sc1
  s_add_u32 s4, s4, 0x1000
  buffer_load_dwordx4 a[176:179], v15, s[60:63], s4 offen sc1
  buffer_load_dwordx4 a[180:183], v16, s[60:63], s4 offen sc1
  buffer_load_dwordx4 a[184:187], v15, s[60:63], s4 offen offset:2048 sc1
  buffer_load_dwordx4 a[188:191], v16, s[60:63], s4 offen offset:2048 sc1
  s_lshl_b32 s82, s66, 10
  s_lshl_b32 s84, s66, 4
  s_add_u32 s83, s84, 0x10000
  buffer_load_dwordx2 v[108:109], v12, s[60:63], s84 offen sc1
  buffer_load_dwordx2 v[110:111], v12, s[60:63], s83 offen sc1
  s_lshl_b32 s82, s67, 10
  s_lshl_b32 s84, s67, 4
  s_add_u32 s83, s84, 0x10000
  buffer_load_dwordx2 v[112:113], v12, s[60:63], s84 offen sc1
  buffer_load_dwordx2 v[114:115], v12, s[60:63], s83 offen sc1
  buffer_load_dword v8, v2, s[60:63], 0 offen sc1
  s_waitcnt vmcnt(0)
  v_cmp_ne_u32 vcc, s80, v8
  s_cbranch_vccz L_pd_29
  s_mov_b32 s86, 0x100000
L_poll_28:
  buffer_load_dword v8, v2, s[60:63], 0 offen sc1
  s_waitcnt vmcnt(0)
  v_cmp_ne_u32 vcc, s80, v8
  s_cbranch_vccz L_pd_29
  s_sub_u32 s86, s86, 1
  s_cbranch_scc0 L_poll_28
L_pd_29:
  s_lshl_b32 s81, s3, 11
  s_add_u32 m0, s81, 0xc000
  s_lshl_b32 s81, s66, 1
  buffer_load_dwordx4 v13, s[60:63], s81 offen sc1 lds
  s_lshl_b32 s81, s3, 11
  s_add_u32 m0, s81, 0xc400
  s_lshl_b32 s81, s67, 1
  buffer_load_dwordx4 v13, s[60:63], s81 offen sc1 lds
  buffer_load_dword v7, v14, s[60:63], s19 offen sc1
  s_waitcnt vmcnt(0)
  v_cmp_ne_u32 vcc, s80, v7
  s_cbranch_vccz L_pd_31
  s_mov_b32 s86, 0x100000
L_poll_30:
  buffer_load_dword v7, v14, s[60:63], s19 offen sc1
  s_waitcnt vmcnt(0)
  v_cmp_ne_u32 vcc, s80, v7
  s_cbranch_vccz L_pd_31
  s_sub_u32 s86, s86, 1
  s_cbranch_scc0 L_poll_30
L_pd_31:
  buffer_load_dwordx4 v[128:131], v38, s[60:63], s24 offen sc1
  buffer_load_dwordx4 v[132:135], v38, s[60:63], s24 offen offset:1024 sc1
  buffer_load_dwordx4 v[136:139], v38, s[60:63], s24 offen offset:2048 sc1
  buffer_load_dwordx4 v[140:143], v38, s[60:63], s24 offen offset:3072 sc1
  s_add_u32 s24, s24, 0x1000
  buffer_load_dwordx4 v[144:147], v38, s[60:63], s24 offen sc1
  buffer_load_dwordx4 v[148:151], v38, s[60:63], s24 offen offset:1024 sc1
  buffer_load_dwordx4 v[152:155], v38, s[60:63], s24 offen offset:2048 sc1
  s_waitcnt vmcnt(0) lgkmcnt(0)
  s_branch L_tail_15
L_slow:
  buffer_store_dwordx4 v[92:95], v46, s[60:63], s9 offen sc1
  buffer_store_dwordx4 v[96:99], v6, s[60:63], s9 offen sc1
  s_lshl_b32 s23, s3, 13
  s_waitcnt lgkmcnt(0)
  v_lshlrev_b32 v16, 16, v128
  v_and_b32 v17, 0xffff0000, v128
  v_pk_fma_f32 v[16:17], v[16:17], v[14:15], v[14:15] op_sel:[0,0,1] op_sel_hi:[1,0,1]
  v_cvt_pk_bf16_f32 v88, v16, v17
  v_lshlrev_b32 v12, 16, v129
  v_and_b32 v13, 0xffff0000, v129
  v_pk_fma_f32 v[12:13], v[12:13], v[14:15], v[14:15] op_sel:[0,0,1] op_sel_hi:[1,0,1]
  v_cvt_pk_bf16_f32 v89, v12, v13
  v_lshlrev_b32 v16, 16, v130
  v_and_b32 v17, 0xffff0000, v130
  v_pk_fma_f32 v[16:17], v[16:17], v[14:15], v[14:15] op_sel:[0,0,1] op_sel_hi:[1,0,1]
  v_cvt_pk_bf16_f32 v90, v16, v17
  v_lshlrev_b32 v12, 16, v131
  v_and_b32 v13, 0xffff0000, v131
  v_pk_fma_f32 v[12:13], v[12:13], v[14:15], v[14:15] op_sel:[0,0,1] op_sel_hi:[1,0,1]
  v_cvt_pk_bf16_f32 v91, v12, v13
  v_lshlrev_b32 v16, 16, v132
  v_and_b32 v17, 0xffff0000, v132
  v_pk_fma_f32 v[16:17], v[16:17], v[14:15], v[14:15] op_sel:[0,0,1] op_sel_hi:[1,0,1]
  v_cvt_pk_bf16_f32 v92, v16, v17
  v_lshlrev_b32 v12, 16, v133
  v_and_b32 v13, 0xffff0000, v133
  v_pk_fma_f32 v[12:13], v[12:13], v[14:15], v[14:15] op_sel:[0,0,1] op_sel_hi:[1,0,1]
  v_cvt_pk_bf16_f32 v93, v12, v13
  v_lshlrev_b32 v16, 16, v134
  v_and_b32 v17, 0xffff0000, v134
  v_pk_fma_f32 v[16:17], v[16:17], v[14:15], v[14:15] op_sel:[0,0,1] op_sel_hi:[1,0,1]
  v_cvt_pk_bf16_f32 v94, v16, v17
  v_lshlrev_b32 v12, 16, v135
  v_and_b32 v13, 0xffff0000, v135
  v_pk_fma_f32 v[12:13], v[12:13], v[14:15], v[14:15] op_sel:[0,0,1] op_sel_hi:[1,0,1]
  v_cvt_pk_bf16_f32 v95, v12, v13
  s_add_u32 s81, s23, 0x10000
  v_and_b32 v6, 3, v2
  v_lshlrev_b32 v6, 5, v6
  v_lshl_add_u32 v6, v2, 7, v6
  v_lshl_add_u32 v6, v3, 3, v6
  v_add_u32 v6, s81, v6
  ds_write_b64 v6, v[88:89]
  v_xor_b32 v7, 32, v6
  ds_write_b64 v7, v[90:91]
  v_xor_b32 v7, 64, v6
  ds_write_b64 v7, v[92:93]
  v_xor_b32 v7, 96, v6
  ds_write_b64 v7, v[94:95]
  v_bfe_u32 v7, v1, 2, 2
  v_xor_b32 v8, v7, v3
  v_lshlrev_b32 v8, 5, v8
  v_lshl_add_u32 v8, v7, 7, v8
  v_and_b32 v7, 3, v1
  v_lshl_add_u32 v8, v7, 3, v8
  v_add_u32 v20, s81, v8
  ds_read_b64_tr_b16 v[68:69], v20 offset:0
  ds_read_b64_tr_b16 v[72:73], v20 offset:512
  ds_read_b64_tr_b16 v[76:77], v20 offset:1024
  ds_read_b64_tr_b16 v[18:19], v20 offset:1536
  ds_read_b32 v96, v54
  ds_read_b32 v97, v55
  ds_read_b32 v98, v56
  ds_read_b32 v99, v57
  ds_read_b32 v100, v58
  ds_read_b32 v101, v59
  ds_read_b32 v102, v60
  ds_read_b32 v103, v61
  ds_read_b32 v104, v62
  ds_read_b32 v105, v63
  ds_read_b32 v106, v64
  v_mov_b32 v7, 0x24000
  ds_read_b128 v[108:111], v7 offset:0
  ds_read_b128 v[112:115], v7 offset:3072
  ds_read_b128 v[116:119], v7 offset:6144
  ds_read_b128 v[120:123], v7 offset:9216
  s_waitcnt vmcnt(0)
  s_mov_b64 exec, 1
  buffer_store_dword v10, v9, s[60:63], s4 offen sc1
  s_mov_b64 exec, -1
  s_lshr_b32 s83, s78, 6
  s_lshl_b32 s81, s83, 7
  s_add_u32 s81, s81, 0x1000
  v_lshl_add_u32 v14, v4, 2, s81
  s_lshl_b32 s81, s3, 11
  s_add_u32 s81, s81, 0x21800
  v_add_u32 v21, s81, v37
  v_mov_b32 v71, v10
  v_mov_b32 v75, v10
  v_mov_b32 v78, v10
  v_mov_b32 v79, v10
  v_lshrrev_b32 v6, 1, v0
  v_and_b32 v7, 1, v0
  v_mul_u32_u24 v8, 0x600, v6
  v_add_lshl_u32 v15, v8, v7, 4
  s_and_b32 s81, s87, 0x1fe
  s_lshl_b32 s24, s81, 4
  s_add_u32 s24, s24, 0x1600000
  s_add_u32 s25, s24, 0x2000
  s_add_u32 s26, s24, 0x4000
  s_waitcnt lgkmcnt(15)
  v_mov_b32 v70, v18
  v_mov_b32 v74, v19
  ds_read_b64_tr_b16 v[80:81], v21 offset:0
  ds_read_b64_tr_b16 v[82:83], v21 offset:512
  ds_read_b64_tr_b16 v[84:85], v21 offset:1024
  ds_read_b64_tr_b16 v[86:87], v21 offset:1536
  buffer_store_dwordx4 v[68:71], v38, s[60:63], s12 offen sc1
  s_add_u32 s12, s12, 0x2000
  buffer_store_dwordx4 v[72:75], v38, s[60:63], s12 offen sc1
  s_add_u32 s12, s12, 0x2000
  buffer_store_dwordx4 v[76:79], v38, s[60:63], s12 offen sc1
  s_waitcnt lgkmcnt(0)
  buffer_store_dwordx4 v[80:83], v38, s[60:63], s20 offen sc1
  buffer_store_dwordx4 v[84:87], v38, s[60:63], s20 offen offset:2048 sc1
  buffer_load_dword v18, v14, s[60:63], 0 offen sc1
  s_mov_b32 s82, 0x05040100
  s_mov_b32 s83, 0x07060302
  s_barrier
  ds_read_b64_tr_b16 a[0:1], v48 offset:0
  v_lshlrev_b32 v19, 4, v0
  ds_read_b64_tr_b16 a[2:3], v48 offset:512
  v_sub_u32 v19, 0x19020, v19
  ds_read_b64_tr_b16 a[4:5], v49 offset:0
  ds_read_b64_tr_b16 a[6:7], v49 offset:512
  v_perm_b32 v20, v102, v103, s82
  ds_read_b64_tr_b16 a[8:9], v50 offset:0
  v_perm_b32 v21, v100, v101, s82
  ds_read_b64_tr_b16 a[10:11], v50 offset:512
  v_perm_b32 v22, v98, v99, s82
  ds_read_b64_tr_b16 a[12:13], v51 offset:0
  v_perm_b32 v23, v96, v97, s82
  ds_read_b64_tr_b16 a[14:15], v51 offset:512
  ds_write_b128 v19, v[20:23] offset:0
  ds_read_b64_tr_b16 a[16:17], v48 offset:4096
  v_perm_b32 v32, v103, v104, s82
  ds_read_b64_tr_b16 a[18:19], v48 offset:4608
  v_perm_b32 v33, v101, v102, s82
  ds_read_b64_tr_b16 a[20:21], v49 offset:4096
  v_perm_b32 v34, v99, v100, s82
  ds_read_b64_tr_b16 a[22:23], v49 offset:4608
  v_perm_b32 v35, v97, v98, s82
  ds_read_b64_tr_b16 a[24:25], v50 offset:4096
  ds_write_b128 v19, v[32:35] offset:4416
  ds_read_b64_tr_b16 a[26:27], v50 offset:4608
  v_perm_b32 v20, v104, v105, s82
  ds_read_b64_tr_b16 a[28:29], v51 offset:4096
  v_perm_b32 v21, v102, v103, s82
  ds_read_b64_tr_b16 a[30:31], v51 offset:4608
  v_perm_b32 v22, v100, v101, s82
  ds_read_b64_tr_b16 a[32:33], v48 offset:8192
  v_perm_b32 v23, v98, v99, s82
  ds_read_b64_tr_b16 a[34:35], v48 offset:8704
  ds_write_b128 v19, v[20:23] offset:8832
  ds_read_b64_tr_b16 a[36:37], v49 offset:8192
  v_perm_b32 v32, v105, v106, s82
  ds_read_b64_tr_b16 a[38:39], v49 offset:8704
  v_perm_b32 v33, v103, v104, s82
  ds_read_b64_tr_b16 a[40:41], v50 offset:8192
  v_perm_b32 v34, v101, v102, s82
  ds_read_b64_tr_b16 a[42:43], v50 offset:8704
  v_perm_b32 v35, v99, v100, s82
  ds_read_b64_tr_b16 a[44:45], v51 offset:8192
  ds_write_b128 v19, v[32:35] offset:13248
  ds_read_b64_tr_b16 a[46:47], v51 offset:8704
  v_perm_b32 v20, v102, v103, s83
  ds_read_b64_tr_b16 a[48:49], v48 offset:12288
  v_perm_b32 v21, v100, v101, s83
  ds_read_b64_tr_b16 a[50:51], v48 offset:12800
  v_perm_b32 v22, v98, v99, s83
  ds_read_b64_tr_b16 a[52:53], v49 offset:12288
  v_perm_b32 v23, v96, v97, s83
  ds_read_b64_tr_b16 a[54:55], v49 offset:12800
  ds_write_b128 v19, v[20:23] offset:17456
  ds_read_b64_tr_b16 a[56:57], v50 offset:12288
  v_perm_b32 v32, v103, v104, s83
  ds_read_b64_tr_b16 a[58:59], v50 offset:12800
  v_perm_b32 v33, v101, v102, s83
  ds_read_b64_tr_b16 a[60:61], v51 offset:12288
  v_perm_b32 v34, v99, v100, s83
  ds_read_b64_tr_b16 a[62:63], v51 offset:12800
  v_perm_b32 v35, v97, v98, s83
  ds_read_b64_tr_b16 a[64:65], v48 offset:16384
  ds_write_b128 v19, v[32:35] offset:21872
  ds_read_b64_tr_b16 a[66:67], v48 offset:16896
  v_perm_b32 v20, v104, v105, s83
  ds_read_b64_tr_b16 a[68:69], v49 offset:16384
  v_perm_b32 v21, v102, v103, s83
  ds_read_b64_tr_b16 a[70:71], v49 offset:16896
  v_perm_b32 v22, v100, v101, s83
  ds_read_b64_tr_b16 a[72:73], v50 offset:16384
  v_perm_b32 v23, v98, v99, s83
  ds_read_b64_tr_b16 a[74:75], v50 offset:16896
  ds_write_b128 v19, v[20:23] offset:26288
  ds_read_b64_tr_b16 a[76:77], v51 offset:16384
  v_perm_b32 v32, v105, v106, s83
  ds_read_b64_tr_b16 a[78:79], v51 offset:16896
  v_perm_b32 v33, v103, v104, s83
  ds_read_b64_tr_b16 a[80:81], v48 offset:20480
  v_perm_b32 v34, v101, v102, s83
  ds_read_b64_tr_b16 a[82:83], v48 offset:20992
  v_perm_b32 v35, v99, v100, s83
  ds_read_b64_tr_b16 a[84:85], v49 offset:20480
  ds_write_b128 v19, v[32:35] offset:30704
  ds_read_b64_tr_b16 a[86:87], v49 offset:20992
  ds_read_b64_tr_b16 a[88:89], v50 offset:20480
  ds_read_b64_tr_b16 a[90:91], v50 offset:20992
  ds_read_b64_tr_b16 a[92:93], v51 offset:20480
  ds_read_b64_tr_b16 a[94:95], v51 offset:20992
  ds_read_b64_tr_b16 a[96:97], v48 offset:24576
  ds_read_b64_tr_b16 a[98:99], v48 offset:25088
  ds_read_b64_tr_b16 a[100:101], v49 offset:24576
  ds_read_b64_tr_b16 a[102:103], v49 offset:25088
  ds_read_b64_tr_b16 a[104:105], v50 offset:24576
  ds_read_b64_tr_b16 a[106:107], v50 offset:25088
  ds_read_b64_tr_b16 a[108:109], v51 offset:24576
  ds_read_b64_tr_b16 a[110:111], v51 offset:25088
  ds_read_b64_tr_b16 a[112:113], v48 offset:28672
  ds_read_b64_tr_b16 a[114:115], v48 offset:29184
  ds_read_b64_tr_b16 a[116:117], v49 offset:28672
  ds_read_b64_tr_b16 a[118:119], v49 offset:29184
  ds_read_b64_tr_b16 a[120:121], v50 offset:28672
  ds_read_b64_tr_b16 a[122:123], v50 offset:29184
  ds_read_b64_tr_b16 a[124:125], v51 offset:28672
  ds_read_b64_tr_b16 a[126:127], v51 offset:29184
  s_waitcnt vmcnt(0)
  v_cmp_ne_u32 vcc, s80, v18
  s_cbranch_vccz L_pd_33
  s_mov_b32 s86, 0x100000
L_poll_32:
  buffer_load_dword v18, v14, s[60:63], 0 offen sc1
  s_waitcnt vmcnt(0)
  v_cmp_ne_u32 vcc, s80, v18
  s_cbranch_vccz L_pd_33
  s_sub_u32 s86, s86, 1
  s_cbranch_scc0 L_poll_32
L_pd_33:
  s_add_u32 s27, s76, 0
  s_and_b32 s27, s27, 3
  s_lshl_b32 s27, s27, 19
  s_add_u32 s27, s27, 0x100000
  buffer_load_dwordx4 v[136:139], v47, s[60:63], s27 offen sc1
  s_add_u32 s27, s27, 0x20000
  buffer_load_dwordx4 v[140:143], v47, s[60:63], s27 offen sc1
  s_add_u32 s27, s27, 0x20000
  buffer_load_dwordx4 v[144:147], v47, s[60:63], s27 offen sc1
  s_add_u32 s27, s27, 0x20000
  buffer_load_dwordx4 v[148:151], v47, s[60:63], s27 offen sc1
  s_add_u32 s27, s76, 1
  s_and_b32 s27, s27, 3
  s_lshl_b32 s27, s27, 19
  s_add_u32 s27, s27, 0x100000
  buffer_load_dwordx4 v[152:155], v47, s[60:63], s27 offen sc1
  s_add_u32 s27, s27, 0x20000
  buffer_load_dwordx4 v[156:159], v47, s[60:63], s27 offen sc1
  s_add_u32 s27, s27, 0x20000
  buffer_load_dwordx4 v[160:163], v47, s[60:63], s27 offen sc1
  s_add_u32 s27, s27, 0x20000
  buffer_load_dwordx4 v[164:167], v47, s[60:63], s27 offen sc1
  ds_read_b64_tr_b16 a[128:129], v48 offset:32768
  ds_read_b64_tr_b16 a[130:131], v48 offset:33280
  v_add_f32 v108, v108, v112
  ds_read_b64_tr_b16 a[132:133], v49 offset:32768
  s_add_u32 s27, s76, 2
  s_and_b32 s27, s27, 3
  s_lshl_b32 s27, s27, 19
  s_add_u32 s27, s27, 0x100000
  buffer_load_dwordx4 v[168:171], v47, s[60:63], s27 offen sc1
  v_add_f32 v116, v116, v120
  ds_read_b64_tr_b16 a[134:135], v49 offset:33280
  v_add_f32 v109, v109, v113
  ds_read_b64_tr_b16 a[136:137], v50 offset:32768
  s_add_u32 s27, s27, 0x20000
  buffer_load_dwordx4 v[172:175], v47, s[60:63], s27 offen sc1
  v_add_f32 v117, v117, v121
  ds_read_b64_tr_b16 a[138:139], v50 offset:33280
  v_add_f32 v110, v110, v114
  ds_read_b64_tr_b16 a[140:141], v51 offset:32768
  s_add_u32 s27, s27, 0x20000
  buffer_load_dwordx4 v[176:179], v47, s[60:63], s27 offen sc1
  v_add_f32 v118, v118, v122
  ds_read_b64_tr_b16 a[142:143], v51 offset:33280
  v_add_f32 v111, v111, v115
  ds_read_b64_tr_b16 a[144:145], v48 offset:36864
  s_add_u32 s27, s27, 0x20000
  buffer_load_dwordx4 v[180:183], v47, s[60:63], s27 offen sc1
  v_add_f32 v119, v119, v123
  ds_read_b64_tr_b16 a[146:147], v48 offset:37376
  v_cmp_lt_u32 vcc, 3, v1
  ds_read_b64_tr_b16 a[148:149], v49 offset:36864
  s_add_u32 s27, s76, 3
  s_and_b32 s27, s27, 3
  s_lshl_b32 s27, s27, 19
  s_add_u32 s27, s27, 0x100000
  buffer_load_dwordx4 v[184:187], v47, s[60:63], s27 offen sc1
  v_cndmask_b32 v108, v108, v116, vcc
  ds_read_b64_tr_b16 a[150:151], v49 offset:37376
  v_cndmask_b32 v109, v109, v117, vcc
  ds_read_b64_tr_b16 a[152:153], v50 offset:36864
  s_add_u32 s27, s27, 0x20000
  buffer_load_dwordx4 v[188:191], v47, s[60:63], s27 offen sc1
  v_cndmask_b32 v110, v110, v118, vcc
  ds_read_b64_tr_b16 a[154:155], v50 offset:37376
  v_cndmask_b32 v111, v111, v119, vcc
  ds_read_b64_tr_b16 a[156:157], v51 offset:36864
  s_add_u32 s27, s27, 0x20000
  buffer_load_dwordx4 v[192:195], v47, s[60:63], s27 offen sc1
  v_cvt_pk_bf16_f32 v20, v108, 0
  ds_read_b64_tr_b16 a[158:159], v51 offset:37376
  v_cvt_pk_bf16_f32 v32, v109, v108
  ds_read_b64_tr_b16 a[160:161], v48 offset:40960
  s_add_u32 s27, s27, 0x20000
  buffer_load_dwordx4 v[196:199], v47, s[60:63], s27 offen sc1
  v_cvt_pk_bf16_f32 v33, v110, v109
  ds_read_b64_tr_b16 a[162:163], v48 offset:41472
  v_cvt_pk_bf16_f32 v34, v111, v110
  ds_read_b64_tr_b16 a[164:165], v49 offset:40960
  v_cndmask_b32 v21, 0, v20, s[68:69]
  ds_read_b64_tr_b16 a[166:167], v49 offset:41472
  v_cndmask_b32 v21, v21, v32, s[70:71]
  ds_read_b64_tr_b16 a[168:169], v50 offset:40960
  v_cndmask_b32 v20, v20, v32, s[66:67]
  ds_read_b64_tr_b16 a[170:171], v50 offset:41472
  v_cndmask_b32 v20, v20, v33, s[68:69]
  ds_read_b64_tr_b16 a[172:173], v51 offset:40960
  v_cndmask_b32 v20, v20, v34, s[70:71]
  ds_read_b64_tr_b16 a[174:175], v51 offset:41472
  v_mov_b32 v22, 0
  ds_read_b64_tr_b16 a[176:177], v48 offset:45056
  v_mov_b32 v23, 0
  ds_read_b64_tr_b16 a[178:179], v48 offset:45568
  v_and_b32 v6, 3, v1
  ds_read_b64_tr_b16 a[180:181], v49 offset:45056
  v_mul_u32_u24 v6, 4416, v6
  ds_read_b64_tr_b16 a[182:183], v49 offset:45568
  v_bfe_u32 v7, v1, 2, 1
  ds_read_b64_tr_b16 a[184:185], v50 offset:45056
  v_mul_u32_u24 v7, 17456, v7
  ds_read_b64_tr_b16 a[186:187], v50 offset:45568
  s_mov_b32 s82, 0x19030
  ds_read_b64_tr_b16 a[188:189], v51 offset:45056
  v_add3_u32 v6, v6, v7, s82
  ds_read_b64_tr_b16 a[190:191], v51 offset:45568
  s_mov_b64 exec, 0xff
  ds_write_b128 v6, v[20:23]
  s_mov_b64 exec, -1
  ds_read_b64_tr_b16 a[192:193], v48 offset:49152
  v_mov_b32 v32, 0
  ds_read_b64_tr_b16 a[194:195], v48 offset:49664
  v_mov_b32 v33, 0
  ds_read_b64_tr_b16 a[196:197], v49 offset:49152
  v_mov_b32 v34, 0
  ds_read_b64_tr_b16 a[198:199], v49 offset:49664
  v_mov_b32 v35, 0
  ds_read_b64_tr_b16 a[200:201], v50 offset:49152
  v_and_b32 v6, 7, v1
  ds_read_b64_tr_b16 a[202:203], v50 offset:49664
  v_min_u32 v6, 5, v6
  ds_read_b64_tr_b16 a[204:205], v51 offset:49152
  v_add_u32 v7, 257, v6
  ds_read_b64_tr_b16 a[206:207], v51 offset:49664
  v_cmp_gt_u32 vcc, 3, v6
  ds_read_b64_tr_b16 a[208:209], v48 offset:53248
  v_mul_u32_u24 v8, 17456, v5
  ds_read_b64_tr_b16 a[210:211], v48 offset:53760
  v_cndmask_b32 v6, v7, v6, vcc
  ds_read_b64_tr_b16 a[212:213], v49 offset:53248
  v_bfe_u32 v7, v1, 3, 2
  ds_read_b64_tr_b16 a[214:215], v49 offset:53760
  v_mul_u32_u24 v7, 4416, v7
  ds_read_b64_tr_b16 a[216:217], v50 offset:53248
  v_lshl_add_u32 v6, v6, 4, v7
  ds_read_b64_tr_b16 a[218:219], v50 offset:53760
  s_mov_b32 s82, 0x18000
  ds_read_b64_tr_b16 a[220:221], v51 offset:53248
  v_add3_u32 v6, v6, v8, s82
  ds_read_b64_tr_b16 a[222:223], v51 offset:53760
  ds_write_b128 v6, v[32:35]
  ds_read_b64_tr_b16 a[224:225], v48 offset:57344
  ds_read_b64_tr_b16 a[226:227], v48 offset:57856
  ds_read_b64_tr_b16 a[228:229], v49 offset:57344
  ds_read_b64_tr_b16 a[230:231], v49 offset:57856
  ds_read_b64_tr_b16 a[232:233], v50 offset:57344
  ds_read_b64_tr_b16 a[234:235], v50 offset:57856
  ds_read_b64_tr_b16 a[236:237], v51 offset:57344
  ds_read_b64_tr_b16 a[238:239], v51 offset:57856
  ds_read_b64_tr_b16 a[240:241], v48 offset:61440
  ds_read_b64_tr_b16 a[242:243], v48 offset:61952
  ds_read_b64_tr_b16 a[244:245], v49 offset:61440
  ds_read_b64_tr_b16 a[246:247], v49 offset:61952
  ds_read_b64_tr_b16 a[248:249], v50 offset:61440
  ds_read_b64_tr_b16 a[250:251], v50 offset:61952
  ds_read_b64_tr_b16 a[252:253], v51 offset:61440
  ds_read_b64_tr_b16 a[254:255], v51 offset:61952
  s_waitcnt lgkmcnt(0)
  s_barrier
  s_waitcnt vmcnt(15)
  v_mfma_f32_16x16x32_bf16 v[96:99], a[0:3], v[136:139], 0
  buffer_load_dwordx4 v[52:55], v15, s[60:63], s24 offen sc1
  buffer_load_dwordx4 v[56:59], v15, s[60:63], s25 offen sc1
  buffer_load_dwordx4 v[60:63], v15, s[60:63], s26 offen sc1
  s_mov_b64 exec, 1
  buffer_store_dword v10, v9, s[60:63], s8 offen sc1
  s_mov_b64 exec, -1
  v_lshrrev_b32 v6, 2, v1
  v_mul_u32_u24 v6, 3584, v6
  v_mfma_f32_16x16x32_bf16 v[100:103], a[4:7], v[136:139], 0
  v_and_b32 v7, 3, v1
  v_lshl_add_u32 v6, v7, 4, v6
  v_mfma_f32_16x16x32_bf16 v[104:107], a[8:11], v[136:139], 0
  s_lshl_b32 s82, s15, 6
  v_add_u32 v64, s82, v6
  v_mfma_f32_16x16x32_bf16 v[108:111], a[12:15], v[136:139], 0
  v_add_u32 v65, 0xdc00, v64
  v_add_u32 v66, 0x1b800, v64
  s_waitcnt vmcnt(18)
  v_mfma_f32_16x16x32_bf16 v[96:99], a[16:19], v[140:143], v[96:99]
  v_add_u32 v67, 0x29400, v64
  s_bfe_u32 s22, s14, 0x10007
  v_mfma_f32_16x16x32_bf16 v[100:103], a[20:23], v[140:143], v[100:103]
  s_lshl_b32 s22, s22, 1
  s_add_u32 s22, s22, s34
  s_add_u32 s27, s22, 0
  s_and_b32 s27, s27, 3
  s_mul_i32 s27, s27, 458752
  s_add_u32 m0, s23, 0x10000
  s_nop 0
  buffer_load_dwordx4 v64, s[48:51], s27 offen lds
  v_mfma_f32_16x16x32_bf16 v[104:107], a[24:27], v[140:143], v[104:107]
  s_mul_i32 s82, s3, 2176
  s_add_u32 s82, s82, 0x24000
  v_mfma_f32_16x16x32_bf16 v[108:111], a[28:31], v[140:143], v[108:111]
  v_mul_u32_u24 v6, 136, v2
  v_lshl_add_u32 v6, v3, 3, v6
  s_waitcnt vmcnt(18)
  v_mfma_f32_16x16x32_bf16 v[96:99], a[32:35], v[144:147], v[96:99]
  v_add_u32 v6, s82, v6
  ds_write_b64 v6, v[128:129] offset:0
  v_mfma_f32_16x16x32_bf16 v[100:103], a[36:39], v[144:147], v[100:103]
  ds_write_b64 v6, v[130:131] offset:32
  ds_write_b64 v6, v[132:133] offset:64
  v_mfma_f32_16x16x32_bf16 v[104:107], a[40:43], v[144:147], v[104:107]
  ds_write_b64 v6, v[134:135] offset:96
  v_subrev_u32 v6, 48, v1
  buffer_load_dwordx4 v65, s[48:51], s27 offen offset:1024 lds
  v_mfma_f32_16x16x32_bf16 v[108:111], a[44:47], v[144:147], v[108:111]
  v_min_u32 v7, 5, v6
  v_add_u32 v7, 432, v7
  s_waitcnt vmcnt(18)
  v_mfma_f32_16x16x32_bf16 v[96:99], a[48:51], v[148:151], v[96:99]
  v_cmp_gt_u32 vcc, 48, v1
  s_mul_i32 s82, s90, 7008
  v_mfma_f32_16x16x32_bf16 v[100:103], a[52:55], v[148:151], v[100:103]
  s_add_u32 s82, s82, 0x20860
  v_cndmask_b32 v6, v7, v1, vcc
  v_mfma_f32_16x16x32_bf16 v[104:107], a[56:59], v[148:151], v[104:107]
  v_lshl_add_u32 v6, v6, 4, s82
  ds_write_b128 v6, v[32:35]
  v_mfma_f32_16x16x32_bf16 v[108:111], a[60:63], v[148:151], v[108:111]
  s_mul_i32 s82, s89, 17456
  s_add_u32 s82, s82, 0x18030
  buffer_load_dwordx4 v66, s[48:51], s27 offen offset:2048 lds
  s_waitcnt vmcnt(18)
  v_mfma_f32_16x16x32_bf16 v[96:99], a[64:67], v[152:155], v[96:99]
  s_lshl_b32 s84, s90, 8
  s_sub_u32 s82, s82, s84
  v_mfma_f32_16x16x32_bf16 v[100:103], a[68:71], v[152:155], v[100:103]
  v_and_b32 v6, 3, v2
  v_mul_u32_u24 v6, 4416, v6
  v_mfma_f32_16x16x32_bf16 v[104:107], a[72:75], v[152:155], v[104:107]
  v_lshrrev_b32 v8, 2, v2
  v_sub_u32 v8, v3, v8
  v_mfma_f32_16x16x32_bf16 v[108:111], a[76:79], v[152:155], v[108:111]
  v_lshl_add_u32 v6, v8, 4, v6
  v_add_u32 v11, s82, v6
  s_waitcnt vmcnt(17)
  v_mfma_f32_16x16x32_bf16 v[96:99], a[80:83], v[156:159], v[96:99]
  s_mul_i32 s83, s89, 7008
  s_add_u32 s83, s83, 0x20860
  buffer_load_dwordx4 v67, s[48:51], s27 offen offset:3072 lds
  v_mfma_f32_16x16x32_bf16 v[100:103], a[84:87], v[156:159], v[100:103]
  s_mul_i32 s84, s90, 384
  s_sub_u32 s83, s83, s84
  v_mfma_f32_16x16x32_bf16 v[104:107], a[88:91], v[156:159], v[104:107]
  v_lshrrev_b32 v6, 1, v2
  v_mul_u32_u24 v6, 96, v6
  v_mfma_f32_16x16x32_bf16 v[108:111], a[92:95], v[156:159], v[108:111]
  v_and_b32 v8, 1, v2
  v_lshl_add_u32 v6, v8, 3, v6
  s_waitcnt vmcnt(17)
  v_mfma_f32_16x16x32_bf16 v[96:99], a[96:99], v[160:163], v[96:99]
  v_lshl_add_u32 v6, v3, 4, v6
  v_add_u32 v18, s83, v6
  v_mfma_f32_16x16x32_bf16 v[100:103], a[100:103], v[160:163], v[100:103]
  v_lshl_add_u32 v8, v3, 1, v8
  v_cmp_eq_u32 vcc, 7, v8
  s_add_u32 s27, s27, 0x38000
  s_add_u32 m0, s23, 0x11000
  s_nop 0
  buffer_load_dwordx4 v64, s[48:51], s27 offen lds
  v_mfma_f32_16x16x32_bf16 v[104:107], a[104:107], v[160:163], v[104:107]
  v_cndmask_b32 v8, 8, 40, vcc
  v_add_u32 v19, v18, v8
  v_mfma_f32_16x16x32_bf16 v[108:111], a[108:111], v[160:163], v[108:111]
  v_lshrrev_b32 v6, 1, v0
  v_and_b32 v7, 1, v0
  s_waitcnt vmcnt(17)
  v_mfma_f32_16x16x32_bf16 v[96:99], a[112:115], v[164:167], v[96:99]
  v_and_b32 v6, 1, v6
  v_mul_u32_u24 v7, 7008, v7
  v_mfma_f32_16x16x32_bf16 v[100:103], a[116:119], v[164:167], v[100:103]
  v_lshl_add_u32 v7, v6, 5, v7
  v_lshrrev_b32 v6, 2, v0
  v_mfma_f32_16x16x32_bf16 v[104:107], a[120:123], v[164:167], v[104:107]
  v_mul_u32_u24 v6, 96, v6
  s_mov_b32 s82, 0x20b60
  buffer_load_dwordx4 v65, s[48:51], s27 offen offset:1024 lds
  v_mfma_f32_16x16x32_bf16 v[108:111], a[124:127], v[164:167], v[108:111]
  v_add3_u32 v24, v6, v7, s82
  s_waitcnt vmcnt(17)
  v_mfma_f32_16x16x32_bf16 v[96:99], a[128:131], v[168:171], v[96:99]
  v_mfma_f32_16x16x32_bf16 v[100:103], a[132:135], v[168:171], v[100:103]
  v_mfma_f32_16x16x32_bf16 v[104:107], a[136:139], v[168:171], v[104:107]
  v_mfma_f32_16x16x32_bf16 v[108:111], a[140:143], v[168:171], v[108:111]
  buffer_load_dwordx4 v66, s[48:51], s27 offen offset:2048 lds
  s_waitcnt vmcnt(17)
  v_mfma_f32_16x16x32_bf16 v[96:99], a[144:147], v[172:175], v[96:99]
  v_mfma_f32_16x16x32_bf16 v[100:103], a[148:151], v[172:175], v[100:103]
  v_mfma_f32_16x16x32_bf16 v[104:107], a[152:155], v[172:175], v[104:107]
  v_mfma_f32_16x16x32_bf16 v[108:111], a[156:159], v[172:175], v[108:111]
  s_waitcnt vmcnt(16)
  v_mfma_f32_16x16x32_bf16 v[96:99], a[160:163], v[176:179], v[96:99]
  buffer_load_dwordx4 v67, s[48:51], s27 offen offset:3072 lds
  v_mfma_f32_16x16x32_bf16 v[100:103], a[164:167], v[176:179], v[100:103]
  v_mfma_f32_16x16x32_bf16 v[104:107], a[168:171], v[176:179], v[104:107]
  v_mfma_f32_16x16x32_bf16 v[108:111], a[172:175], v[176:179], v[108:111]
  s_waitcnt vmcnt(16)
  v_mfma_f32_16x16x32_bf16 v[96:99], a[176:179], v[180:183], v[96:99]
  v_mfma_f32_16x16x32_bf16 v[100:103], a[180:183], v[180:183], v[100:103]
  s_add_u32 s27, s22, 1
  s_and_b32 s27, s27, 3
  s_mul_i32 s27, s27, 458752
  s_add_u32 m0, s23, 0x0
  s_nop 0
  buffer_load_dwordx4 v64, s[48:51], s27 offen lds
  v_mfma_f32_16x16x32_bf16 v[104:107], a[184:187], v[180:183], v[104:107]
  v_mfma_f32_16x16x32_bf16 v[108:111], a[188:191], v[180:183], v[108:111]
  s_waitcnt vmcnt(16)
  v_mfma_f32_16x16x32_bf16 v[96:99], a[192:195], v[184:187], v[96:99]
  v_mfma_f32_16x16x32_bf16 v[100:103], a[196:199], v[184:187], v[100:103]
  v_mfma_f32_16x16x32_bf16 v[104:107], a[200:203], v[184:187], v[104:107]
  buffer_load_dwordx4 v65, s[48:51], s27 offen offset:1024 lds
  v_mfma_f32_16x16x32_bf16 v[108:111], a[204:207], v[184:187], v[108:111]
  s_waitcnt vmcnt(16)
  v_mfma_f32_16x16x32_bf16 v[96:99], a[208:211], v[188:191], v[96:99]
  v_mfma_f32_16x16x32_bf16 v[100:103], a[212:215], v[188:191], v[100:103]
  v_mfma_f32_16x16x32_bf16 v[104:107], a[216:219], v[188:191], v[104:107]
  v_mfma_f32_16x16x32_bf16 v[108:111], a[220:223], v[188:191], v[108:111]
  buffer_load_dwordx4 v66, s[48:51], s27 offen offset:2048 lds
  s_waitcnt vmcnt(16)
  v_mfma_f32_16x16x32_bf16 v[96:99], a[224:227], v[192:195], v[96:99]
  v_mfma_f32_16x16x32_bf16 v[100:103], a[228:231], v[192:195], v[100:103]
  v_mfma_f32_16x16x32_bf16 v[104:107], a[232:235], v[192:195], v[104:107]
  v_mfma_f32_16x16x32_bf16 v[108:111], a[236:239], v[192:195], v[108:111]
  s_waitcnt vmcnt(15)
  v_mfma_f32_16x16x32_bf16 v[96:99], a[240:243], v[196:199], v[96:99]
  buffer_load_dwordx4 v67, s[48:51], s27 offen offset:3072 lds
  v_mfma_f32_16x16x32_bf16 v[100:103], a[244:247], v[196:199], v[100:103]
  v_mfma_f32_16x16x32_bf16 v[104:107], a[248:251], v[196:199], v[104:107]
  v_mfma_f32_16x16x32_bf16 v[108:111], a[252:255], v[196:199], v[108:111]
  s_add_u32 s82, s10, 0x20000
  v_lshlrev_b32 v16, 16, v88
  v_and_b32 v17, 0xffff0000, v88
  s_nop 0
  v_pk_add_f32 v[16:17], v[16:17], v[96:97]
  v_cvt_pk_bf16_f32 v68, v16, v17
  v_lshlrev_b32 v12, 16, v89
  v_and_b32 v13, 0xffff0000, v89
  v_pk_add_f32 v[12:13], v[12:13], v[98:99]
  v_cvt_pk_bf16_f32 v69, v12, v13
  v_lshlrev_b32 v16, 16, v90
  v_and_b32 v17, 0xffff0000, v90
  v_pk_add_f32 v[16:17], v[16:17], v[100:101]
  v_cvt_pk_bf16_f32 v70, v16, v17
  v_lshlrev_b32 v12, 16, v91
  v_and_b32 v13, 0xffff0000, v91
  v_pk_add_f32 v[12:13], v[12:13], v[102:103]
  v_cvt_pk_bf16_f32 v71, v12, v13
  buffer_store_dwordx4 v[68:71], v47, s[60:63], s10 offen sc1
  v_lshlrev_b32 v16, 16, v92
  v_and_b32 v17, 0xffff0000, v92
  v_pk_add_f32 v[16:17], v[16:17], v[104:105]
  v_cvt_pk_bf16_f32 v72, v16, v17
  v_lshlrev_b32 v12, 16, v93
  v_and_b32 v13, 0xffff0000, v93
  v_pk_add_f32 v[12:13], v[12:13], v[106:107]
  v_cvt_pk_bf16_f32 v73, v12, v13
  v_lshlrev_b32 v16, 16, v94
  v_and_b32 v17, 0xffff0000, v94
  v_pk_add_f32 v[16:17], v[16:17], v[108:109]
  v_cvt_pk_bf16_f32 v74, v16, v17
  v_lshlrev_b32 v12, 16, v95
  v_and_b32 v13, 0xffff0000, v95
  v_pk_add_f32 v[12:13], v[12:13], v[110:111]
  v_cvt_pk_bf16_f32 v75, v12, v13
  buffer_store_dwordx4 v[72:75], v47, s[60:63], s82 offen sc1
  v_mov_b32 v12, 0
  v_mov_b32 v16, 0
  v_dot2_f32_bf16 v12, v68, v40, v12
  v_dot2_f32_bf16 v16, v68, v68, v16
  v_dot2_f32_bf16 v12, v69, v40, v12
  v_dot2_f32_bf16 v16, v69, v69, v16
  v_dot2_f32_bf16 v12, v70, v40, v12
  v_dot2_f32_bf16 v16, v70, v70, v16
  v_dot2_f32_bf16 v12, v71, v40, v12
  v_dot2_f32_bf16 v16, v71, v71, v16
  v_dot2_f32_bf16 v12, v72, v40, v12
  v_dot2_f32_bf16 v16, v72, v72, v16
  v_dot2_f32_bf16 v12, v73, v40, v12
  v_dot2_f32_bf16 v16, v73, v73, v16
  v_dot2_f32_bf16 v12, v74, v40, v12
  v_dot2_f32_bf16 v16, v74, v74, v16
  v_dot2_f32_bf16 v12, v75, v40, v12
  v_dot2_f32_bf16 v16, v75, v75, v16
  v_lshlrev_b32 v6, 6, v5
  v_lshl_add_u32 v6, v2, 2, v6
  s_nop 0
  v_permlane32_swap_b32 v12, v16
  v_add_f32 v12, v12, v16
  v_mov_b32 v16, v12
  s_nop 1
  v_permlane16_swap_b32 v12, v16
  v_add_f32 v12, v12, v16
  buffer_store_dword v12, v6, s[60:63], s11 offen sc1
  v_add_u32 v12, s23, v37
  v_add_u32 v13, 0x10000, v12
  s_lshl_b32 s81, s77, 9
  s_mul_i32 s85, s3, 112
  s_add_u32 s81, s81, s85
  s_add_u32 s81, s81, 0x6000
  v_min_u32 v14, 27, v1
  v_lshl_add_u32 v14, v14, 2, s81
  s_waitcnt vmcnt(16)
  v_xor_b32 v6, s80, v55
  v_xor_b32 v7, s80, v59
  v_xor_b32 v8, s80, v63
  v_or3_b32 v6, v6, v7, v8
  v_cmp_ne_u32 vcc, 0, v6
  s_nop 1
  s_cbranch_vccz L_ud_35
  s_mov_b32 s86, 0x100000
L_u_34:
  buffer_load_dwordx4 v[52:55], v15, s[60:63], s24 offen sc1
  buffer_load_dwordx4 v[56:59], v15, s[60:63], s25 offen sc1
  buffer_load_dwordx4 v[60:63], v15, s[60:63], s26 offen sc1
  s_waitcnt vmcnt(0)
  v_xor_b32 v6, s80, v55
  v_xor_b32 v7, s80, v59
  v_xor_b32 v8, s80, v63
  v_or3_b32 v6, v6, v7, v8
  v_cmp_ne_u32 vcc, 0, v6
  s_nop 1
  s_cbranch_vccz L_ud_35
  s_sub_u32 s86, s86, 1
  s_cbranch_scc0 L_u_34
L_ud_35:
  ds_write_b64 v24, v[52:53] offset:0
  ds_write_b64 v24, v[56:57] offset:8
  ds_write_b64 v24, v[60:61] offset:16
  ds_write2_b32 v24, v54, v58 offset0:6 offset1:7
  s_add_u32 s27, s27, 0x38000
  s_add_u32 m0, s23, 0x1000
  s_nop 0
  buffer_load_dwordx4 v64, s[48:51], s27 offen lds
  buffer_load_dwordx4 v65, s[48:51], s27 offen offset:1024 lds
  s_waitcnt lgkmcnt(0)
  s_barrier
  s_lshl_b32 s81, s89, 8
  v_xor_b32 v6, s81, v38
  s_lshl_b32 s81, s90, 10
  v_add_u32 v15, s81, v6
  v_xor_b32 v16, 0x400, v15
  s_and_b32 s81, s76, 1
  s_mul_i32 s81, s81, 28672
  s_mul_i32 s82, s77, 229376
  s_mul_i32 s85, s3, 57344
  s_add_u32 s82, s82, s85
  s_add_u32 s82, s82, 0x1200000
  s_add_u32 s4, s82, s81
  s_sub_u32 s9, s82, s81
  s_add_u32 s9, s9, 28672
  ds_read_b64 a[180:181], v18 offset:768
  ds_read_b64 a[182:183], v19 offset:768
  ds_read_b128 a[144:147], v11 offset:4096
  ds_read_b64 a[184:185], v18 offset:1536
  ds_read_b64 a[186:187], v19 offset:1536
  ds_read_b128 a[148:151], v11 offset:3584
  ds_read_b64 a[188:189], v18 offset:2304
  ds_read_b64 a[190:191], v19 offset:2304
  ds_read_b128 a[152:155], v11 offset:3072
  ds_read_b64 a[192:193], v18 offset:3072
  ds_read_b64 a[194:195], v19 offset:3072
  ds_read_b128 a[156:159], v11 offset:2560
  ds_read_b64 a[196:197], v18 offset:3840
  ds_read_b64 a[198:199], v19 offset:3840
  ds_read_b128 a[160:163], v11 offset:2048
  ds_read_b64 a[200:201], v18 offset:4608
  ds_read_b64 a[202:203], v19 offset:4608
  ds_read_b128 a[164:167], v11 offset:1536
  ds_read_b64 a[204:205], v18 offset:5376
  ds_read_b64 a[206:207], v19 offset:5376
  ds_read_b128 a[168:171], v11 offset:1024
  ds_read_b64 a[208:209], v18 offset:6144
  ds_read_b64 a[210:211], v19 offset:6144
  ds_read_b128 a[172:175], v11 offset:512
  s_waitcnt lgkmcnt(15)
  v_mfma_f32_16x16x32_bf16 a[224:227], a[144:147], a[180:183], 0
  buffer_load_dwordx4 v66, s[48:51], s27 offen offset:2048 lds
  v_mfma_f32_16x16x32_bf16 a[228:231], a[144:147], a[184:187], 0
  v_mfma_f32_16x16x32_bf16 a[228:231], a[148:151], a[180:183], a[228:231]
  v_mfma_f32_16x16x32_bf16 a[232:235], a[148:151], a[184:187], 0
  v_mfma_f32_16x16x32_bf16 a[232:235], a[144:147], a[188:191], a[232:235]
  s_waitcnt vmcnt(16)
  ds_read_b64_tr_b16 v[128:129], v13 offset:0
  ds_read_b64_tr_b16 v[130:131], v13 offset:1024
  buffer_load_dwordx4 v67, s[48:51], s27 offen offset:3072 lds
  v_mfma_f32_16x16x32_bf16 a[236:239], a[148:151], a[188:191], 0
  ds_read_b64_tr_b16 v[132:133], v13 offset:512
  ds_read_b64_tr_b16 v[134:135], v13 offset:1536
  v_mfma_f32_16x16x32_bf16 a[232:235], a[152:155], a[180:183], a[232:235]
  ds_read_b64 v[68:69], v18 offset:672
  ds_read_b64 v[70:71], v19 offset:672
  s_waitcnt vmcnt(15)
  ds_read_b64_tr_b16 v[136:137], v13 offset:2048
  ds_read_b64_tr_b16 v[138:139], v13 offset:3072
  v_mfma_f32_16x16x32_bf16 a[236:239], a[152:155], a[184:187], a[236:239]
  ds_read_b128 v[20:23], v11 offset:4032
  ds_read_b64_tr_b16 v[140:141], v13 offset:2560
  ds_read_b64_tr_b16 v[142:143], v13 offset:3584
  v_mfma_f32_16x16x32_bf16 a[240:243], a[152:155], a[188:191], 0
  ds_read_b64 v[72:73], v18 offset:1440
  ds_read_b64 v[74:75], v19 offset:1440
  s_waitcnt vmcnt(13)
  ds_read_b64_tr_b16 v[144:145], v13 offset:4096
  ds_read_b64_tr_b16 v[146:147], v13 offset:5120
  s_add_u32 s27, s22, 2
  s_and_b32 s27, s27, 3
  s_mul_i32 s27, s27, 458752
  s_add_u32 m0, s23, 0x8000
  s_nop 0
  buffer_load_dwordx4 v64, s[48:51], s27 offen lds
  s_waitcnt vmcnt(5)
  s_mov_b64 exec, 1
  buffer_store_dword v10, v9, s[60:63], s5 offen sc1
  s_mov_b64 exec, -1
  s_waitcnt lgkmcnt(15)
  v_mfma_f32_16x16x32_bf16 a[236:239], a[144:147], a[192:195], a[236:239]
  ds_read_b128 v[28:31], v11 offset:3520
  ds_read_b64_tr_b16 v[148:149], v13 offset:4608
  ds_read_b64_tr_b16 v[150:151], v13 offset:5632
  v_mfma_f32_16x16x32_bf16 a[240:243], a[148:151], a[192:195], a[240:243]
  ds_read_b64 v[76:77], v18 offset:2208
  ds_read_b64 v[78:79], v19 offset:2208
  ds_read_b64_tr_b16 v[152:153], v13 offset:6144
  ds_read_b64_tr_b16 v[154:155], v13 offset:7168
  v_mfma_f32_16x16x32_bf16 a[244:247], a[152:155], a[192:195], 0
  ds_read_b128 v[32:35], v11 offset:3008
  ds_read_b64_tr_b16 v[156:157], v13 offset:6656
  ds_read_b64_tr_b16 v[158:159], v13 offset:7680
  v_mfma_f32_16x16x32_bf16 a[236:239], a[156:159], a[180:183], a[236:239]
  ds_read_b64 v[88:89], v18 offset:2976
  ds_read_b64 v[90:91], v19 offset:2976
  buffer_load_dwordx4 v65, s[48:51], s27 offen offset:1024 lds
  v_mfma_f32_16x16x32_bf16 a[240:243], a[156:159], a[184:187], a[240:243]
  ds_read_b128 v[44:47], v11 offset:2496
  v_mfma_f32_16x16x32_bf16 a[244:247], a[156:159], a[188:191], a[244:247]
  ds_read_b64 v[92:93], v18 offset:3744
  ds_read_b64 v[94:95], v19 offset:3744
  v_mfma_f32_16x16x32_bf16 a[248:251], a[156:159], a[192:195], 0
  ds_read_b128 v[48:51], v11 offset:1984
  v_mfma_f32_16x16x32_bf16 a[240:243], a[144:147], a[196:199], a[240:243]
  ds_read_b64 v[96:97], v18 offset:4512
  ds_read_b64 v[98:99], v19 offset:4512
  buffer_load_dwordx4 v66, s[48:51], s27 offen offset:2048 lds
  v_mfma_f32_16x16x32_bf16 a[244:247], a[148:151], a[196:199], a[244:247]
  ds_read_b128 v[52:55], v11 offset:1472
  v_mfma_f32_16x16x32_bf16 a[248:251], a[152:155], a[196:199], a[248:251]
  ds_read_b64 v[100:101], v18 offset:5280
  ds_read_b64 v[102:103], v19 offset:5280
  v_mfma_f32_16x16x32_bf16 a[252:255], a[156:159], a[196:199], 0
  ds_read_b128 v[56:59], v11 offset:960
  v_mfma_f32_16x16x32_bf16 a[240:243], a[160:163], a[180:183], a[240:243]
  ds_read_b64 v[104:105], v18 offset:6048
  ds_read_b64 v[106:107], v19 offset:6048
  buffer_load_dwordx4 v67, s[48:51], s27 offen offset:3072 lds
  v_mfma_f32_16x16x32_bf16 a[244:247], a[160:163], a[184:187], a[244:247]
  ds_read_b128 v[60:63], v11 offset:448
  v_mfma_f32_16x16x32_bf16 a[248:251], a[160:163], a[188:191], a[248:251]
  v_mfma_f32_16x16x32_bf16 a[252:255], a[160:163], a[192:195], a[252:255]
  v_mfma_f32_16x16x32_bf16 a[244:247], a[144:147], a[200:203], a[244:247]
  s_add_u32 s27, s27, 0x38000
  s_add_u32 m0, s23, 0x9000
  s_nop 0
  buffer_load_dwordx4 v64, s[48:51], s27 offen lds
  v_mfma_f32_16x16x32_bf16 a[248:251], a[148:151], a[200:203], a[248:251]
  v_mfma_f32_16x16x32_bf16 a[252:255], a[152:155], a[200:203], a[252:255]
  v_mfma_f32_16x16x32_bf16 a[244:247], a[164:167], a[180:183], a[244:247]
  v_mfma_f32_16x16x32_bf16 a[248:251], a[164:167], a[184:187], a[248:251]
  buffer_load_dwordx4 v65, s[48:51], s27 offen offset:1024 lds
  v_mfma_f32_16x16x32_bf16 a[252:255], a[164:167], a[188:191], a[252:255]
  v_mfma_f32_16x16x32_bf16 a[248:251], a[144:147], a[204:207], a[248:251]
  v_mfma_f32_16x16x32_bf16 a[252:255], a[148:151], a[204:207], a[252:255]
  v_mfma_f32_16x16x32_bf16 a[248:251], a[168:171], a[180:183], a[248:251]
  buffer_load_dwordx4 v66, s[48:51], s27 offen offset:2048 lds
  v_mfma_f32_16x16x32_bf16 a[252:255], a[168:171], a[184:187], a[252:255]
  v_mfma_f32_16x16x32_bf16 a[252:255], a[144:147], a[208:211], a[252:255]
  v_mfma_f32_16x16x32_bf16 a[252:255], a[172:175], a[180:183], a[252:255]
  s_waitcnt lgkmcnt(0)
  s_cmp_lg_u32 s90, 0
  s_cbranch_scc1 L_cx_36
  ds_read_b128 a[176:179], v11 offset:0
  ds_read_b64 a[212:213], v18 offset:0
  ds_read_b64 a[214:215], v19 offset:0
  s_waitcnt lgkmcnt(0)
  v_mfma_f32_16x16x32_bf16 a[224:227], a[148:151], a[212:215], a[224:227]
  v_mfma_f32_16x16x32_bf16 a[228:231], a[152:155], a[212:215], a[228:231]
  v_mfma_f32_16x16x32_bf16 a[232:235], a[156:159], a[212:215], a[232:235]
  v_mfma_f32_16x16x32_bf16 a[236:239], a[160:163], a[212:215], a[236:239]
  v_mfma_f32_16x16x32_bf16 a[240:243], a[164:167], a[212:215], a[240:243]
  v_mfma_f32_16x16x32_bf16 a[244:247], a[168:171], a[212:215], a[244:247]
  v_mfma_f32_16x16x32_bf16 a[248:251], a[172:175], a[212:215], a[248:251]
  v_mfma_f32_16x16x32_bf16 a[252:255], a[176:179], a[212:215], a[252:255]
L_cx_36:
  s_lshl_b32 s81, s14, 1
  s_add_u32 s81, s81, 0x3000
  v_lshl_add_u32 v17, v1, 2, s81
  v_mfma_f32_16x16x32_bf16 a[224:227], v[20:23], v[68:71], a[224:227]
  buffer_load_dwordx4 v67, s[48:51], s27 offen offset:3072 lds
  v_mfma_f32_16x16x32_bf16 a[228:231], v[20:23], v[72:75], a[228:231]
  v_mfma_f32_16x16x32_bf16 a[228:231], v[28:31], v[68:71], a[228:231]
  ds_read_b64 a[180:181], v18 offset:576
  ds_read_b64 a[182:183], v19 offset:576
  v_mfma_f32_16x16x32_bf16 a[232:235], v[28:31], v[72:75], a[232:235]
  ds_read_b128 a[144:147], v11 offset:3968
  v_mfma_f32_16x16x32_bf16 a[232:235], v[20:23], v[76:79], a[232:235]
  ds_read_b64 a[184:185], v18 offset:1344
  ds_read_b64 a[186:187], v19 offset:1344
  v_mfma_f32_16x16x32_bf16 a[236:239], v[28:31], v[76:79], a[236:239]
  ds_read_b128 a[148:151], v11 offset:3456
  v_mfma_f32_16x16x32_bf16 a[232:235], v[32:35], v[68:71], a[232:235]
  ds_read_b64 a[188:189], v18 offset:2112
  ds_read_b64 a[190:191], v19 offset:2112
  v_mfma_f32_16x16x32_bf16 a[236:239], v[32:35], v[72:75], a[236:239]
  ds_read_b128 a[152:155], v11 offset:2944
  v_mfma_f32_16x16x32_bf16 a[240:243], v[32:35], v[76:79], a[240:243]
  ds_read_b64 a[192:193], v18 offset:2880
  ds_read_b64 a[194:195], v19 offset:2880
  s_add_u32 s27, s22, 3
  s_and_b32 s27, s27, 3
  s_mul_i32 s27, s27, 458752
  s_add_u32 m0, s23, 0x10000
  s_nop 0
  buffer_load_dwordx4 v64, s[48:51], s27 offen lds
  v_mfma_f32_16x16x32_bf16 a[236:239], v[20:23], v[88:91], a[236:239]
  ds_read_b128 a[156:159], v11 offset:2432
  v_mfma_f32_16x16x32_bf16 a[240:243], v[28:31], v[88:91], a[240:243]
  ds_read_b64 a[196:197], v18 offset:3648
  ds_read_b64 a[198:199], v19 offset:3648
  ds_read_b64_tr_b16 v[160:161], v12 offset:0
  ds_read_b64_tr_b16 v[162:163], v12 offset:1024
  v_mfma_f32_16x16x32_bf16 a[244:247], v[32:35], v[88:91], a[244:247]
  ds_read_b128 a[160:163], v11 offset:1920
  ds_read_b64_tr_b16 v[164:165], v12 offset:512
  ds_read_b64_tr_b16 v[166:167], v12 offset:1536
  v_mfma_f32_16x16x32_bf16 a[236:239], v[44:47], v[68:71], a[236:239]
  ds_read_b64 a[200:201], v18 offset:4416
  ds_read_b64 a[202:203], v19 offset:4416
  buffer_load_dwordx4 v65, s[48:51], s27 offen offset:1024 lds
  ds_read_b64_tr_b16 v[168:169], v12 offset:2048
  ds_read_b64_tr_b16 v[170:171], v12 offset:3072
  v_mfma_f32_16x16x32_bf16 a[240:243], v[44:47], v[72:75], a[240:243]
  ds_read_b128 a[164:167], v11 offset:1408
  ds_read_b64_tr_b16 v[172:173], v12 offset:2560
  ds_read_b64_tr_b16 v[174:175], v12 offset:3584
  v_mfma_f32_16x16x32_bf16 a[244:247], v[44:47], v[76:79], a[244:247]
  ds_read_b64 a[204:205], v18 offset:5184
  ds_read_b64 a[206:207], v19 offset:5184
  s_waitcnt vmcnt(13)
  ds_read_b64_tr_b16 v[176:177], v12 offset:4096
  ds_read_b64_tr_b16 v[178:179], v12 offset:5120
  v_mfma_f32_16x16x32_bf16 a[248:251], v[44:47], v[88:91], a[248:251]
  ds_read_b128 a[168:171], v11 offset:896
  ds_read_b64_tr_b16 v[180:181], v12 offset:4608
  ds_read_b64_tr_b16 v[182:183], v12 offset:5632
  v_mfma_f32_16x16x32_bf16 a[240:243], v[20:23], v[92:95], a[240:243]
  ds_read_b64 a[208:209], v18 offset:5952
  ds_read_b64 a[210:211], v19 offset:5952
  buffer_load_dwordx4 v66, s[48:51], s27 offen offset:2048 lds
  s_waitcnt vmcnt(12)
  ds_read_b64_tr_b16 v[184:185], v12 offset:6144
  ds_read_b64_tr_b16 v[186:187], v12 offset:7168
  v_mfma_f32_16x16x32_bf16 a[244:247], v[28:31], v[92:95], a[244:247]
  ds_read_b128 a[172:175], v11 offset:384
  ds_read_b64_tr_b16 v[188:189], v12 offset:6656
  ds_read_b64_tr_b16 v[190:191], v12 offset:7680
  v_mfma_f32_16x16x32_bf16 a[248:251], v[32:35], v[92:95], a[248:251]
  v_mfma_f32_16x16x32_bf16 a[252:255], v[44:47], v[92:95], a[252:255]
  v_mfma_f32_16x16x32_bf16 a[240:243], v[48:51], v[68:71], a[240:243]
  buffer_load_dwordx4 v67, s[48:51], s27 offen offset:3072 lds
  v_mfma_f32_16x16x32_bf16 a[244:247], v[48:51], v[72:75], a[244:247]
  v_mfma_f32_16x16x32_bf16 a[248:251], v[48:51], v[76:79], a[248:251]
  v_mfma_f32_16x16x32_bf16 a[252:255], v[48:51], v[88:91], a[252:255]
  v_mfma_f32_16x16x32_bf16 a[244:247], v[20:23], v[96:99], a[244:247]
  s_add_u32 s27, s27, 0x38000
  s_add_u32 m0, s23, 0x11000
  s_nop 0
  buffer_load_dwordx4 v64, s[48:51], s27 offen lds
  v_mfma_f32_16x16x32_bf16 a[248:251], v[28:31], v[96:99], a[248:251]
  v_mfma_f32_16x16x32_bf16 a[252:255], v[32:35], v[96:99], a[252:255]
  v_mfma_f32_16x16x32_bf16 a[244:247], v[52:55], v[68:71], a[244:247]
  v_mfma_f32_16x16x32_bf16 a[248:251], v[52:55], v[72:75], a[248:251]
  buffer_load_dwordx4 v65, s[48:51], s27 offen offset:1024 lds
  v_mfma_f32_16x16x32_bf16 a[252:255], v[52:55], v[76:79], a[252:255]
  v_mfma_f32_16x16x32_bf16 a[248:251], v[20:23], v[100:103], a[248:251]
  buffer_load_dword v24, v17, s[60:63], 0 offen sc1
  v_mfma_f32_16x16x32_bf16 a[252:255], v[28:31], v[100:103], a[252:255]
  buffer_load_dword v25, v14, s[60:63], 0 offen sc1
  v_mfma_f32_16x16x32_bf16 a[248:251], v[56:59], v[68:71], a[248:251]
  buffer_load_dwordx4 v66, s[48:51], s27 offen offset:2048 lds
  v_mfma_f32_16x16x32_bf16 a[252:255], v[56:59], v[72:75], a[252:255]
  v_mfma_f32_16x16x32_bf16 a[252:255], v[20:23], v[104:107], a[252:255]
  v_mfma_f32_16x16x32_bf16 a[252:255], v[60:63], v[68:71], a[252:255]
  buffer_load_dwordx4 v67, s[48:51], s27 offen offset:3072 lds
  s_waitcnt lgkmcnt(15)
  v_mfma_f32_16x16x32_bf16 a[224:227], a[144:147], a[180:183], a[224:227]
  ds_read_b64 v[68:69], v18 offset:480
  ds_read_b64 v[70:71], v19 offset:480
  v_and_b32 v6, 1, v3
  v_mfma_f32_16x16x32_bf16 a[228:231], a[144:147], a[184:187], a[228:231]
  ds_read_b128 v[20:23], v11 offset:3904
  v_lshlrev_b32 v6, 10, v6
  v_mfma_f32_16x16x32_bf16 a[228:231], a[148:151], a[180:183], a[228:231]
  ds_read_b64 v[72:73], v18 offset:1248
  ds_read_b64 v[74:75], v19 offset:1248
  v_lshl_add_u32 v6, v5, 6, v6
  s_waitcnt vmcnt(16)
  ds_read_b64_tr_b16 v[192:193], v12 offset:32768
  ds_read_b64_tr_b16 v[194:195], v12 offset:33792
  v_mfma_f32_16x16x32_bf16 a[232:235], a[148:151], a[184:187], a[232:235]
  ds_read_b128 v[28:31], v11 offset:3392
  v_lshl_add_u32 v6, v2, 2, v6
  ds_read_b64_tr_b16 v[196:197], v12 offset:33280
  ds_read_b64_tr_b16 v[198:199], v12 offset:34304
  v_mfma_f32_16x16x32_bf16 a[232:235], a[144:147], a[188:191], a[232:235]
  ds_read_b64 v[76:77], v18 offset:2016
  ds_read_b64 v[78:79], v19 offset:2016
  s_mul_i32 s82, s16, 3
  s_waitcnt vmcnt(14)
  ds_read_b64_tr_b16 v[200:201], v12 offset:34816
  ds_read_b64_tr_b16 v[202:203], v12 offset:35840
  v_mfma_f32_16x16x32_bf16 a[236:239], a[148:151], a[188:191], a[236:239]
  ds_read_b128 v[32:35], v11 offset:2880
  s_xor_b32 s81, s82, s3
  ds_read_b64_tr_b16 v[204:205], v12 offset:35328
  ds_read_b64_tr_b16 v[206:207], v12 offset:36352
  v_mfma_f32_16x16x32_bf16 a[232:235], a[152:155], a[180:183], a[232:235]
  ds_read_b64 v[88:89], v18 offset:2784
  ds_read_b64 v[90:91], v19 offset:2784
  s_lshl_b32 s83, s14, 6
  s_waitcnt vmcnt(12)
  ds_read_b64_tr_b16 v[208:209], v12 offset:36864
  ds_read_b64_tr_b16 v[210:211], v12 offset:37888
  v_mfma_f32_16x16x32_bf16 a[236:239], a[152:155], a[184:187], a[236:239]
  ds_read_b128 v[44:47], v11 offset:2368
  s_lshl_b32 s85, s81, 11
  ds_read_b64_tr_b16 v[212:213], v12 offset:37376
  ds_read_b64_tr_b16 v[214:215], v12 offset:38400
  v_mfma_f32_16x16x32_bf16 a[240:243], a[152:155], a[188:191], a[240:243]
  ds_read_b64 v[92:93], v18 offset:3552
  ds_read_b64 v[94:95], v19 offset:3552
  s_add_u32 s83, s83, s85
  s_waitcnt vmcnt(10)
  ds_read_b64_tr_b16 v[216:217], v12 offset:38912
  ds_read_b64_tr_b16 v[218:219], v12 offset:39936
  v_mfma_f32_16x16x32_bf16 a[236:239], a[144:147], a[192:195], a[236:239]
  ds_read_b128 v[48:51], v11 offset:1856
  s_add_u32 s83, s83, 0x500000
  ds_read_b64_tr_b16 v[220:221], v12 offset:39424
  ds_read_b64_tr_b16 v[222:223], v12 offset:40448
  v_mfma_f32_16x16x32_bf16 a[240:243], a[148:151], a[192:195], a[240:243]
  ds_read_b64 v[96:97], v18 offset:4320
  ds_read_b64 v[98:99], v19 offset:4320
  v_add_u32 v26, s83, v6
  v_mfma_f32_16x16x32_bf16 a[244:247], a[152:155], a[192:195], a[244:247]
  ds_read_b128 v[52:55], v11 offset:1344
  v_lshlrev_b32 v6, 11, v5
  v_mfma_f32_16x16x32_bf16 a[236:239], a[156:159], a[180:183], a[236:239]
  ds_read_b64 v[100:101], v18 offset:5088
  ds_read_b64 v[102:103], v19 offset:5088
  v_add3_u32 v6, v6, v4, s14
  v_mfma_f32_16x16x32_bf16 a[240:243], a[156:159], a[184:187], a[240:243]
  ds_read_b128 v[56:59], v11 offset:832
  v_lshlrev_b32 v64, 4, v6
  ds_read_b64 v[104:105], v18 offset:5856
  ds_read_b64 v[106:107], v19 offset:5856
  ds_read_b128 v[60:63], v11 offset:320
  v_add_u32 v65, 0xfc00, v64
  v_add_u32 v66, 0x1f800, v64
  v_add_u32 v67, 0x2f400, v64
  s_add_u32 s81, s3, s22
  s_and_b32 s81, s81, 3
  s_lshl_b32 s8, s81, 19
  s_lshl_b32 s85, s82, 9
  s_add_u32 s8, s8, s85
  s_add_u32 s8, s8, 0x300000
  s_lshl_b32 s81, s16, 10
  s_sub_u32 s12, 0x200, s81
  s_waitcnt vmcnt(2)
  v_cmp_ne_u32 vcc, s80, v25
  s_cbranch_vccz L_pd_38
  s_mov_b32 s86, 0x100000
L_poll_37:
  buffer_load_dword v25, v14, s[60:63], 0 offen sc1
  s_waitcnt vmcnt(0)
  v_cmp_ne_u32 vcc, s80, v25
  s_cbranch_vccz L_pd_38
  s_sub_u32 s86, s86, 1
  s_cbranch_scc0 L_poll_37
L_pd_38:
  v_cmp_ne_u32 vcc, s80, v24
  s_cbranch_vccz L_pd_40
  s_mov_b32 s86, 0x100000
L_poll_39:
  buffer_load_dword v24, v17, s[60:63], 0 offen sc1
  s_waitcnt vmcnt(0)
  v_cmp_ne_u32 vcc, s80, v24
  s_cbranch_vccz L_pd_40
  s_sub_u32 s86, s86, 1
  s_cbranch_scc0 L_poll_39
L_pd_40:
  s_waitcnt lgkmcnt(9)
  s_barrier
  v_xor_b32 v6, v3, v2
  v_and_b32 v6, 1, v6
  v_cmp_eq_u32 vcc, 0, v6
  s_nop 1
  v_cndmask_b32 v108, 0, v40, vcc
  v_cndmask_b32 v109, 0, v40, vcc
  v_cndmask_b32 v110, 0, v40, vcc
  v_cndmask_b32 v111, 0, v40, vcc
  s_add_u32 s88, s8, 0x0
  s_add_u32 m0, s23, 0x0
  s_nop 0
  buffer_load_dwordx4 v64, s[60:63], s88 offen sc1 lds
  buffer_load_dwordx4 v65, s[60:63], s88 offen offset:1024 sc1 lds
  buffer_load_dwordx4 v66, s[60:63], s88 offen offset:2048 sc1 lds
  v_mfma_f32_16x16x32_bf16 a[244:247], a[156:159], a[188:191], a[244:247]
  buffer_load_dwordx4 v67, s[60:63], s88 offen offset:3072 sc1 lds
  v_mfma_f32_16x16x32_bf16 a[248:251], a[156:159], a[192:195], a[248:251]
  v_mfma_f32_16x16x32_bf16 a[240:243], a[144:147], a[196:199], a[240:243]
  v_mfma_f32_16x16x32_bf16 a[244:247], a[148:151], a[196:199], a[244:247]
  s_add_u32 s88, s8, 0x40000
  s_add_u32 m0, s23, 0x1000
  s_nop 0
  buffer_load_dwordx4 v64, s[60:63], s88 offen sc1 lds
  v_mfma_f32_16x16x32_bf16 a[248:251], a[152:155], a[196:199], a[248:251]
  v_mfma_f32_16x16x32_bf16 a[252:255], a[156:159], a[196:199], a[252:255]
  v_mfma_f32_16x16x32_bf16 a[240:243], a[160:163], a[180:183], a[240:243]
  buffer_load_dwordx4 v65, s[60:63], s88 offen offset:1024 sc1 lds
  v_mfma_f32_16x16x32_bf16 a[244:247], a[160:163], a[184:187], a[244:247]
  v_mfma_f32_16x16x32_bf16 a[248:251], a[160:163], a[188:191], a[248:251]
  v_mfma_f32_16x16x32_bf16 a[252:255], a[160:163], a[192:195], a[252:255]
  buffer_load_dwordx4 v66, s[60:63], s88 offen offset:2048 sc1 lds
  v_mfma_f32_16x16x32_bf16 a[244:247], a[144:147], a[200:203], a[244:247]
  v_mfma_f32_16x16x32_bf16 a[248:251], a[148:151], a[200:203], a[248:251]
  v_mfma_f32_16x16x32_bf16 a[252:255], a[152:155], a[200:203], a[252:255]
  buffer_load_dwordx4 v67, s[60:63], s88 offen offset:3072 sc1 lds
  v_mfma_f32_16x16x32_bf16 a[244:247], a[164:167], a[180:183], a[244:247]
  v_mfma_f32_16x16x32_bf16 a[248:251], a[164:167], a[184:187], a[248:251]
  v_mfma_f32_16x16x32_bf16 a[252:255], a[164:167], a[188:191], a[252:255]
  buffer_load_dword v80, v26, s[60:63], 0 offen offset:0 sc1
  v_mfma_f32_16x16x32_bf16 a[248:251], a[144:147], a[204:207], a[248:251]
  v_mfma_f32_16x16x32_bf16 a[252:255], a[148:151], a[204:207], a[252:255]
  v_mfma_f32_16x16x32_bf16 a[248:251], a[168:171], a[180:183], a[248:251]
  buffer_load_dword v81, v26, s[60:63], 0 offen offset:128 sc1
  v_mfma_f32_16x16x32_bf16 a[252:255], a[168:171], a[184:187], a[252:255]
  v_mfma_f32_16x16x32_bf16 a[252:255], a[144:147], a[208:211], a[252:255]
  ds_read_b64_tr_b16 v[224:225], v13 offset:0
  ds_read_b64_tr_b16 v[226:227], v13 offset:1024
  v_mfma_f32_16x16x32_bf16 a[252:255], a[172:175], a[180:183], a[252:255]
  buffer_load_dword v82, v26, s[60:63], 0 offen offset:256 sc1
  v_mfma_f32_16x16x32_bf16 a[224:227], v[20:23], v[68:71], a[224:227]
  ds_read_b64_tr_b16 v[228:229], v13 offset:512
  ds_read_b64_tr_b16 v[230:231], v13 offset:1536
  v_mfma_f32_16x16x32_bf16 a[228:231], v[20:23], v[72:75], a[228:231]
  v_mfma_f32_16x16x32_bf16 a[228:231], v[28:31], v[68:71], a[228:231]
  buffer_load_dword v83, v26, s[60:63], 0 offen offset:384 sc1
  ds_read_b64_tr_b16 v[232:233], v13 offset:2048
  ds_read_b64_tr_b16 v[234:235], v13 offset:3072
  v_mfma_f32_16x16x32_bf16 a[232:235], v[28:31], v[72:75], a[232:235]
  v_mfma_f32_16x16x32_bf16 a[232:235], v[20:23], v[76:79], a[232:235]
  ds_read_b64_tr_b16 v[236:237], v13 offset:2560
  ds_read_b64_tr_b16 v[238:239], v13 offset:3584
  v_mfma_f32_16x16x32_bf16 a[236:239], v[28:31], v[76:79], a[236:239]
  buffer_load_dword v84, v26, s[60:63], 0 offen offset:512 sc1
  v_mfma_f32_16x16x32_bf16 a[232:235], v[32:35], v[68:71], a[232:235]
  ds_read_b64_tr_b16 v[240:241], v13 offset:4096
  ds_read_b64_tr_b16 v[242:243], v13 offset:5120
  v_mfma_f32_16x16x32_bf16 a[236:239], v[32:35], v[72:75], a[236:239]
  v_mfma_f32_16x16x32_bf16 a[240:243], v[32:35], v[76:79], a[240:243]
  buffer_load_dword v85, v26, s[60:63], 0 offen offset:640 sc1
  ds_read_b64_tr_b16 v[244:245], v13 offset:4608
  ds_read_b64_tr_b16 v[246:247], v13 offset:5632
  v_mfma_f32_16x16x32_bf16 a[236:239], v[20:23], v[88:91], a[236:239]
  v_mfma_f32_16x16x32_bf16 a[240:243], v[28:31], v[88:91], a[240:243]
  s_waitcnt vmcnt(14)
  ds_read_b64_tr_b16 v[248:249], v13 offset:6144
  ds_read_b64_tr_b16 v[250:251], v13 offset:7168
  v_mfma_f32_16x16x32_bf16 a[244:247], v[32:35], v[88:91], a[244:247]
  buffer_load_dword v86, v26, s[60:63], 0 offen offset:768 sc1
  v_mfma_f32_16x16x32_bf16 a[236:239], v[44:47], v[68:71], a[236:239]
  ds_read_b64_tr_b16 v[252:253], v13 offset:6656
  ds_read_b64_tr_b16 v[254:255], v13 offset:7680
  v_mfma_f32_16x16x32_bf16 a[240:243], v[44:47], v[72:75], a[240:243]
  v_mfma_f32_16x16x32_bf16 a[244:247], v[44:47], v[76:79], a[244:247]
  buffer_load_dword v87, v26, s[60:63], 0 offen offset:896 sc1
  v_mfma_f32_16x16x32_bf16 a[248:251], v[44:47], v[88:91], a[248:251]
  v_mfma_f32_16x16x32_bf16 a[240:243], v[20:23], v[92:95], a[240:243]
  v_mfma_f32_16x16x32_bf16 a[244:247], v[28:31], v[92:95], a[244:247]
  s_add_u32 s8, s8, s12
  s_add_u32 s88, s8, 0x0
  s_add_u32 m0, s23, 0x8000
  s_nop 0
  buffer_load_dwordx4 v64, s[60:63], s88 offen sc1 lds
  v_mfma_f32_16x16x32_bf16 a[248:251], v[32:35], v[92:95], a[248:251]
  v_mfma_f32_16x16x32_bf16 a[252:255], v[44:47], v[92:95], a[252:255]
  v_mfma_f32_16x16x32_bf16 a[240:243], v[48:51], v[68:71], a[240:243]
  buffer_load_dwordx4 v65, s[60:63], s88 offen offset:1024 sc1 lds
  v_mfma_f32_16x16x32_bf16 a[244:247], v[48:51], v[72:75], a[244:247]
  v_mfma_f32_16x16x32_bf16 a[248:251], v[48:51], v[76:79], a[248:251]
  v_mfma_f32_16x16x32_bf16 a[252:255], v[48:51], v[88:91], a[252:255]
  buffer_load_dwordx4 v66, s[60:63], s88 offen offset:2048 sc1 lds
  s_waitcnt lgkmcnt(15)
  v_mfma_f32_16x16x32_bf16 a[244:247], v[20:23], v[96:99], a[244:247]
  v_mfma_f32_16x16x32_bf16 a[248:251], v[28:31], v[96:99], a[248:251]
  v_mfma_f32_16x16x32_bf16 a[252:255], v[32:35], v[96:99], a[252:255]
  buffer_load_dwordx4 v67, s[60:63], s88 offen offset:3072 sc1 lds
  v_mfma_f32_16x16x32_bf16 a[244:247], v[52:55], v[68:71], a[244:247]
  v_mfma_f32_16x16x32_bf16 a[248:251], v[52:55], v[72:75], a[248:251]
  v_mfma_f32_16x16x32_bf16 a[252:255], v[52:55], v[76:79], a[252:255]
  s_add_u32 s88, s8, 0x40000
  s_add_u32 m0, s23, 0x9000
  s_nop 0
  buffer_load_dwordx4 v64, s[60:63], s88 offen sc1 lds
  v_mfma_f32_16x16x32_bf16 a[248:251], v[20:23], v[100:103], a[248:251]
  v_mfma_f32_16x16x32_bf16 a[252:255], v[28:31], v[100:103], a[252:255]
  v_mfma_f32_16x16x32_bf16 a[248:251], v[56:59], v[68:71], a[248:251]
  v_mfma_f32_16x16x32_bf16 a[252:255], v[56:59], v[72:75], a[252:255]
  v_mfma_f32_16x16x32_bf16 a[252:255], v[20:23], v[104:107], a[252:255]
  v_mfma_f32_16x16x32_bf16 a[252:255], v[60:63], v[68:71], a[252:255]
  s_add_u32 s81, s23, 0x10000
  v_add_u32 v7, s81, v38
  v_mfma_f32_16x16x32_bf16 v[112:115], v[108:111], v[128:131], 0
  buffer_load_dwordx4 v65, s[60:63], s88 offen offset:1024 sc1 lds
  v_mfma_f32_16x16x32_bf16 v[112:115], v[108:111], v[132:135], v[112:115]
  s_waitcnt lgkmcnt(0)
  v_mfma_f32_16x16x32_bf16 v[112:115], v[108:111], v[136:139], v[112:115]
  ds_write_b128 v7, a[224:227] offset:0
  v_mfma_f32_16x16x32_bf16 v[112:115], v[108:111], v[140:143], v[112:115]
  ds_write_b128 v7, a[228:231] offset:1024
  v_mfma_f32_16x16x32_bf16 v[112:115], v[108:111], v[144:147], v[112:115]
  ds_write_b128 v7, a[232:235] offset:2048
  buffer_load_dwordx4 v66, s[60:63], s88 offen offset:2048 sc1 lds
  v_mfma_f32_16x16x32_bf16 v[112:115], v[108:111], v[148:151], v[112:115]
  ds_write_b128 v7, a[236:239] offset:3072
  v_mfma_f32_16x16x32_bf16 v[112:115], v[108:111], v[152:155], v[112:115]
  ds_write_b128 v7, a[240:243] offset:4096
  v_mfma_f32_16x16x32_bf16 v[112:115], v[108:111], v[156:159], v[112:115]
  ds_write_b128 v7, a[244:247] offset:5120
  v_mfma_f32_16x16x32_bf16 v[112:115], v[108:111], v[160:163], v[112:115]
  ds_write_b128 v7, a[248:251] offset:6144
  buffer_load_dwordx4 v67, s[60:63], s88 offen offset:3072 sc1 lds
  v_mfma_f32_16x16x32_bf16 v[112:115], v[108:111], v[164:167], v[112:115]
  ds_write_b128 v7, a[252:255] offset:7168
  v_mfma_f32_16x16x32_bf16 v[112:115], v[108:111], v[168:171], v[112:115]
  s_waitcnt vmcnt(8)
  v_mfma_f32_16x16x32_bf16 v[112:115], v[108:111], v[172:175], v[112:115]
  v_add_f32 v80, v80, v84
  v_mfma_f32_16x16x32_bf16 v[112:115], v[108:111], v[176:179], v[112:115]
  v_add_f32 v81, v81, v85
  buffer_load_dwordx4 a[0:3], v15, s[60:63], s4 offen sc1
  v_mfma_f32_16x16x32_bf16 v[112:115], v[108:111], v[180:183], v[112:115]
  v_add_f32 v82, v82, v86
  v_mfma_f32_16x16x32_bf16 v[112:115], v[108:111], v[184:187], v[112:115]
  v_add_f32 v83, v83, v87
  v_mfma_f32_16x16x32_bf16 v[112:115], v[108:111], v[188:191], v[112:115]
  v_add_f32 v80, v80, v82
  v_mfma_f32_16x16x32_bf16 v[112:115], v[108:111], v[192:195], v[112:115]
  v_add_f32 v81, v81, v83
  buffer_load_dwordx4 a[4:7], v16, s[60:63], s4 offen sc1
  v_mfma_f32_16x16x32_bf16 v[112:115], v[108:111], v[196:199], v[112:115]
  v_add_f32 v80, v80, v81
  v_mfma_f32_16x16x32_bf16 v[112:115], v[108:111], v[200:203], v[112:115]
  v_mov_b32 v81, v80
  v_mfma_f32_16x16x32_bf16 v[112:115], v[108:111], v[204:207], v[112:115]
  s_nop 0
  v_permlane32_swap_b32 v80, v81
  v_mfma_f32_16x16x32_bf16 v[112:115], v[108:111], v[208:211], v[112:115]
  v_mul_f32 v82, 0xbb000000, v80
  buffer_load_dwordx4 a[8:11], v15, s[60:63], s4 offen offset:2048 sc1
  v_mfma_f32_16x16x32_bf16 v[112:115], v[108:111], v[212:215], v[112:115]
  v_mul_f32 v81, 0x3b000000, v81
  v_mfma_f32_16x16x32_bf16 v[112:115], v[108:111], v[216:219], v[112:115]
  v_fma_f32 v81, -v82, v82, v81
  v_mfma_f32_16x16x32_bf16 v[112:115], v[108:111], v[220:223], v[112:115]
  v_max_f32 v81, 0, v81
  v_mfma_f32_16x16x32_bf16 v[112:115], v[108:111], v[224:227], v[112:115]
  v_cvt_pk_bf16_f32 v20, v82, v82
  buffer_load_dwordx4 a[12:15], v16, s[60:63], s4 offen offset:2048 sc1
  v_mfma_f32_16x16x32_bf16 v[112:115], v[108:111], v[228:231], v[112:115]
  v_cvt_pk_bf16_f32 v21, v82, 0
  v_mfma_f32_16x16x32_bf16 v[112:115], v[108:111], v[232:235], v[112:115]
  v_cvt_pk_bf16_f32 v81, v81, v81
  v_mfma_f32_16x16x32_bf16 v[112:115], v[108:111], v[236:239], v[112:115]
  v_and_b32 v81, 0xffff0000, v81
  v_mfma_f32_16x16x32_bf16 v[112:115], v[108:111], v[240:243], v[112:115]
  v_add_f32 v81, 0x3727c5ac, v81
  s_add_u32 s4, s4, 0x1000
  buffer_load_dwordx4 a[16:19], v15, s[60:63], s4 offen sc1
  v_mfma_f32_16x16x32_bf16 v[112:115], v[108:111], v[244:247], v[112:115]
  v_cvt_pk_bf16_f32 v81, v81, v81
  v_mfma_f32_16x16x32_bf16 v[112:115], v[108:111], v[248:251], v[112:115]
  v_and_b32 v81, 0xffff0000, v81
  v_mfma_f32_16x16x32_bf16 v[112:115], v[108:111], v[252:255], v[112:115]
  v_sqrt_f32 v81, v81
  s_nop 0
  v_cvt_pk_bf16_f32 v81, v81, v81
  v_and_b32 v81, 0xffff0000, v81
  v_rcp_f32 v81, v81
  v_mov_b32 v23, 0
  s_lshl_b32 s81, s3, 9
  s_add_u32 s81, s81, 0x27000
  v_lshl_add_u32 v11, v4, 4, s81
  v_mul_f32 v22, 0xbeeff558, v81
  v_and_b32 v22, 0xffffff7f, v22
  ds_write_b128 v11, v[20:23]
  s_waitcnt lgkmcnt(0)
  s_barrier
  s_and_b32 s81, s3, 2
  s_lshl_b32 s82, s81, 13
  s_lshl_b32 s85, s90, 12
  s_add_u32 s82, s82, s85
  s_add_u32 s82, s82, 0x10000
  v_add_u32 v6, s82, v38
  s_mul_i32 s83, s90, 3456
  v_add_u32 v18, s83, v18
  ds_read_b128 v[68:71], v6 offset:0
  ds_read_b128 v[84:87], v6 offset:8192
  ds_read_b64 v[28:29], v18 offset:768
  ds_read_b128 v[72:75], v6 offset:1024
  ds_read_b128 v[88:91], v6 offset:9216
  ds_read_b64 v[30:31], v18 offset:1536
  ds_read_b128 v[76:79], v6 offset:2048
  ds_read_b128 v[92:95], v6 offset:10240
  ds_read_b64 v[32:33], v18 offset:2304
  ds_read_b128 v[80:83], v6 offset:3072
  ds_read_b128 v[96:99], v6 offset:11264
  ds_read_b64 v[34:35], v18 offset:3072
  v_and_b32 v7, 1, v3
  v_cmp_eq_u32 vcc, 1, v7
  v_lshrrev_b32 v8, 1, v2
  s_nop 0
  v_cndmask_b32 v112, v112, v113, vcc
  v_cmp_eq_u32 vcc, 0, v5
  v_lshlrev_b32 v8, 6, v8
  s_nop 0
  v_cndmask_b32 v112, 0, v112, vcc
  v_cvt_pk_bf16_f32 v113, v112, v112
  v_and_b32 v113, 0xffff0000, v113
  v_sub_f32 v112, v112, v113
  v_cvt_pk_bf16_f32 v114, v112, v112
  v_and_b32 v114, 0xffff0000, v114
  v_sub_f32 v112, v112, v114
  v_cvt_pk_bf16_f32 v116, v113, v114
  v_cvt_pk_bf16_f32 v117, v112, 0
  v_mov_b32 v118, 0
  v_mov_b32 v119, 0
  buffer_load_dwordx4 a[20:23], v16, s[60:63], s4 offen sc1
  buffer_load_dwordx4 a[24:27], v15, s[60:63], s4 offen offset:2048 sc1
  v_and_b32 v7, 1, v2
  v_lshl_add_u32 v8, v7, 3, v8
  v_lshl_add_u32 v7, v3, 4, v8
  s_lshl_b32 s82, s87, 12
  s_lshl_b32 s85, s90, 11
  s_add_u32 s82, s82, s85
  s_add_u32 s82, s82, 0x1000000
  s_waitcnt lgkmcnt(9)
  v_lshlrev_b32 v20, 16, v28
  v_and_b32 v21, 0xffff0000, v28
  v_lshlrev_b32 v22, 16, v29
  v_and_b32 v23, 0xffff0000, v29
  v_pk_add_f32 v[68:69], v[68:69], v[84:85]
  v_pk_add_f32 v[70:71], v[70:71], v[86:87]
  v_fma_f32 v68, v20, v27, v68
  v_fma_f32 v69, v21, v27, v69
  v_fma_f32 v70, v22, v27, v70
  v_fma_f32 v71, v23, v27, v71
  v_cvt_pk_bf16_f32 v28, v68, v69
  v_cvt_pk_bf16_f32 v29, v70, v71
  buffer_store_dwordx2 v[28:29], v7, s[60:63], s82 offen offset:0 sc1
  buffer_load_dwordx4 a[28:31], v16, s[60:63], s4 offen offset:2048 sc1
  s_waitcnt lgkmcnt(6)
  v_lshlrev_b32 v20, 16, v30
  v_and_b32 v21, 0xffff0000, v30
  v_lshlrev_b32 v22, 16, v31
  v_and_b32 v23, 0xffff0000, v31
  v_pk_add_f32 v[72:73], v[72:73], v[88:89]
  v_pk_add_f32 v[74:75], v[74:75], v[90:91]
  v_fma_f32 v72, v20, v27, v72
  v_fma_f32 v73, v21, v27, v73
  v_fma_f32 v74, v22, v27, v74
  v_fma_f32 v75, v23, v27, v75
  v_cvt_pk_bf16_f32 v30, v72, v73
  v_cvt_pk_bf16_f32 v31, v74, v75
  buffer_store_dwordx2 v[30:31], v7, s[60:63], s82 offen offset:512 sc1
  s_add_u32 s4, s4, 0x1000
  buffer_load_dwordx4 a[32:35], v15, s[60:63], s4 offen sc1
  s_waitcnt lgkmcnt(3)
  v_lshlrev_b32 v20, 16, v32
  v_and_b32 v21, 0xffff0000, v32
  v_lshlrev_b32 v22, 16, v33
  v_and_b32 v23, 0xffff0000, v33
  v_pk_add_f32 v[76:77], v[76:77], v[92:93]
  v_pk_add_f32 v[78:79], v[78:79], v[94:95]
  v_fma_f32 v76, v20, v27, v76
  v_fma_f32 v77, v21, v27, v77
  v_fma_f32 v78, v22, v27, v78
  v_fma_f32 v79, v23, v27, v79
  v_cvt_pk_bf16_f32 v32, v76, v77
  v_cvt_pk_bf16_f32 v33, v78, v79
  buffer_store_dwordx2 v[32:33], v7, s[60:63], s82 offen offset:1024 sc1
  buffer_load_dwordx4 a[36:39], v16, s[60:63], s4 offen sc1
  s_waitcnt lgkmcnt(0)
  v_lshlrev_b32 v20, 16, v34
  v_and_b32 v21, 0xffff0000, v34
  v_lshlrev_b32 v22, 16, v35
  v_and_b32 v23, 0xffff0000, v35
  v_pk_add_f32 v[80:81], v[80:81], v[96:97]
  v_pk_add_f32 v[82:83], v[82:83], v[98:99]
  v_fma_f32 v80, v20, v27, v80
  v_fma_f32 v81, v21, v27, v81
  v_fma_f32 v82, v22, v27, v82
  v_fma_f32 v83, v23, v27, v83
  v_cvt_pk_bf16_f32 v34, v80, v81
  v_cvt_pk_bf16_f32 v35, v82, v83
  buffer_store_dwordx2 v[34:35], v7, s[60:63], s82 offen offset:1536 sc1
  buffer_load_dwordx4 a[40:43], v15, s[60:63], s4 offen offset:2048 sc1
  s_cmp_ge_u32 s35, 28
  s_cbranch_scc1 L_p3skip_41
  v_lshlrev_b32 v22, 4, v4
  v_add_u32 v22, 0x27000, v22
  v_add_u32 v23, 0x10000, v38
  s_barrier
  ds_read_b128 v[24:27], v22 offset:0
  ds_read_b128 v[84:87], v38 offset:0
  ds_read_b128 v[88:91], v38 offset:1024
  ds_read_b128 v[92:95], v38 offset:2048
  ds_read_b128 v[96:99], v38 offset:3072
  ds_read_b128 v[100:103], v38 offset:4096
  s_waitcnt lgkmcnt(5)
  v_mfma_f32_32x32x16_bf16 v[40:55], v[116:119], v[24:27], 0
  ds_read_b128 v[104:107], v38 offset:5120
  s_waitcnt lgkmcnt(4)
  v_mfma_f32_32x32x16_bf16 v[40:55], v[128:131], v[84:87], v[40:55]
  buffer_load_dwordx4 a[44:47], v16, s[60:63], s4 offen offset:2048 sc1
  s_and_b32 s82, s76, 1
  s_xor_b32 s83, s82, 1
  s_lshl_b32 s66, s82, 5
  s_lshl_b32 s67, s83, 5
  ds_read_b128 v[84:87], v38 offset:6144
  v_mfma_f32_32x32x16_bf16 v[40:55], v[132:135], v[88:91], v[40:55]
  s_lshr_b32 s81, s78, 5
  s_mul_i32 s84, s81, 114688
  s_mul_i32 s85, s3, 28672
  ds_read_b128 v[88:91], v38 offset:7168
  s_waitcnt lgkmcnt(4)
  v_mfma_f32_32x32x16_bf16 v[40:55], v[136:139], v[92:95], v[40:55]
  s_add_u32 s8, s8, s12
  s_add_u32 s88, s8, 0x0
  s_add_u32 m0, s23, 0x10000
  s_nop 0
  buffer_load_dwordx4 v64, s[60:63], s88 offen sc1 lds
  s_add_u32 s84, s84, s85
  s_add_u32 s84, s84, 0x600000
  s_mul_i32 s24, s82, 129024
  ds_read_b128 v[92:95], v38 offset:8192
  v_mfma_f32_32x32x16_bf16 v[40:55], v[140:143], v[96:99], v[40:55]
  s_add_u32 s24, s24, s84
  s_mul_i32 s25, s83, 114688
  s_mul_i32 s85, s82, 14336
  s_add_u32 s25, s25, s85
  ds_read_b128 v[96:99], v38 offset:9216
  s_waitcnt lgkmcnt(4)
  v_mfma_f32_32x32x16_bf16 v[40:55], v[144:147], v[100:103], v[40:55]
  buffer_load_dwordx4 v65, s[60:63], s88 offen offset:1024 sc1 lds
  s_add_u32 s25, s25, s84
  s_mul_i32 s26, s83, 129024
  s_add_u32 s26, s26, s84
  ds_read_b128 v[100:103], v38 offset:10240
  v_mfma_f32_32x32x16_bf16 v[40:55], v[148:151], v[104:107], v[40:55]
  s_mul_i32 s27, s82, 114688
  s_mul_i32 s85, s83, 14336
  s_add_u32 s27, s27, s85
  ds_read_b128 v[104:107], v38 offset:11264
  s_waitcnt lgkmcnt(4)
  v_mfma_f32_32x32x16_bf16 v[40:55], v[152:155], v[84:87], v[40:55]
  buffer_load_dwordx4 v66, s[60:63], s88 offen offset:2048 sc1 lds
  s_add_u32 s27, s27, s84
  s_lshr_b32 s81, s78, 7
  s_lshl_b32 s84, s81, 10
  s_lshl_b32 s85, s3, 5
  ds_read_b128 v[84:87], v38 offset:12288
  v_mfma_f32_32x32x16_bf16 v[40:55], v[156:159], v[88:91], v[40:55]
  s_add_u32 s84, s84, s85
  s_add_u32 s84, s84, 0x8000
  v_min_u32 v6, 6, v1
  ds_read_b128 v[88:91], v38 offset:13312
  s_waitcnt lgkmcnt(4)
  v_mfma_f32_32x32x16_bf16 v[40:55], v[160:163], v[92:95], v[40:55]
  buffer_load_dwordx4 v67, s[60:63], s88 offen offset:3072 sc1 lds
  v_lshl_add_u32 v14, v6, 2, s84
  s_mul_i32 s19, s82, 896
  s_mul_i32 s20, s82, 384
  ds_read_b128 v[92:95], v38 offset:14336
  v_mfma_f32_32x32x16_bf16 v[40:55], v[164:167], v[96:99], v[40:55]
  s_add_u32 s20, s20, 0x100
  s_lshl_b32 s21, s82, 7
  s_add_u32 s21, s21, 0x180
  s_mul_i32 s22, s82, 640
  ds_read_b128 v[96:99], v38 offset:15360
  s_waitcnt lgkmcnt(4)
  v_mfma_f32_32x32x16_bf16 v[40:55], v[168:171], v[100:103], v[40:55]
  s_add_u32 s88, s8, 0x40000
  s_add_u32 m0, s23, 0x11000
  s_nop 0
  buffer_load_dwordx4 v64, s[60:63], s88 offen sc1 lds
  s_add_u32 s22, s22, 0x80
  s_lshl_b32 s81, s78, 10
  s_lshl_b32 s85, s77, 7
  ds_read_b128 v[100:103], v38 offset:16384
  v_mfma_f32_32x32x16_bf16 v[40:55], v[172:175], v[104:107], v[40:55]
  s_add_u32 s81, s81, s85
  s_lshl_b32 s85, s90, 6
  s_add_u32 s81, s81, s85
  ds_read_b128 v[104:107], v38 offset:17408
  s_waitcnt lgkmcnt(4)
  v_mfma_f32_32x32x16_bf16 v[40:55], v[176:179], v[84:87], v[40:55]
  buffer_load_dwordx4 v65, s[60:63], s88 offen offset:1024 sc1 lds
  s_lshl_b32 s85, s89, 5
  s_add_u32 s81, s81, s85
  v_lshlrev_b32 v6, 10, v4
  v_add_u32 v6, s81, v6
  ds_read_b128 v[84:87], v38 offset:18432
  v_mfma_f32_32x32x16_bf16 v[40:55], v[180:183], v[88:91], v[40:55]
  v_lshl_add_u32 v3, v5, 4, v6
  s_lshl_b32 s81, s90, 6
  s_lshl_b32 s85, s89, 5
  ds_read_b128 v[88:91], v38 offset:19456
  s_waitcnt lgkmcnt(4)
  v_mfma_f32_32x32x16_bf16 v[40:55], v[184:187], v[92:95], v[40:55]
  buffer_load_dwordx4 v66, s[60:63], s88 offen offset:2048 sc1 lds
  s_add_u32 s81, s81, s85
  s_add_u32 s81, s81, 0x24000
  v_mul_u32_u24 v11, 136, v4
  ds_read_b128 v[92:95], v38 offset:20480
  v_mfma_f32_32x32x16_bf16 v[40:55], v[188:191], v[96:99], v[40:55]
  s_waitcnt vmcnt(9)
  s_mov_b64 exec, 1
  buffer_store_dword v10, v9, s[60:63], s7 offen sc1
  s_mov_b64 exec, -1
  v_lshl_add_u32 v11, v5, 3, v11
  v_add_u32 v11, s81, v11
  s_lshl_b32 s81, s77, 18
  ds_read_b128 v[96:99], v38 offset:21504
  s_waitcnt lgkmcnt(4)
  v_mfma_f32_32x32x16_bf16 v[40:55], v[192:195], v[100:103], v[40:55]
  buffer_load_dwordx4 v67, s[60:63], s88 offen offset:3072 sc1 lds
  s_lshl_b32 s85, s90, 17
  s_add_u32 s81, s81, s85
  s_lshl_b32 s85, s89, 3
  s_add_u32 s81, s81, s85
  ds_read_b128 v[100:103], v38 offset:22528
  v_mfma_f32_32x32x16_bf16 v[40:55], v[196:199], v[104:107], v[40:55]
  s_lshl_b32 s85, s78, 4
  s_add_u32 s81, s81, s85
  s_add_u32 s81, s81, 0x300000
  ds_read_b128 v[104:107], v38 offset:23552
  s_waitcnt lgkmcnt(4)
  v_mfma_f32_32x32x16_bf16 v[40:55], v[200:203], v[84:87], v[40:55]
  s_add_u32 s8, s8, s12
  s_add_u32 s88, s8, 0x0
  s_add_u32 m0, s23, 0x18000
  s_nop 0
  buffer_load_dwordx4 v64, s[60:63], s88 offen sc1 lds
  v_lshl_add_u32 v6, v5, 11, v4
  v_lshl_add_u32 v12, v6, 4, s81
  s_lshl_b32 s81, s77, 18
  ds_read_b128 v[84:87], v38 offset:24576
  v_mfma_f32_32x32x16_bf16 v[40:55], v[204:207], v[88:91], v[40:55]
  s_lshl_b32 s85, s90, 17
  s_add_u32 s81, s81, s85
  s_lshl_b32 s85, s89, 16
  s_add_u32 s81, s81, s85
  ds_read_b128 v[88:91], v38 offset:25600
  s_waitcnt lgkmcnt(4)
  v_mfma_f32_32x32x16_bf16 v[40:55], v[208:211], v[92:95], v[40:55]
  buffer_load_dwordx4 v65, s[60:63], s88 offen offset:1024 sc1 lds
  s_lshl_b32 s85, s78, 1
  s_add_u32 s81, s81, s85
  s_add_u32 s81, s81, 0x1000000
  ds_read_b128 v[92:95], v38 offset:26624
  v_mfma_f32_32x32x16_bf16 v[40:55], v[212:215], v[96:99], v[40:55]
  v_lshrrev_b32 v6, 2, v1
  v_lshlrev_b32 v6, 12, v6
  v_and_b32 v7, 3, v1
  ds_read_b128 v[96:99], v38 offset:27648
  s_waitcnt lgkmcnt(4)
  v_mfma_f32_32x32x16_bf16 v[40:55], v[216:219], v[100:103], v[40:55]
  buffer_load_dwordx4 v66, s[60:63], s88 offen offset:2048 sc1 lds
  v_lshl_add_u32 v6, v7, 4, v6
  v_add_u32 v13, s81, v6
  s_lshl_b32 s81, s3, 11
  s_add_u32 s81, s81, 0xc000
  ds_read_b128 v[100:103], v38 offset:28672
  v_mfma_f32_32x32x16_bf16 v[40:55], v[220:223], v[104:107], v[40:55]
  v_add_u32 v17, s81, v37
  s_xor_b32 s81, s3, 1
  s_mul_i32 s82, s81, 6144
  ds_read_b128 v[104:107], v38 offset:29696
  s_waitcnt lgkmcnt(4)
  v_mfma_f32_32x32x16_bf16 v[40:55], v[224:227], v[84:87], v[40:55]
  buffer_load_dwordx4 v67, s[60:63], s88 offen offset:3072 sc1 lds
  v_add_u32 v18, s82, v38
  s_xor_b32 s81, s3, 2
  s_mul_i32 s82, s81, 6144
  ds_read_b128 v[84:87], v38 offset:30720
  v_mfma_f32_32x32x16_bf16 v[40:55], v[228:231], v[88:91], v[40:55]
  s_add_u32 s82, s82, 0x800
  v_add_u32 v19, s82, v38
  s_xor_b32 s81, s3, 3
  s_mul_i32 s82, s81, 6144
  ds_read_b128 v[88:91], v38 offset:31744
  s_waitcnt lgkmcnt(4)
  v_mfma_f32_32x32x16_bf16 v[40:55], v[232:235], v[92:95], v[40:55]
  s_add_u32 s88, s8, 0x40000
  s_add_u32 m0, s23, 0x19000
  s_nop 0
  buffer_load_dwordx4 v64, s[60:63], s88 offen sc1 lds
  s_add_u32 s82, s82, 0x1000
  v_add_u32 v20, s82, v38
  s_mul_i32 s81, s3, 6144
  v_mfma_f32_32x32x16_bf16 v[40:55], v[236:239], v[96:99], v[40:55]
  v_add_u32 v21, s81, v38
  s_lshr_b32 s82, s34, 2
  s_lshl_b32 s81, s77, 9
  s_waitcnt lgkmcnt(2)
  v_mfma_f32_32x32x16_bf16 v[40:55], v[240:243], v[100:103], v[40:55]
  buffer_load_dwordx4 v65, s[60:63], s88 offen offset:1024 sc1 lds
  s_lshl_b32 s85, s82, 8
  s_add_u32 s81, s81, s85
  s_lshl_b32 s85, s90, 6
  s_add_u32 s81, s81, s85
  v_mfma_f32_32x32x16_bf16 v[40:55], v[244:247], v[104:107], v[40:55]
  s_lshl_b32 s85, s89, 5
  s_add_u32 s81, s81, s85
  s_add_u32 s81, s81, 0x5000
  s_waitcnt lgkmcnt(0)
  v_mfma_f32_32x32x16_bf16 v[40:55], v[248:251], v[84:87], v[40:55]
  buffer_load_dwordx4 v66, s[60:63], s88 offen offset:2048 sc1 lds
  v_bfe_u32 v6, v1, 3, 1
  v_and_b32 v7, 7, v1
  v_lshl_add_u32 v6, v6, 5, v7
  v_mfma_f32_32x32x16_bf16 v[40:55], v[252:255], v[88:91], v[40:55]
  v_lshl_add_u32 v2, v6, 2, s81
  s_mov_b32 s64, 0xbfb8aa3b
  s_mov_b32 s65, 0xbfb8aa3b
  s_barrier
  ds_read_b128 v[28:31], v22 offset:512
  ds_read_b128 v[84:87], v38 offset:32768
  ds_read_b128 v[88:91], v38 offset:33792
  ds_read_b128 v[92:95], v38 offset:34816
  ds_read_b128 v[96:99], v38 offset:35840
  ds_read_b128 v[100:103], v38 offset:36864
  s_waitcnt lgkmcnt(5)
  v_mfma_f32_32x32x16_bf16 v[68:83], v[116:119], v[28:31], 0
  ds_read_b128 v[104:107], v38 offset:37888
  s_waitcnt lgkmcnt(4)
  v_mfma_f32_32x32x16_bf16 v[68:83], v[128:131], v[84:87], v[68:83]
  buffer_load_dwordx4 v67, s[60:63], s88 offen offset:3072 sc1 lds
  v_mul_f32 v40, v40, v26
  v_mul_f32 v41, v41, v26
  v_mul_f32 v42, v42, v26
  v_mul_f32 v43, v43, v26
  ds_read_b128 v[84:87], v38 offset:38912
  v_mfma_f32_32x32x16_bf16 v[68:83], v[132:135], v[88:91], v[68:83]
  v_fma_f32 v36, v40, v40, s72
  v_fma_f32 v39, v41, v41, s72
  v_fma_f32 v120, v42, v42, s72
  v_fma_f32 v121, v43, v43, s72
  ds_read_b128 v[88:91], v38 offset:39936
  s_waitcnt lgkmcnt(4)
  v_mfma_f32_32x32x16_bf16 v[68:83], v[136:139], v[92:95], v[68:83]
  s_add_u32 s4, s4, 0x1000
  buffer_load_dwordx4 a[48:51], v15, s[60:63], s4 offen sc1
  v_mul_f32 v36, v36, v40
  v_mul_f32 v39, v39, v41
  v_mul_f32 v120, v120, v42
  v_mul_f32 v121, v121, v43
  ds_read_b128 v[92:95], v38 offset:40960
  v_mfma_f32_32x32x16_bf16 v[68:83], v[140:143], v[96:99], v[68:83]
  v_exp_f32 v36, v36
  v_exp_f32 v39, v39
  v_exp_f32 v120, v120
  v_exp_f32 v121, v121
  ds_read_b128 v[96:99], v38 offset:41984
  s_waitcnt lgkmcnt(4)
  v_mfma_f32_32x32x16_bf16 v[68:83], v[144:147], v[100:103], v[68:83]
  buffer_load_dwordx4 a[52:55], v16, s[60:63], s4 offen sc1
  v_fma_f32 v36, v36, s74, s74
  v_fma_f32 v39, v39, s74, s74
  v_fma_f32 v120, v120, s74, s74
  v_fma_f32 v121, v121, s74, s74
  ds_read_b128 v[100:103], v38 offset:43008
  v_mfma_f32_32x32x16_bf16 v[68:83], v[148:151], v[104:107], v[68:83]
  v_rcp_f32 v36, v36
  v_rcp_f32 v39, v39
  v_rcp_f32 v120, v120
  ds_read_b128 v[104:107], v38 offset:44032
  s_waitcnt lgkmcnt(4)
  v_mfma_f32_32x32x16_bf16 v[68:83], v[152:155], v[84:87], v[68:83]
  buffer_load_dwordx4 a[56:59], v15, s[60:63], s4 offen offset:2048 sc1
  v_rcp_f32 v121, v121
  v_mul_f32 v36, v36, v40
  v_mul_f32 v39, v39, v41
  v_mul_f32 v120, v120, v42
  ds_read_b128 v[84:87], v38 offset:45056
  v_mfma_f32_32x32x16_bf16 v[68:83], v[156:159], v[88:91], v[68:83]
  v_mul_f32 v121, v121, v43
  v_cvt_pk_bf16_f32 v56, v36, v39
  v_cvt_pk_bf16_f32 v57, v120, v121
  v_mul_f32 v44, v44, v26
  ds_read_b128 v[88:91], v38 offset:46080
  s_waitcnt lgkmcnt(4)
  v_mfma_f32_32x32x16_bf16 v[68:83], v[160:163], v[92:95], v[68:83]
  buffer_load_dwordx4 a[60:63], v16, s[60:63], s4 offen offset:2048 sc1
  v_mul_f32 v45, v45, v26
  v_mul_f32 v46, v46, v26
  v_mul_f32 v47, v47, v26
  v_fma_f32 v36, v44, v44, s72
  ds_read_b128 v[92:95], v38 offset:47104
  v_mfma_f32_32x32x16_bf16 v[68:83], v[164:167], v[96:99], v[68:83]
  v_fma_f32 v39, v45, v45, s72
  v_fma_f32 v120, v46, v46, s72
  v_fma_f32 v121, v47, v47, s72
  v_mul_f32 v36, v36, v44
  ds_read_b128 v[96:99], v38 offset:48128
  s_waitcnt lgkmcnt(4)
  v_mfma_f32_32x32x16_bf16 v[68:83], v[168:171], v[100:103], v[68:83]
  s_add_u32 s4, s4, 0x1000
  buffer_load_dwordx4 a[64:67], v15, s[60:63], s4 offen sc1
  v_mul_f32 v39, v39, v45
  v_mul_f32 v120, v120, v46
  v_mul_f32 v121, v121, v47
  ds_read_b128 v[100:103], v38 offset:49152
  v_mfma_f32_32x32x16_bf16 v[68:83], v[172:175], v[104:107], v[68:83]
  v_exp_f32 v36, v36
  v_exp_f32 v39, v39
  v_exp_f32 v120, v120
  v_exp_f32 v121, v121
  ds_read_b128 v[104:107], v38 offset:50176
  s_waitcnt lgkmcnt(4)
  v_mfma_f32_32x32x16_bf16 v[68:83], v[176:179], v[84:87], v[68:83]
  buffer_load_dwordx4 a[68:71], v16, s[60:63], s4 offen sc1
  v_fma_f32 v36, v36, s74, s74
  v_fma_f32 v39, v39, s74, s74
  v_fma_f32 v120, v120, s74, s74
  v_fma_f32 v121, v121, s74, s74
  ds_read_b128 v[84:87], v38 offset:51200
  v_mfma_f32_32x32x16_bf16 v[68:83], v[180:183], v[88:91], v[68:83]
  v_rcp_f32 v36, v36
  v_rcp_f32 v39, v39
  v_rcp_f32 v120, v120
  v_rcp_f32 v121, v121
  ds_read_b128 v[88:91], v38 offset:52224
  s_waitcnt lgkmcnt(4)
  v_mfma_f32_32x32x16_bf16 v[68:83], v[184:187], v[92:95], v[68:83]
  buffer_load_dwordx4 a[72:75], v15, s[60:63], s4 offen offset:2048 sc1
  v_mul_f32 v36, v36, v44
  v_mul_f32 v39, v39, v45
  v_mul_f32 v120, v120, v46
  v_mul_f32 v121, v121, v47
  ds_read_b128 v[92:95], v38 offset:53248
  v_mfma_f32_32x32x16_bf16 v[68:83], v[188:191], v[96:99], v[68:83]
  v_cvt_pk_bf16_f32 v58, v36, v39
  v_cvt_pk_bf16_f32 v59, v120, v121
  buffer_store_dwordx4 v[56:59], v38, s[60:63], s13 offen sc1
  ds_read_b128 v[96:99], v38 offset:54272
  s_waitcnt lgkmcnt(4)
  v_mfma_f32_32x32x16_bf16 v[68:83], v[192:195], v[100:103], v[68:83]
  buffer_load_dwordx4 a[76:79], v16, s[60:63], s4 offen offset:2048 sc1
  v_mul_f32 v48, v48, v26
  v_mul_f32 v49, v49, v26
  v_mul_f32 v50, v50, v26
  v_mul_f32 v51, v51, v26
  ds_read_b128 v[100:103], v38 offset:55296
  v_mfma_f32_32x32x16_bf16 v[68:83], v[196:199], v[104:107], v[68:83]
  v_fma_f32 v36, v48, v48, s72
  v_fma_f32 v39, v49, v49, s72
  v_fma_f32 v120, v50, v50, s72
  v_fma_f32 v121, v51, v51, s72
  ds_read_b128 v[104:107], v38 offset:56320
  s_waitcnt lgkmcnt(4)
  v_mfma_f32_32x32x16_bf16 v[68:83], v[200:203], v[84:87], v[68:83]
  s_add_u32 s4, s4, 0x1000
  buffer_load_dwordx4 a[80:83], v15, s[60:63], s4 offen sc1
  v_mul_f32 v36, v36, v48
  v_mul_f32 v39, v39, v49
  v_mul_f32 v120, v120, v50
  v_mul_f32 v121, v121, v51
  ds_read_b128 v[84:87], v38 offset:57344
  v_mfma_f32_32x32x16_bf16 v[68:83], v[204:207], v[88:91], v[68:83]
  v_exp_f32 v36, v36
  v_exp_f32 v39, v39
  v_exp_f32 v120, v120
  v_exp_f32 v121, v121
  ds_read_b128 v[88:91], v38 offset:58368
  s_waitcnt lgkmcnt(4)
  v_mfma_f32_32x32x16_bf16 v[68:83], v[208:211], v[92:95], v[68:83]
  buffer_load_dwordx4 a[84:87], v16, s[60:63], s4 offen sc1
  v_fma_f32 v36, v36, s74, s74
  v_fma_f32 v39, v39, s74, s74
  v_fma_f32 v120, v120, s74, s74
  v_fma_f32 v121, v121, s74, s74
  ds_read_b128 v[92:95], v38 offset:59392
  v_mfma_f32_32x32x16_bf16 v[68:83], v[212:215], v[96:99], v[68:83]
  v_rcp_f32 v36, v36
  v_rcp_f32 v39, v39
  v_rcp_f32 v120, v120
  ds_read_b128 v[96:99], v38 offset:60416
  s_waitcnt lgkmcnt(4)
  v_mfma_f32_32x32x16_bf16 v[68:83], v[216:219], v[100:103], v[68:83]
  buffer_load_dwordx4 a[88:91], v15, s[60:63], s4 offen offset:2048 sc1
  v_rcp_f32 v121, v121
  v_mul_f32 v36, v36, v48
  v_mul_f32 v39, v39, v49
  v_mul_f32 v120, v120, v50
  ds_read_b128 v[100:103], v38 offset:61440
  v_mfma_f32_32x32x16_bf16 v[68:83], v[220:223], v[104:107], v[68:83]
  v_mul_f32 v121, v121, v51
  v_cvt_pk_bf16_f32 v60, v36, v39
  v_cvt_pk_bf16_f32 v61, v120, v121
  v_mul_f32 v52, v52, v26
  ds_read_b128 v[104:107], v38 offset:62464
  s_waitcnt lgkmcnt(4)
  v_mfma_f32_32x32x16_bf16 v[68:83], v[224:227], v[84:87], v[68:83]
  buffer_load_dwordx4 a[92:95], v16, s[60:63], s4 offen offset:2048 sc1
  v_mul_f32 v53, v53, v26
  v_mul_f32 v54, v54, v26
  v_mul_f32 v55, v55, v26
  v_fma_f32 v36, v52, v52, s72
  ds_read_b128 v[84:87], v38 offset:63488
  v_mfma_f32_32x32x16_bf16 v[68:83], v[228:231], v[88:91], v[68:83]
  v_fma_f32 v39, v53, v53, s72
  v_fma_f32 v120, v54, v54, s72
  v_fma_f32 v121, v55, v55, s72
  v_mul_f32 v36, v36, v52
  ds_read_b128 v[88:91], v38 offset:64512
  s_waitcnt lgkmcnt(4)
  v_mfma_f32_32x32x16_bf16 v[68:83], v[232:235], v[92:95], v[68:83]
  s_add_u32 s4, s4, 0x1000
  buffer_load_dwordx4 a[96:99], v15, s[60:63], s4 offen sc1
  v_mul_f32 v39, v39, v53
  v_mul_f32 v120, v120, v54
  v_mul_f32 v121, v121, v55
  v_mfma_f32_32x32x16_bf16 v[68:83], v[236:239], v[96:99], v[68:83]
  v_exp_f32 v36, v36
  v_exp_f32 v39, v39
  v_exp_f32 v120, v120
  v_exp_f32 v121, v121
  s_waitcnt lgkmcnt(2)
  v_mfma_f32_32x32x16_bf16 v[68:83], v[240:243], v[100:103], v[68:83]
  buffer_load_dwordx4 a[100:103], v16, s[60:63], s4 offen sc1
  v_fma_f32 v36, v36, s74, s74
  v_fma_f32 v39, v39, s74, s74
  v_fma_f32 v120, v120, s74, s74
  v_fma_f32 v121, v121, s74, s74
  v_mfma_f32_32x32x16_bf16 v[68:83], v[244:247], v[104:107], v[68:83]
  v_rcp_f32 v36, v36
  v_rcp_f32 v39, v39
  v_rcp_f32 v120, v120
  v_rcp_f32 v121, v121
  s_waitcnt lgkmcnt(0)
  v_mfma_f32_32x32x16_bf16 v[68:83], v[248:251], v[84:87], v[68:83]
  buffer_load_dwordx4 a[104:107], v15, s[60:63], s4 offen offset:2048 sc1
  v_mul_f32 v36, v36, v52
  v_mul_f32 v39, v39, v53
  v_mul_f32 v120, v120, v54
  v_mul_f32 v121, v121, v55
  v_mfma_f32_32x32x16_bf16 v[68:83], v[252:255], v[88:91], v[68:83]
  v_cvt_pk_bf16_f32 v62, v36, v39
  v_cvt_pk_bf16_f32 v63, v120, v121
  buffer_store_dwordx4 v[60:63], v38, s[60:63], s13 offen offset:1024 sc1
  s_add_u32 s13, s13, s17
  s_waitcnt vmcnt(25)
  s_barrier
  ds_read_b128 v[24:27], v22 offset:1024
  ds_read_b128 v[84:87], v23 offset:0
  ds_read_b128 v[88:91], v23 offset:1024
  ds_read_b128 v[92:95], v23 offset:2048
  ds_read_b128 v[96:99], v23 offset:3072
  ds_read_b128 v[100:103], v23 offset:4096
  s_waitcnt lgkmcnt(5)
  v_mfma_f32_32x32x16_bf16 v[40:55], v[116:119], v[24:27], 0
  ds_read_b128 v[104:107], v23 offset:5120
  s_waitcnt lgkmcnt(4)
  v_mfma_f32_32x32x16_bf16 v[40:55], v[128:131], v[84:87], v[40:55]
  buffer_load_dwordx4 a[108:111], v16, s[60:63], s4 offen offset:2048 sc1
  v_mul_f32 v68, v68, v30
  v_mul_f32 v69, v69, v30
  v_mul_f32 v70, v70, v30
  v_mul_f32 v71, v71, v30
  ds_read_b128 v[84:87], v23 offset:6144
  v_mfma_f32_32x32x16_bf16 v[40:55], v[132:135], v[88:91], v[40:55]
  v_fma_f32 v36, v68, v68, s72
  v_fma_f32 v39, v69, v69, s72
  v_fma_f32 v120, v70, v70, s72
  v_fma_f32 v121, v71, v71, s72
  ds_read_b128 v[88:91], v23 offset:7168
  s_waitcnt lgkmcnt(4)
  v_mfma_f32_32x32x16_bf16 v[40:55], v[136:139], v[92:95], v[40:55]
  s_mov_b32 s4, s9
  buffer_load_dwordx4 a[112:115], v15, s[60:63], s4 offen sc1
  v_mul_f32 v36, v36, v68
  v_mul_f32 v39, v39, v69
  v_mul_f32 v120, v120, v70
  v_mul_f32 v121, v121, v71
  ds_read_b128 v[92:95], v23 offset:8192
  v_mfma_f32_32x32x16_bf16 v[40:55], v[140:143], v[96:99], v[40:55]
  v_exp_f32 v36, v36
  v_exp_f32 v39, v39
  v_exp_f32 v120, v120
  v_exp_f32 v121, v121
  ds_read_b128 v[96:99], v23 offset:9216
  s_waitcnt lgkmcnt(4)
  v_mfma_f32_32x32x16_bf16 v[40:55], v[144:147], v[100:103], v[40:55]
  buffer_load_dwordx4 a[116:119], v16, s[60:63], s4 offen sc1
  v_fma_f32 v36, v36, s74, s74
  v_fma_f32 v39, v39, s74, s74
  v_fma_f32 v120, v120, s74, s74
  v_fma_f32 v121, v121, s74, s74
  ds_read_b128 v[100:103], v23 offset:10240
  v_mfma_f32_32x32x16_bf16 v[40:55], v[148:151], v[104:107], v[40:55]
  v_rcp_f32 v36, v36
  v_rcp_f32 v39, v39
  v_rcp_f32 v120, v120
  ds_read_b128 v[104:107], v23 offset:11264
  s_waitcnt lgkmcnt(4)
  v_mfma_f32_32x32x16_bf16 v[40:55], v[152:155], v[84:87], v[40:55]
  buffer_load_dwordx4 a[120:123], v15, s[60:63], s4 offen offset:2048 sc1
  v_rcp_f32 v121, v121
  v_mul_f32 v36, v36, v68
  v_mul_f32 v39, v39, v69
  v_mul_f32 v120, v120, v70
  ds_read_b128 v[84:87], v23 offset:12288
  v_mfma_f32_32x32x16_bf16 v[40:55], v[156:159], v[88:91], v[40:55]
  v_mul_f32 v121, v121, v71
  v_cvt_pk_bf16_f32 v56, v36, v39
  v_cvt_pk_bf16_f32 v57, v120, v121
  v_mul_f32 v72, v72, v30
  ds_read_b128 v[88:91], v23 offset:13312
  s_waitcnt lgkmcnt(4)
  v_mfma_f32_32x32x16_bf16 v[40:55], v[160:163], v[92:95], v[40:55]
  buffer_load_dwordx4 a[124:127], v16, s[60:63], s4 offen offset:2048 sc1
  v_mul_f32 v73, v73, v30
  v_mul_f32 v74, v74, v30
  v_mul_f32 v75, v75, v30
  v_fma_f32 v36, v72, v72, s72
  ds_read_b128 v[92:95], v23 offset:14336
  v_mfma_f32_32x32x16_bf16 v[40:55], v[164:167], v[96:99], v[40:55]
  v_fma_f32 v39, v73, v73, s72
  v_fma_f32 v120, v74, v74, s72
  v_fma_f32 v121, v75, v75, s72
  v_mul_f32 v36, v36, v72
  ds_read_b128 v[96:99], v23 offset:15360
  s_waitcnt lgkmcnt(4)
  v_mfma_f32_32x32x16_bf16 v[40:55], v[168:171], v[100:103], v[40:55]
  s_add_u32 s4, s4, 0x1000
  buffer_load_dwordx4 a[128:131], v15, s[60:63], s4 offen sc1
  v_mul_f32 v39, v39, v73
  v_mul_f32 v120, v120, v74
  v_mul_f32 v121, v121, v75
  ds_read_b128 v[100:103], v23 offset:16384
  v_mfma_f32_32x32x16_bf16 v[40:55], v[172:175], v[104:107], v[40:55]
  v_exp_f32 v36, v36
  v_exp_f32 v39, v39
  v_exp_f32 v120, v120
  v_exp_f32 v121, v121
  ds_read_b128 v[104:107], v23 offset:17408
  s_waitcnt lgkmcnt(4)
  v_mfma_f32_32x32x16_bf16 v[40:55], v[176:179], v[84:87], v[40:55]
  buffer_load_dwordx4 a[132:135], v16, s[60:63], s4 offen sc1
  v_fma_f32 v36, v36, s74, s74
  v_fma_f32 v39, v39, s74, s74
  v_fma_f32 v120, v120, s74, s74
  v_fma_f32 v121, v121, s74, s74
  ds_read_b128 v[84:87], v23 offset:18432
  v_mfma_f32_32x32x16_bf16 v[40:55], v[180:183], v[88:91], v[40:55]
  v_rcp_f32 v36, v36
  v_rcp_f32 v39, v39
  v_rcp_f32 v120, v120
  v_rcp_f32 v121, v121
  ds_read_b128 v[88:91], v23 offset:19456
  s_waitcnt lgkmcnt(4)
  v_mfma_f32_32x32x16_bf16 v[40:55], v[184:187], v[92:95], v[40:55]
  buffer_load_dwordx4 a[136:139], v15, s[60:63], s4 offen offset:2048 sc1
  v_mul_f32 v36, v36, v72
  v_mul_f32 v39, v39, v73
  v_mul_f32 v120, v120, v74
  v_mul_f32 v121, v121, v75
  ds_read_b128 v[92:95], v23 offset:20480
  v_mfma_f32_32x32x16_bf16 v[40:55], v[188:191], v[96:99], v[40:55]
  v_cvt_pk_bf16_f32 v58, v36, v39
  v_cvt_pk_bf16_f32 v59, v120, v121
  buffer_store_dwordx4 v[56:59], v38, s[60:63], s13 offen sc1
  ds_read_b128 v[96:99], v23 offset:21504
  s_waitcnt lgkmcnt(4)
  v_mfma_f32_32x32x16_bf16 v[40:55], v[192:195], v[100:103], v[40:55]
  buffer_load_dwordx4 a[140:143], v16, s[60:63], s4 offen offset:2048 sc1
  v_mul_f32 v76, v76, v30
  v_mul_f32 v77, v77, v30
  v_mul_f32 v78, v78, v30
  v_mul_f32 v79, v79, v30
  ds_read_b128 v[100:103], v23 offset:22528
  v_mfma_f32_32x32x16_bf16 v[40:55], v[196:199], v[104:107], v[40:55]
  s_waitcnt vmcnt(10)
  s_mov_b64 exec, 1
  buffer_store_dword v10, v9, s[60:63], s6 offen sc1
  s_mov_b64 exec, -1
  s_add_u32 s6, s6, s18
  v_fma_f32 v36, v76, v76, s72
  v_fma_f32 v39, v77, v77, s72
  v_fma_f32 v120, v78, v78, s72
  v_fma_f32 v121, v79, v79, s72
  ds_read_b128 v[104:107], v23 offset:23552
  s_waitcnt lgkmcnt(4)
  v_mfma_f32_32x32x16_bf16 v[40:55], v[200:203], v[84:87], v[40:55]
  s_add_u32 s4, s4, 0x1000
  buffer_load_dwordx4 a[144:147], v15, s[60:63], s4 offen sc1
  v_mul_f32 v36, v36, v76
  v_mul_f32 v39, v39, v77
  v_mul_f32 v120, v120, v78
  v_mul_f32 v121, v121, v79
  ds_read_b128 v[84:87], v23 offset:24576
  v_mfma_f32_32x32x16_bf16 v[40:55], v[204:207], v[88:91], v[40:55]
  v_exp_f32 v36, v36
  v_exp_f32 v39, v39
  v_exp_f32 v120, v120
  v_exp_f32 v121, v121
  ds_read_b128 v[88:91], v23 offset:25600
  s_waitcnt lgkmcnt(4)
  v_mfma_f32_32x32x16_bf16 v[40:55], v[208:211], v[92:95], v[40:55]
  buffer_load_dwordx4 a[148:151], v16, s[60:63], s4 offen sc1
  v_fma_f32 v36, v36, s74, s74
  v_fma_f32 v39, v39, s74, s74
  v_fma_f32 v120, v120, s74, s74
  v_fma_f32 v121, v121, s74, s74
  ds_read_b128 v[92:95], v23 offset:26624
  v_mfma_f32_32x32x16_bf16 v[40:55], v[212:215], v[96:99], v[40:55]
  v_rcp_f32 v36, v36
  v_rcp_f32 v39, v39
  v_rcp_f32 v120, v120
  ds_read_b128 v[96:99], v23 offset:27648
  s_waitcnt lgkmcnt(4)
  v_mfma_f32_32x32x16_bf16 v[40:55], v[216:219], v[100:103], v[40:55]
  buffer_load_dwordx4 a[152:155], v15, s[60:63], s4 offen offset:2048 sc1
  v_rcp_f32 v121, v121
  v_mul_f32 v36, v36, v76
  v_mul_f32 v39, v39, v77
  v_mul_f32 v120, v120, v78
  ds_read_b128 v[100:103], v23 offset:28672
  v_mfma_f32_32x32x16_bf16 v[40:55], v[220:223], v[104:107], v[40:55]
  v_mul_f32 v121, v121, v79
  v_cvt_pk_bf16_f32 v60, v36, v39
  v_cvt_pk_bf16_f32 v61, v120, v121
  v_mul_f32 v80, v80, v30
  ds_read_b128 v[104:107], v23 offset:29696
  s_waitcnt lgkmcnt(4)
  v_mfma_f32_32x32x16_bf16 v[40:55], v[224:227], v[84:87], v[40:55]
  buffer_load_dwordx4 a[156:159], v16, s[60:63], s4 offen offset:2048 sc1
  v_mul_f32 v81, v81, v30
  v_mul_f32 v82, v82, v30
  v_mul_f32 v83, v83, v30
  v_fma_f32 v36, v80, v80, s72
  ds_read_b128 v[84:87], v23 offset:30720
  v_mfma_f32_32x32x16_bf16 v[40:55], v[228:231], v[88:91], v[40:55]
  v_fma_f32 v39, v81, v81, s72
  v_fma_f32 v120, v82, v82, s72
  v_fma_f32 v121, v83, v83, s72
  v_mul_f32 v36, v36, v80
  ds_read_b128 v[88:91], v23 offset:31744
  s_waitcnt lgkmcnt(4)
  v_mfma_f32_32x32x16_bf16 v[40:55], v[232:235], v[92:95], v[40:55]
  s_add_u32 s4, s4, 0x1000
  buffer_load_dwordx4 a[160:163], v15, s[60:63], s4 offen sc1
  v_mul_f32 v39, v39, v81
  v_mul_f32 v120, v120, v82
  v_mul_f32 v121, v121, v83
  v_mfma_f32_32x32x16_bf16 v[40:55], v[236:239], v[96:99], v[40:55]
  v_exp_f32 v36, v36
  v_exp_f32 v39, v39
  v_exp_f32 v120, v120
  v_exp_f32 v121, v121
  s_waitcnt lgkmcnt(2)
  v_mfma_f32_32x32x16_bf16 v[40:55], v[240:243], v[100:103], v[40:55]
  buffer_load_dwordx4 a[164:167], v16, s[60:63], s4 offen sc1
  v_fma_f32 v36, v36, s74, s74
  v_fma_f32 v39, v39, s74, s74
  v_fma_f32 v120, v120, s74, s74
  v_fma_f32 v121, v121, s74, s74
  v_mfma_f32_32x32x16_bf16 v[40:55], v[244:247], v[104:107], v[40:55]
  v_rcp_f32 v36, v36
  v_rcp_f32 v39, v39
  v_rcp_f32 v120, v120
  v_rcp_f32 v121, v121
  s_waitcnt lgkmcnt(0)
  v_mfma_f32_32x32x16_bf16 v[40:55], v[248:251], v[84:87], v[40:55]
  buffer_load_dwordx4 a[168:171], v15, s[60:63], s4 offen offset:2048 sc1
  v_mul_f32 v36, v36, v80
  v_mul_f32 v39, v39, v81
  v_mul_f32 v120, v120, v82
  v_mul_f32 v121, v121, v83
  v_mfma_f32_32x32x16_bf16 v[40:55], v[252:255], v[88:91], v[40:55]
  v_cvt_pk_bf16_f32 v62, v36, v39
  v_cvt_pk_bf16_f32 v63, v120, v121
  buffer_store_dwordx4 v[60:63], v38, s[60:63], s13 offen offset:1024 sc1
  s_add_u32 s13, s13, s17
  s_barrier
  ds_read_b128 v[28:31], v22 offset:1536
  ds_read_b128 v[84:87], v23 offset:32768
  ds_read_b128 v[88:91], v23 offset:33792
  ds_read_b128 v[92:95], v23 offset:34816
  ds_read_b128 v[96:99], v23 offset:35840
  ds_read_b128 v[100:103], v23 offset:36864
  s_waitcnt lgkmcnt(5)
  v_mfma_f32_32x32x16_bf16 v[68:83], v[116:119], v[28:31], 0
  ds_read_b128 v[104:107], v23 offset:37888
  s_waitcnt lgkmcnt(4)
  v_mfma_f32_32x32x16_bf16 v[68:83], v[128:131], v[84:87], v[68:83]
  buffer_load_dwordx4 a[172:175], v16, s[60:63], s4 offen offset:2048 sc1
  v_mul_f32 v40, v40, v26
  v_mul_f32 v41, v41, v26
  v_mul_f32 v42, v42, v26
  v_mul_f32 v43, v43, v26
  ds_read_b128 v[84:87], v23 offset:38912
  v_mfma_f32_32x32x16_bf16 v[68:83], v[132:135], v[88:91], v[68:83]
  v_fma_f32 v36, v40, v40, s72
  v_fma_f32 v39, v41, v41, s72
  v_fma_f32 v120, v42, v42, s72
  v_fma_f32 v121, v43, v43, s72
  ds_read_b128 v[88:91], v23 offset:39936
  s_waitcnt lgkmcnt(4)
  v_mfma_f32_32x32x16_bf16 v[68:83], v[136:139], v[92:95], v[68:83]
  s_add_u32 s4, s4, 0x1000
  buffer_load_dwordx4 a[176:179], v15, s[60:63], s4 offen sc1
  v_mul_f32 v36, v36, v40
  v_mul_f32 v39, v39, v41
  v_mul_f32 v120, v120, v42
  v_mul_f32 v121, v121, v43
  ds_read_b128 v[92:95], v23 offset:40960
  v_mfma_f32_32x32x16_bf16 v[68:83], v[140:143], v[96:99], v[68:83]
  v_exp_f32 v36, v36
  v_exp_f32 v39, v39
  v_exp_f32 v120, v120
  v_exp_f32 v121, v121
  ds_read_b128 v[96:99], v23 offset:41984
  s_waitcnt lgkmcnt(4)
  v_mfma_f32_32x32x16_bf16 v[68:83], v[144:147], v[100:103], v[68:83]
  buffer_load_dwordx4 a[180:183], v16, s[60:63], s4 offen sc1
  v_fma_f32 v36, v36, s74, s74
  v_fma_f32 v39, v39, s74, s74
  v_fma_f32 v120, v120, s74, s74
  v_fma_f32 v121, v121, s74, s74
  ds_read_b128 v[100:103], v23 offset:43008
  v_mfma_f32_32x32x16_bf16 v[68:83], v[148:151], v[104:107], v[68:83]
  buffer_load_dword v7, v14, s[60:63], s19 offen sc1
  v_rcp_f32 v36, v36
  v_rcp_f32 v39, v39
  v_rcp_f32 v120, v120
  ds_read_b128 v[104:107], v23 offset:44032
  s_waitcnt lgkmcnt(4)
  v_mfma_f32_32x32x16_bf16 v[68:83], v[152:155], v[84:87], v[68:83]
  buffer_load_dwordx4 a[184:187], v15, s[60:63], s4 offen offset:2048 sc1
  v_rcp_f32 v121, v121
  v_mul_f32 v36, v36, v40
  v_mul_f32 v39, v39, v41
  v_mul_f32 v120, v120, v42
  ds_read_b128 v[84:87], v23 offset:45056
  v_mfma_f32_32x32x16_bf16 v[68:83], v[156:159], v[88:91], v[68:83]
  buffer_load_dword v8, v2, s[60:63], 0 offen sc1
  v_mul_f32 v121, v121, v43
  v_cvt_pk_bf16_f32 v56, v36, v39
  v_cvt_pk_bf16_f32 v57, v120, v121
  v_mul_f32 v44, v44, v26
  ds_read_b128 v[88:91], v23 offset:46080
  s_waitcnt lgkmcnt(4)
  v_mfma_f32_32x32x16_bf16 v[68:83], v[160:163], v[92:95], v[68:83]
  buffer_load_dwordx4 a[188:191], v16, s[60:63], s4 offen offset:2048 sc1
  v_mul_f32 v45, v45, v26
  v_mul_f32 v46, v46, v26
  v_mul_f32 v47, v47, v26
  v_fma_f32 v36, v44, v44, s72
  ds_read_b128 v[92:95], v23 offset:47104
  v_mfma_f32_32x32x16_bf16 v[68:83], v[164:167], v[96:99], v[68:83]
  s_waitcnt vmcnt(7)
  s_mov_b64 exec, 1
  buffer_store_dword v10, v9, s[60:63], s6 offen sc1
  s_mov_b64 exec, -1
  s_add_u32 s6, s6, s18
  v_fma_f32 v39, v45, v45, s72
  v_fma_f32 v120, v46, v46, s72
  v_fma_f32 v121, v47, v47, s72
  v_mul_f32 v36, v36, v44
  ds_read_b128 v[96:99], v23 offset:48128
  s_waitcnt lgkmcnt(4)
  v_mfma_f32_32x32x16_bf16 v[68:83], v[168:171], v[100:103], v[68:83]
  s_lshl_b32 s82, s66, 10
  s_lshl_b32 s84, s66, 4
  s_add_u32 s83, s84, 0x10000
  buffer_load_dwordx2 v[108:109], v12, s[60:63], s84 offen sc1
  v_mul_f32 v39, v39, v45
  v_mul_f32 v120, v120, v46
  v_mul_f32 v121, v121, v47
  ds_read_b128 v[100:103], v23 offset:49152
  v_mfma_f32_32x32x16_bf16 v[68:83], v[172:175], v[104:107], v[68:83]
  v_exp_f32 v36, v36
  v_exp_f32 v39, v39
  v_exp_f32 v120, v120
  v_exp_f32 v121, v121
  ds_read_b128 v[104:107], v23 offset:50176
  s_waitcnt lgkmcnt(4)
  v_mfma_f32_32x32x16_bf16 v[68:83], v[176:179], v[84:87], v[68:83]
  buffer_load_dwordx2 v[110:111], v12, s[60:63], s83 offen sc1
  v_fma_f32 v36, v36, s74, s74
  v_fma_f32 v39, v39, s74, s74
  v_fma_f32 v120, v120, s74, s74
  v_fma_f32 v121, v121, s74, s74
  ds_read_b128 v[84:87], v23 offset:51200
  v_mfma_f32_32x32x16_bf16 v[68:83], v[180:183], v[88:91], v[68:83]
  v_rcp_f32 v36, v36
  v_rcp_f32 v39, v39
  v_rcp_f32 v120, v120
  v_rcp_f32 v121, v121
  ds_read_b128 v[88:91], v23 offset:52224
  s_waitcnt lgkmcnt(4)
  v_mfma_f32_32x32x16_bf16 v[68:83], v[184:187], v[92:95], v[68:83]
  s_lshl_b32 s82, s67, 10
  s_lshl_b32 s84, s67, 4
  s_add_u32 s83, s84, 0x10000
  buffer_load_dwordx2 v[112:113], v12, s[60:63], s84 offen sc1
  v_mul_f32 v36, v36, v44
  v_mul_f32 v39, v39, v45
  v_mul_f32 v120, v120, v46
  v_mul_f32 v121, v121, v47
  ds_read_b128 v[92:95], v23 offset:53248
  v_mfma_f32_32x32x16_bf16 v[68:83], v[188:191], v[96:99], v[68:83]
  v_cvt_pk_bf16_f32 v58, v36, v39
  v_cvt_pk_bf16_f32 v59, v120, v121
  buffer_store_dwordx4 v[56:59], v38, s[60:63], s13 offen sc1
  ds_read_b128 v[96:99], v23 offset:54272
  s_waitcnt lgkmcnt(4)
  v_mfma_f32_32x32x16_bf16 v[68:83], v[192:195], v[100:103], v[68:83]
  buffer_load_dwordx2 v[114:115], v12, s[60:63], s83 offen sc1
  v_mul_f32 v48, v48, v26
  v_mul_f32 v49, v49, v26
  v_mul_f32 v50, v50, v26
  v_mul_f32 v51, v51, v26
  ds_read_b128 v[100:103], v23 offset:55296
  v_mfma_f32_32x32x16_bf16 v[68:83], v[196:199], v[104:107], v[68:83]
  s_waitcnt vmcnt(9)
  v_cmp_ne_u32 vcc, s80, v7
  s_cbranch_vccz L_pd_44
  s_mov_b32 s86, 0x100000
L_poll_43:
  buffer_load_dword v7, v14, s[60:63], s19 offen sc1
  s_waitcnt vmcnt(0)
  v_cmp_ne_u32 vcc, s80, v7
  s_cbranch_vccz L_pd_44
  s_sub_u32 s86, s86, 1
  s_cbranch_scc0 L_poll_43
L_pd_44:
  s_waitcnt vmcnt(7)
  v_cmp_ne_u32 vcc, s80, v8
  s_cbranch_vccz L_pd_46
  s_mov_b32 s86, 0x100000
L_poll_45:
  buffer_load_dword v8, v2, s[60:63], 0 offen sc1
  s_waitcnt vmcnt(0)
  v_cmp_ne_u32 vcc, s80, v8
  s_cbranch_vccz L_pd_46
  s_sub_u32 s86, s86, 1
  s_cbranch_scc0 L_poll_45
L_pd_46:
  s_lshl_b32 s81, s3, 11
  s_add_u32 m0, s81, 0xc000
  s_lshl_b32 s81, s66, 1
  buffer_load_dwordx4 v13, s[60:63], s81 offen sc1 lds
  s_lshl_b32 s81, s3, 11
  s_add_u32 m0, s81, 0xc400
  s_lshl_b32 s81, s67, 1
  buffer_load_dwordx4 v13, s[60:63], s81 offen sc1 lds
  v_fma_f32 v36, v48, v48, s72
  v_fma_f32 v39, v49, v49, s72
  v_fma_f32 v120, v50, v50, s72
  v_fma_f32 v121, v51, v51, s72
  ds_read_b128 v[104:107], v23 offset:56320
  s_waitcnt lgkmcnt(4)
  v_mfma_f32_32x32x16_bf16 v[68:83], v[200:203], v[84:87], v[68:83]
  v_mul_f32 v36, v36, v48
  v_mul_f32 v39, v39, v49
  v_mul_f32 v120, v120, v50
  v_mul_f32 v121, v121, v51
  ds_read_b128 v[84:87], v23 offset:57344
  v_mfma_f32_32x32x16_bf16 v[68:83], v[204:207], v[88:91], v[68:83]
  buffer_load_dwordx4 v[128:131], v38, s[60:63], s24 offen sc1
  v_exp_f32 v36, v36
  v_exp_f32 v39, v39
  v_exp_f32 v120, v120
  v_exp_f32 v121, v121
  ds_read_b128 v[88:91], v23 offset:58368
  s_waitcnt lgkmcnt(4)
  v_mfma_f32_32x32x16_bf16 v[68:83], v[208:211], v[92:95], v[68:83]
  v_fma_f32 v36, v36, s74, s74
  v_fma_f32 v39, v39, s74, s74
  v_fma_f32 v120, v120, s74, s74
  v_fma_f32 v121, v121, s74, s74
  ds_read_b128 v[92:95], v23 offset:59392
  v_mfma_f32_32x32x16_bf16 v[68:83], v[212:215], v[96:99], v[68:83]
  buffer_load_dwordx4 v[132:135], v38, s[60:63], s24 offen offset:1024 sc1
  v_rcp_f32 v36, v36
  v_rcp_f32 v39, v39
  v_rcp_f32 v120, v120
  ds_read_b128 v[96:99], v23 offset:60416
  s_waitcnt lgkmcnt(4)
  v_mfma_f32_32x32x16_bf16 v[68:83], v[216:219], v[100:103], v[68:83]
  v_rcp_f32 v121, v121
  v_mul_f32 v36, v36, v48
  v_mul_f32 v39, v39, v49
  v_mul_f32 v120, v120, v50
  ds_read_b128 v[100:103], v23 offset:61440
  v_mfma_f32_32x32x16_bf16 v[68:83], v[220:223], v[104:107], v[68:83]
  buffer_load_dwordx4 v[136:139], v38, s[60:63], s24 offen offset:2048 sc1
  v_mul_f32 v121, v121, v51
  v_cvt_pk_bf16_f32 v60, v36, v39
  v_cvt_pk_bf16_f32 v61, v120, v121
  v_mul_f32 v52, v52, v26
  ds_read_b128 v[104:107], v23 offset:62464
  s_waitcnt lgkmcnt(4)
  v_mfma_f32_32x32x16_bf16 v[68:83], v[224:227], v[84:87], v[68:83]
  v_mul_f32 v53, v53, v26
  v_mul_f32 v54, v54, v26
  v_mul_f32 v55, v55, v26
  v_fma_f32 v36, v52, v52, s72
  ds_read_b128 v[84:87], v23 offset:63488
  v_mfma_f32_32x32x16_bf16 v[68:83], v[228:231], v[88:91], v[68:83]
  buffer_load_dwordx4 v[140:143], v38, s[60:63], s24 offen offset:3072 sc1
  v_fma_f32 v39, v53, v53, s72
  v_fma_f32 v120, v54, v54, s72
  v_fma_f32 v121, v55, v55, s72
  v_mul_f32 v36, v36, v52
  ds_read_b128 v[88:91], v23 offset:64512
  s_waitcnt lgkmcnt(4)
  v_mfma_f32_32x32x16_bf16 v[68:83], v[232:235], v[92:95], v[68:83]
  v_mul_f32 v39, v39, v53
  v_mul_f32 v120, v120, v54
  v_mul_f32 v121, v121, v55
  v_mfma_f32_32x32x16_bf16 v[68:83], v[236:239], v[96:99], v[68:83]
  s_add_u32 s24, s24, 0x1000
  buffer_load_dwordx4 v[144:147], v38, s[60:63], s24 offen sc1
  v_exp_f32 v36, v36
  v_exp_f32 v39, v39
  v_exp_f32 v120, v120
  v_exp_f32 v121, v121
  s_waitcnt lgkmcnt(2)
  v_mfma_f32_32x32x16_bf16 v[68:83], v[240:243], v[100:103], v[68:83]
  v_fma_f32 v36, v36, s74, s74
  v_fma_f32 v39, v39, s74, s74
  v_fma_f32 v120, v120, s74, s74
  v_fma_f32 v121, v121, s74, s74
  v_mfma_f32_32x32x16_bf16 v[68:83], v[244:247], v[104:107], v[68:83]
  buffer_load_dwordx4 v[148:151], v38, s[60:63], s24 offen offset:1024 sc1
  v_rcp_f32 v36, v36
  v_rcp_f32 v39, v39
  v_rcp_f32 v120, v120
  v_rcp_f32 v121, v121
  s_waitcnt lgkmcnt(0)
  v_mfma_f32_32x32x16_bf16 v[68:83], v[248:251], v[84:87], v[68:83]
  v_mul_f32 v36, v36, v52
  v_mul_f32 v39, v39, v53
  v_mul_f32 v120, v120, v54
  v_mul_f32 v121, v121, v55
  v_mfma_f32_32x32x16_bf16 v[68:83], v[252:255], v[88:91], v[68:83]
  buffer_load_dwordx4 v[152:155], v38, s[60:63], s24 offen offset:2048 sc1
  v_cvt_pk_bf16_f32 v62, v36, v39
  v_cvt_pk_bf16_f32 v63, v120, v121
  buffer_store_dwordx4 v[60:63], v38, s[60:63], s13 offen offset:1024 sc1
  s_add_u32 s13, s13, s17
L_tail_42:
  s_waitcnt vmcnt(7)
  v_mfma_f32_32x32x16_bf16 v[192:207], a[0:3], v[128:131], 0
  buffer_load_dwordx4 v[156:159], v38, s[60:63], s24 offen offset:3072 sc1
  buffer_load_dword v7, v14, s[60:63], s20 offen sc1
  s_add_u32 s4, s4, 0x1000
  buffer_load_dwordx4 a[192:195], v15, s[60:63], s4 offen sc1
  v_mfma_f32_32x32x16_bf16 v[208:223], a[4:7], v[128:131], 0
  s_add_u32 s24, s24, 0x1000
  buffer_load_dwordx4 v[160:163], v38, s[60:63], s24 offen sc1
  v_mul_f32 v68, v68, v30
  v_mul_f32 v69, v69, v30
  v_mul_f32 v70, v70, v30
  v_mul_f32 v71, v71, v30
  v_fma_f32 v36, v68, v68, s72
  v_fma_f32 v39, v69, v69, s72
  s_waitcnt vmcnt(10)
  v_mfma_f32_32x32x16_bf16 v[192:207], a[8:11], v[132:135], v[192:207]
  buffer_load_dwordx4 v[164:167], v38, s[60:63], s24 offen offset:1024 sc1
  v_fma_f32 v120, v70, v70, s72
  v_fma_f32 v121, v71, v71, s72
  v_mul_f32 v36, v36, v68
  v_mul_f32 v39, v39, v69
  v_mul_f32 v120, v120, v70
  v_mul_f32 v121, v121, v71
  v_mfma_f32_32x32x16_bf16 v[208:223], a[12:15], v[132:135], v[208:223]
  buffer_load_dwordx4 v[168:171], v38, s[60:63], s24 offen offset:2048 sc1
  v_exp_f32 v36, v36
  v_exp_f32 v39, v39
  v_exp_f32 v120, v120
  v_exp_f32 v121, v121
  v_fma_f32 v36, v36, s74, s74
  v_fma_f32 v39, v39, s74, s74
  s_waitcnt vmcnt(11)
  v_mfma_f32_32x32x16_bf16 v[192:207], a[16:19], v[136:139], v[192:207]
  buffer_load_dwordx4 v[172:175], v38, s[60:63], s24 offen offset:3072 sc1
  v_fma_f32 v120, v120, s74, s74
  v_fma_f32 v121, v121, s74, s74
  v_rcp_f32 v36, v36
  v_rcp_f32 v39, v39
  v_rcp_f32 v120, v120
  v_rcp_f32 v121, v121
  buffer_load_dwordx4 a[196:199], v16, s[60:63], s4 offen sc1
  v_mfma_f32_32x32x16_bf16 v[208:223], a[20:23], v[136:139], v[208:223]
  s_add_u32 s24, s24, 0x1000
  buffer_load_dwordx4 v[176:179], v38, s[60:63], s24 offen sc1
  v_mul_f32 v36, v36, v68
  v_mul_f32 v39, v39, v69
  v_mul_f32 v120, v120, v70
  v_mul_f32 v121, v121, v71
  v_cvt_pk_bf16_f32 v56, v36, v39
  v_cvt_pk_bf16_f32 v57, v120, v121
  s_waitcnt vmcnt(13)
  v_mfma_f32_32x32x16_bf16 v[192:207], a[24:27], v[140:143], v[192:207]
  v_mul_f32 v72, v72, v30
  v_mul_f32 v73, v73, v30
  v_mul_f32 v74, v74, v30
  v_mul_f32 v75, v75, v30
  v_fma_f32 v36, v72, v72, s72
  v_fma_f32 v39, v73, v73, s72
  v_mfma_f32_32x32x16_bf16 v[208:223], a[28:31], v[140:143], v[208:223]
  buffer_load_dwordx4 v[180:183], v38, s[60:63], s24 offen offset:1024 sc1
  v_fma_f32 v120, v74, v74, s72
  v_fma_f32 v121, v75, v75, s72
  v_mul_f32 v36, v36, v72
  v_mul_f32 v39, v39, v73
  v_mul_f32 v120, v120, v74
  v_mul_f32 v121, v121, v75
  s_waitcnt vmcnt(13)
  v_mfma_f32_32x32x16_bf16 v[192:207], a[32:35], v[144:147], v[192:207]
  v_exp_f32 v36, v36
  v_exp_f32 v39, v39
  v_exp_f32 v120, v120
  v_exp_f32 v121, v121
  v_fma_f32 v36, v36, s74, s74
  v_fma_f32 v39, v39, s74, s74
  s_waitcnt vmcnt(10)
  s_mov_b64 exec, 1
  buffer_store_dword v10, v9, s[60:63], s6 offen sc1
  s_mov_b64 exec, -1
  s_add_u32 s6, s6, s18
  buffer_load_dwordx4 a[200:203], v15, s[60:63], s4 offen offset:2048 sc1
  v_mfma_f32_32x32x16_bf16 v[208:223], a[36:39], v[144:147], v[208:223]
  s_waitcnt vmcnt(10)
  v_cmp_ne_u32 vcc, s80, v7
  s_cbranch_vccz L_pd_48
  s_mov_b32 s86, 0x100000
L_poll_47:
  buffer_load_dword v7, v14, s[60:63], s20 offen sc1
  s_waitcnt vmcnt(0)
  v_cmp_ne_u32 vcc, s80, v7
  s_cbranch_vccz L_pd_48
  s_sub_u32 s86, s86, 1
  s_cbranch_scc0 L_poll_47
L_pd_48:
  buffer_load_dwordx4 v[184:187], v38, s[60:63], s25 offen sc1
  v_fma_f32 v120, v120, s74, s74
  v_fma_f32 v121, v121, s74, s74
  v_rcp_f32 v36, v36
  v_rcp_f32 v39, v39
  v_rcp_f32 v120, v120
  v_rcp_f32 v121, v121
  v_mfma_f32_32x32x16_bf16 v[192:207], a[40:43], v[148:151], v[192:207]
  v_mul_f32 v36, v36, v72
  v_mul_f32 v39, v39, v73
  v_mul_f32 v120, v120, v74
  v_mul_f32 v121, v121, v75
  v_cvt_pk_bf16_f32 v58, v36, v39
  v_cvt_pk_bf16_f32 v59, v120, v121
  v_mfma_f32_32x32x16_bf16 v[208:223], a[44:47], v[148:151], v[208:223]
  buffer_load_dwordx4 v[188:191], v38, s[60:63], s25 offen offset:1024 sc1
  buffer_store_dwordx4 v[56:59], v38, s[60:63], s13 offen sc1
  v_mul_f32 v76, v76, v30
  v_mul_f32 v77, v77, v30
  v_mul_f32 v78, v78, v30
  v_mul_f32 v79, v79, v30
  v_fma_f32 v36, v76, v76, s72
  v_mfma_f32_32x32x16_bf16 v[192:207], a[48:51], v[152:155], v[192:207]
  v_fma_f32 v39, v77, v77, s72
  v_fma_f32 v120, v78, v78, s72
  v_fma_f32 v121, v79, v79, s72
  v_mul_f32 v36, v36, v76
  v_mul_f32 v39, v39, v77
  v_mul_f32 v120, v120, v78
  buffer_load_dwordx4 a[204:207], v16, s[60:63], s4 offen offset:2048 sc1
  v_mfma_f32_32x32x16_bf16 v[208:223], a[52:55], v[152:155], v[208:223]
  buffer_load_dwordx4 v[128:131], v38, s[60:63], s25 offen offset:2048 sc1
  v_mul_f32 v121, v121, v79
  v_exp_f32 v36, v36
  v_exp_f32 v39, v39
  v_exp_f32 v120, v120
  v_exp_f32 v121, v121
  v_fma_f32 v36, v36, s74, s74
  v_mfma_f32_32x32x16_bf16 v[192:207], a[56:59], v[156:159], v[192:207]
  v_fma_f32 v39, v39, s74, s74
  v_fma_f32 v120, v120, s74, s74
  v_fma_f32 v121, v121, s74, s74
  v_rcp_f32 v36, v36
  v_rcp_f32 v39, v39
  v_rcp_f32 v120, v120
  v_mfma_f32_32x32x16_bf16 v[208:223], a[60:63], v[156:159], v[208:223]
  buffer_load_dwordx4 v[132:135], v38, s[60:63], s25 offen offset:3072 sc1
  v_rcp_f32 v121, v121
  v_mul_f32 v36, v36, v76
  v_mul_f32 v39, v39, v77
  v_mul_f32 v120, v120, v78
  v_mul_f32 v121, v121, v79
  v_cvt_pk_bf16_f32 v60, v36, v39
  s_waitcnt vmcnt(14)
  v_mfma_f32_32x32x16_bf16 v[192:207], a[64:67], v[160:163], v[192:207]
  v_cvt_pk_bf16_f32 v61, v120, v121
  v_mul_f32 v80, v80, v30
  v_mul_f32 v81, v81, v30
  v_mul_f32 v82, v82, v30
  v_mul_f32 v83, v83, v30
  v_fma_f32 v36, v80, v80, s72
  s_add_u32 s4, s4, 0x1000
  buffer_load_dwordx4 a[208:211], v15, s[60:63], s4 offen sc1
  v_mfma_f32_32x32x16_bf16 v[208:223], a[68:71], v[160:163], v[208:223]
  s_add_u32 s25, s25, 0x1000
  buffer_load_dwordx4 v[136:139], v38, s[60:63], s25 offen sc1
  v_fma_f32 v39, v81, v81, s72
  v_fma_f32 v120, v82, v82, s72
  v_fma_f32 v121, v83, v83, s72
  v_mul_f32 v36, v36, v80
  v_mul_f32 v39, v39, v81
  v_mul_f32 v120, v120, v82
  s_waitcnt vmcnt(15)
  v_mfma_f32_32x32x16_bf16 v[192:207], a[72:75], v[164:167], v[192:207]
  v_mul_f32 v121, v121, v83
  v_exp_f32 v36, v36
  v_exp_f32 v39, v39
  v_exp_f32 v120, v120
  v_exp_f32 v121, v121
  v_fma_f32 v36, v36, s74, s74
  v_mfma_f32_32x32x16_bf16 v[208:223], a[76:79], v[164:167], v[208:223]
  buffer_load_dwordx4 v[140:143], v38, s[60:63], s25 offen offset:1024 sc1
  v_fma_f32 v39, v39, s74, s74
  v_fma_f32 v120, v120, s74, s74
  v_fma_f32 v121, v121, s74, s74
  v_rcp_f32 v36, v36
  v_rcp_f32 v39, v39
  v_rcp_f32 v120, v120
  s_waitcnt vmcnt(15)
  v_mfma_f32_32x32x16_bf16 v[192:207], a[80:83], v[168:171], v[192:207]
  v_rcp_f32 v121, v121
  v_mul_f32 v36, v36, v80
  v_mul_f32 v39, v39, v81
  v_mul_f32 v120, v120, v82
  v_mul_f32 v121, v121, v83
  v_cvt_pk_bf16_f32 v62, v36, v39
  buffer_load_dwordx4 a[212:215], v16, s[60:63], s4 offen sc1
  v_mfma_f32_32x32x16_bf16 v[208:223], a[84:87], v[168:171], v[208:223]
  buffer_load_dwordx4 v[144:147], v38, s[60:63], s25 offen offset:2048 sc1
  v_cvt_pk_bf16_f32 v63, v120, v121
  buffer_store_dwordx4 v[60:63], v38, s[60:63], s13 offen offset:1024 sc1
  s_waitcnt vmcnt(17)
  v_mfma_f32_32x32x16_bf16 v[192:207], a[88:91], v[172:175], v[192:207]
  v_mfma_f32_32x32x16_bf16 v[208:223], a[92:95], v[172:175], v[208:223]
  buffer_load_dwordx4 v[148:151], v38, s[60:63], s25 offen offset:3072 sc1
  s_waitcnt vmcnt(16)
  v_mfma_f32_32x32x16_bf16 v[192:207], a[96:99], v[176:179], v[192:207]
  buffer_load_dwordx4 a[216:219], v15, s[60:63], s4 offen offset:2048 sc1
  v_mfma_f32_32x32x16_bf16 v[208:223], a[100:103], v[176:179], v[208:223]
  s_add_u32 s25, s25, 0x1000
  buffer_load_dwordx4 v[152:155], v38, s[60:63], s25 offen sc1
  buffer_load_dword v8, v14, s[60:63], s21 offen sc1
  s_waitcnt vmcnt(18)
  v_mfma_f32_32x32x16_bf16 v[192:207], a[104:107], v[180:183], v[192:207]
  v_mfma_f32_32x32x16_bf16 v[208:223], a[108:111], v[180:183], v[208:223]
  buffer_load_dwordx4 v[156:159], v38, s[60:63], s25 offen offset:1024 sc1
  s_waitcnt vmcnt(16)
  v_mfma_f32_32x32x16_bf16 v[224:239], a[0:3], v[184:187], 0
  buffer_load_dwordx4 a[220:223], v16, s[60:63], s4 offen offset:2048 sc1
  v_mfma_f32_32x32x16_bf16 v[240:255], a[4:7], v[184:187], 0
  buffer_load_dwordx4 v[160:163], v38, s[60:63], s25 offen offset:2048 sc1
  s_waitcnt vmcnt(17)
  v_mfma_f32_32x32x16_bf16 v[224:239], a[8:11], v[188:191], v[224:239]
  s_waitcnt vmcnt(7)
  s_mov_b64 exec, 1
  buffer_store_dword v10, v9, s[60:63], s6 offen sc1
  s_mov_b64 exec, -1
  s_add_u32 s6, s6, s18
  v_mfma_f32_32x32x16_bf16 v[240:255], a[12:15], v[188:191], v[240:255]
  buffer_load_dwordx4 v[164:167], v38, s[60:63], s25 offen offset:3072 sc1
  v_mfma_f32_32x32x16_bf16 v[224:239], a[16:19], v[128:131], v[224:239]
  v_mfma_f32_32x32x16_bf16 v[240:255], a[20:23], v[128:131], v[240:255]
  s_add_u32 s25, s25, 0x1000
  buffer_load_dwordx4 v[168:171], v38, s[60:63], s25 offen sc1
  v_mfma_f32_32x32x16_bf16 v[224:239], a[24:27], v[132:135], v[224:239]
  v_mfma_f32_32x32x16_bf16 v[240:255], a[28:31], v[132:135], v[240:255]
  buffer_load_dwordx4 v[172:175], v38, s[60:63], s25 offen offset:1024 sc1
  v_mfma_f32_32x32x16_bf16 v[224:239], a[32:35], v[136:139], v[224:239]
  v_mfma_f32_32x32x16_bf16 v[240:255], a[36:39], v[136:139], v[240:255]
  s_waitcnt vmcnt(7)
  v_cmp_ne_u32 vcc, s80, v8
  s_cbranch_vccz L_pd_50
  s_mov_b32 s86, 0x100000
L_poll_49:
  buffer_load_dword v8, v14, s[60:63], s21 offen sc1
  s_waitcnt vmcnt(0)
  v_cmp_ne_u32 vcc, s80, v8
  s_cbranch_vccz L_pd_50
  s_sub_u32 s86, s86, 1
  s_cbranch_scc0 L_poll_49
L_pd_50:
  buffer_load_dwordx4 v[176:179], v38, s[60:63], s26 offen sc1
  v_mfma_f32_32x32x16_bf16 v[224:239], a[40:43], v[140:143], v[224:239]
  v_mfma_f32_32x32x16_bf16 v[240:255], a[44:47], v[140:143], v[240:255]
  buffer_load_dwordx4 v[180:183], v38, s[60:63], s26 offen offset:1024 sc1
  v_mfma_f32_32x32x16_bf16 v[224:239], a[48:51], v[144:147], v[224:239]
  v_mfma_f32_32x32x16_bf16 v[240:255], a[52:55], v[144:147], v[240:255]
  buffer_load_dwordx4 v[184:187], v38, s[60:63], s26 offen offset:2048 sc1
  v_mfma_f32_32x32x16_bf16 v[224:239], a[56:59], v[148:151], v[224:239]
  v_mfma_f32_32x32x16_bf16 v[240:255], a[60:63], v[148:151], v[240:255]
  buffer_load_dwordx4 v[188:191], v38, s[60:63], s26 offen offset:3072 sc1
  v_mfma_f32_32x32x16_bf16 v[224:239], a[64:67], v[152:155], v[224:239]
  v_mfma_f32_32x32x16_bf16 v[240:255], a[68:71], v[152:155], v[240:255]
  s_add_u32 s26, s26, 0x1000
  buffer_load_dwordx4 v[128:131], v38, s[60:63], s26 offen sc1
  s_waitcnt vmcnt(11)
  v_mfma_f32_32x32x16_bf16 v[224:239], a[72:75], v[156:159], v[224:239]
  v_mfma_f32_32x32x16_bf16 v[240:255], a[76:79], v[156:159], v[240:255]
  buffer_load_dwordx4 v[132:135], v38, s[60:63], s26 offen offset:1024 sc1
  s_waitcnt vmcnt(10)
  v_mfma_f32_32x32x16_bf16 v[224:239], a[80:83], v[160:163], v[224:239]
  v_mfma_f32_32x32x16_bf16 v[240:255], a[84:87], v[160:163], v[240:255]
  buffer_load_dwordx4 v[136:139], v38, s[60:63], s26 offen offset:2048 sc1
  s_waitcnt vmcnt(9)
  v_mfma_f32_32x32x16_bf16 v[224:239], a[88:91], v[164:167], v[224:239]
  v_mfma_f32_32x32x16_bf16 v[240:255], a[92:95], v[164:167], v[240:255]
  buffer_load_dwordx4 v[140:143], v38, s[60:63], s26 offen offset:3072 sc1
  s_waitcnt vmcnt(9)
  v_mfma_f32_32x32x16_bf16 v[224:239], a[96:99], v[168:171], v[224:239]
  v_mfma_f32_32x32x16_bf16 v[240:255], a[100:103], v[168:171], v[240:255]
  s_add_u32 s26, s26, 0x1000
  buffer_load_dwordx4 v[144:147], v38, s[60:63], s26 offen sc1
  buffer_load_dword v7, v14, s[60:63], s22 offen sc1
  s_waitcnt vmcnt(10)
  v_mfma_f32_32x32x16_bf16 v[224:239], a[104:107], v[172:175], v[224:239]
  v_mfma_f32_32x32x16_bf16 v[240:255], a[108:111], v[172:175], v[240:255]
  buffer_load_dwordx4 v[148:151], v38, s[60:63], s26 offen offset:1024 sc1
  s_waitcnt vmcnt(10)
  v_mfma_f32_32x32x16_bf16 v[224:239], a[112:115], v[176:179], v[224:239]
  v_mfma_f32_32x32x16_bf16 v[240:255], a[116:119], v[176:179], v[240:255]
  buffer_load_dwordx4 v[152:155], v38, s[60:63], s26 offen offset:2048 sc1
  s_waitcnt vmcnt(10)
  v_mfma_f32_32x32x16_bf16 v[224:239], a[120:123], v[180:183], v[224:239]
  v_mfma_f32_32x32x16_bf16 v[240:255], a[124:127], v[180:183], v[240:255]
  buffer_load_dwordx4 v[156:159], v38, s[60:63], s26 offen offset:3072 sc1
  s_waitcnt vmcnt(10)
  v_mfma_f32_32x32x16_bf16 v[224:239], a[128:131], v[184:187], v[224:239]
  v_mfma_f32_32x32x16_bf16 v[240:255], a[132:135], v[184:187], v[240:255]
  s_add_u32 s26, s26, 0x1000
  buffer_load_dwordx4 v[160:163], v38, s[60:63], s26 offen sc1
  s_waitcnt vmcnt(10)
  v_mfma_f32_32x32x16_bf16 v[224:239], a[136:139], v[188:191], v[224:239]
  v_mfma_f32_32x32x16_bf16 v[240:255], a[140:143], v[188:191], v[240:255]
  buffer_load_dwordx4 v[164:167], v38, s[60:63], s26 offen offset:1024 sc1
  s_waitcnt vmcnt(10)
  v_mfma_f32_32x32x16_bf16 v[224:239], a[144:147], v[128:131], v[224:239]
  v_mfma_f32_32x32x16_bf16 v[240:255], a[148:151], v[128:131], v[240:255]
  s_waitcnt vmcnt(5)
  v_cmp_ne_u32 vcc, s80, v7
  s_cbranch_vccz L_pd_52
  s_mov_b32 s86, 0x100000
L_poll_51:
  buffer_load_dword v7, v14, s[60:63], s22 offen sc1
  s_waitcnt vmcnt(0)
  v_cmp_ne_u32 vcc, s80, v7
  s_cbranch_vccz L_pd_52
  s_sub_u32 s86, s86, 1
  s_cbranch_scc0 L_poll_51
L_pd_52:
  buffer_load_dwordx4 v[168:171], v38, s[60:63], s27 offen sc1
  v_mfma_f32_32x32x16_bf16 v[224:239], a[152:155], v[132:135], v[224:239]
  v_mfma_f32_32x32x16_bf16 v[240:255], a[156:159], v[132:135], v[240:255]
  buffer_load_dwordx4 v[172:175], v38, s[60:63], s27 offen offset:1024 sc1
  v_mfma_f32_32x32x16_bf16 v[224:239], a[160:163], v[136:139], v[224:239]
  v_mfma_f32_32x32x16_bf16 v[240:255], a[164:167], v[136:139], v[240:255]
  buffer_load_dwordx4 v[176:179], v38, s[60:63], s27 offen offset:2048 sc1
  v_mfma_f32_32x32x16_bf16 v[224:239], a[168:171], v[140:143], v[224:239]
  v_mfma_f32_32x32x16_bf16 v[240:255], a[172:175], v[140:143], v[240:255]
  buffer_load_dwordx4 v[180:183], v38, s[60:63], s27 offen offset:3072 sc1
  v_mfma_f32_32x32x16_bf16 v[224:239], a[176:179], v[144:147], v[224:239]
  v_mfma_f32_32x32x16_bf16 v[240:255], a[180:183], v[144:147], v[240:255]
  s_add_u32 s27, s27, 0x1000
  buffer_load_dwordx4 v[184:187], v38, s[60:63], s27 offen sc1
  s_waitcnt vmcnt(9)
  v_mfma_f32_32x32x16_bf16 v[224:239], a[184:187], v[148:151], v[224:239]
  v_mfma_f32_32x32x16_bf16 v[240:255], a[188:191], v[148:151], v[240:255]
  buffer_load_dwordx4 v[188:191], v38, s[60:63], s27 offen offset:1024 sc1
  s_waitcnt vmcnt(9)
  v_mfma_f32_32x32x16_bf16 v[224:239], a[192:195], v[152:155], v[224:239]
  v_mfma_f32_32x32x16_bf16 v[240:255], a[196:199], v[152:155], v[240:255]
  buffer_load_dwordx4 v[128:131], v38, s[60:63], s27 offen offset:2048 sc1
  s_waitcnt vmcnt(9)
  v_mfma_f32_32x32x16_bf16 v[224:239], a[200:203], v[156:159], v[224:239]
  v_mfma_f32_32x32x16_bf16 v[240:255], a[204:207], v[156:159], v[240:255]
  buffer_load_dwordx4 v[132:135], v38, s[60:63], s27 offen offset:3072 sc1
  s_waitcnt vmcnt(9)
  v_mfma_f32_32x32x16_bf16 v[224:239], a[208:211], v[160:163], v[224:239]
  v_mfma_f32_32x32x16_bf16 v[240:255], a[212:215], v[160:163], v[240:255]
  s_add_u32 s27, s27, 0x1000
  buffer_load_dwordx4 v[136:139], v38, s[60:63], s27 offen sc1
  s_waitcnt vmcnt(9)
  v_mfma_f32_32x32x16_bf16 v[224:239], a[216:219], v[164:167], v[224:239]
  v_mfma_f32_32x32x16_bf16 v[240:255], a[220:223], v[164:167], v[240:255]
  buffer_load_dwordx4 v[140:143], v38, s[60:63], s27 offen offset:1024 sc1
  s_waitcnt vmcnt(9)
  v_mfma_f32_32x32x16_bf16 v[192:207], a[112:115], v[168:171], v[192:207]
  v_mfma_f32_32x32x16_bf16 v[208:223], a[116:119], v[168:171], v[208:223]
  buffer_load_dwordx4 v[144:147], v38, s[60:63], s27 offen offset:2048 sc1
  s_waitcnt vmcnt(9)
  v_mfma_f32_32x32x16_bf16 v[192:207], a[120:123], v[172:175], v[192:207]
  s_nop 4
  ds_write_b128 v18, v[240:243] offset:24576
  v_mfma_f32_32x32x16_bf16 v[208:223], a[124:127], v[172:175], v[208:223]
  buffer_load_dwordx4 v[148:151], v38, s[60:63], s27 offen offset:3072 sc1
  ds_write_b128 v18, v[244:247] offset:25600
  s_waitcnt vmcnt(9)
  v_mfma_f32_32x32x16_bf16 v[192:207], a[128:131], v[176:179], v[192:207]
  ds_write_b128 v19, v[232:235] offset:24576
  v_mfma_f32_32x32x16_bf16 v[208:223], a[132:135], v[176:179], v[208:223]
  s_add_u32 s27, s27, 0x1000
  buffer_load_dwordx4 v[152:155], v38, s[60:63], s27 offen sc1
  ds_write_b128 v19, v[236:239] offset:25600
  s_waitcnt vmcnt(9)
  v_mfma_f32_32x32x16_bf16 v[192:207], a[136:139], v[180:183], v[192:207]
  ds_write_b128 v20, v[248:251] offset:24576
  v_mfma_f32_32x32x16_bf16 v[208:223], a[140:143], v[180:183], v[208:223]
  buffer_load_dwordx4 v[156:159], v38, s[60:63], s27 offen offset:1024 sc1
  ds_write_b128 v20, v[252:255] offset:25600
  s_waitcnt vmcnt(9)
  v_mfma_f32_32x32x16_bf16 v[192:207], a[144:147], v[184:187], v[192:207]
  s_waitcnt lgkmcnt(0)
  s_barrier
  v_mfma_f32_32x32x16_bf16 v[208:223], a[148:151], v[184:187], v[208:223]
  ds_read_b128 v[84:87], v21 offset:24576
  ds_read_b128 v[88:91], v21 offset:25600
  ds_read_b128 v[92:95], v21 offset:26624
  ds_read_b128 v[96:99], v21 offset:27648
  s_waitcnt vmcnt(8)
  v_mfma_f32_32x32x16_bf16 v[192:207], a[152:155], v[188:191], v[192:207]
  ds_read_b128 v[100:103], v21 offset:28672
  ds_read_b128 v[104:107], v21 offset:29696
  s_mul_i32 s81, s67, 136
  v_add_u32 v6, s81, v11
  ds_read_b64 v[32:33], v6 offset:0
  ds_read_b64 v[34:35], v6 offset:16
  ds_read_b64_tr_b16 v[22:23], v17 offset:1024
  ds_read_b64_tr_b16 v[24:25], v17 offset:1536
  v_lshlrev_b32 v68, 16, v112
  v_mfma_f32_32x32x16_bf16 v[208:223], a[156:159], v[188:191], v[208:223]
  v_and_b32 v69, 0xffff0000, v112
  v_lshlrev_b32 v70, 16, v113
  v_and_b32 v71, 0xffff0000, v113
  v_lshlrev_b32 v72, 16, v114
  s_waitcnt vmcnt(7)
  v_mfma_f32_32x32x16_bf16 v[192:207], a[160:163], v[128:131], v[192:207]
  v_and_b32 v73, 0xffff0000, v114
  v_lshlrev_b32 v74, 16, v115
  v_and_b32 v75, 0xffff0000, v115
  v_add_f32 v224, v224, v68
  v_mfma_f32_32x32x16_bf16 v[208:223], a[164:167], v[128:131], v[208:223]
  v_add_f32 v225, v225, v69
  v_add_f32 v226, v226, v70
  v_add_f32 v227, v227, v71
  v_add_f32 v228, v228, v72
  s_waitcnt vmcnt(6)
  v_mfma_f32_32x32x16_bf16 v[192:207], a[168:171], v[132:135], v[192:207]
  v_add_f32 v229, v229, v73
  v_add_f32 v230, v230, v74
  v_add_f32 v231, v231, v75
  s_waitcnt lgkmcnt(9)
  v_mfma_f32_32x32x16_bf16 v[208:223], a[172:175], v[132:135], v[208:223]
  v_add_f32 v224, v224, v84
  v_add_f32 v225, v225, v85
  v_add_f32 v226, v226, v86
  v_add_f32 v227, v227, v87
  s_waitcnt vmcnt(5)
  v_mfma_f32_32x32x16_bf16 v[192:207], a[176:179], v[136:139], v[192:207]
  s_waitcnt lgkmcnt(8)
  v_add_f32 v228, v228, v88
  v_add_f32 v229, v229, v89
  v_add_f32 v230, v230, v90
  v_mfma_f32_32x32x16_bf16 v[208:223], a[180:183], v[136:139], v[208:223]
  v_add_f32 v231, v231, v91
  s_waitcnt lgkmcnt(7)
  v_add_f32 v224, v224, v92
  v_add_f32 v225, v225, v93
  s_waitcnt vmcnt(4)
  v_mfma_f32_32x32x16_bf16 v[192:207], a[184:187], v[140:143], v[192:207]
  v_add_f32 v226, v226, v94
  v_add_f32 v227, v227, v95
  s_waitcnt lgkmcnt(6)
  v_add_f32 v228, v228, v96
  v_mfma_f32_32x32x16_bf16 v[208:223], a[188:191], v[140:143], v[208:223]
  v_add_f32 v229, v229, v97
  v_add_f32 v230, v230, v98
  v_add_f32 v231, v231, v99
  s_waitcnt lgkmcnt(5)
  s_waitcnt vmcnt(3)
  v_mfma_f32_32x32x16_bf16 v[192:207], a[192:195], v[144:147], v[192:207]
  v_add_f32 v224, v224, v100
  v_add_f32 v225, v225, v101
  v_add_f32 v226, v226, v102
  v_add_f32 v227, v227, v103
  v_mfma_f32_32x32x16_bf16 v[208:223], a[196:199], v[144:147], v[208:223]
  s_waitcnt lgkmcnt(4)
  v_add_f32 v228, v228, v104
  v_add_f32 v229, v229, v105
  v_add_f32 v230, v230, v106
  s_waitcnt vmcnt(2)
  v_mfma_f32_32x32x16_bf16 v[192:207], a[200:203], v[148:151], v[192:207]
  v_add_f32 v231, v231, v107
  v_mul_f32 v76, s64, v224
  v_mul_f32 v77, s64, v225
  v_mul_f32 v78, s64, v226
  v_mfma_f32_32x32x16_bf16 v[208:223], a[204:207], v[148:151], v[208:223]
  v_mul_f32 v79, s64, v227
  v_mul_f32 v80, s64, v228
  v_mul_f32 v81, s64, v229
  v_mul_f32 v82, s64, v230
  s_waitcnt vmcnt(1)
  v_mfma_f32_32x32x16_bf16 v[192:207], a[208:211], v[152:155], v[192:207]
  v_mul_f32 v83, s64, v231
  v_exp_f32 v76, v76
  v_exp_f32 v77, v77
  v_exp_f32 v78, v78
  v_mfma_f32_32x32x16_bf16 v[208:223], a[212:215], v[152:155], v[208:223]
  v_exp_f32 v79, v79
  v_exp_f32 v80, v80
  v_exp_f32 v81, v81
  v_exp_f32 v82, v82
  s_waitcnt vmcnt(0)
  v_mfma_f32_32x32x16_bf16 v[192:207], a[216:219], v[156:159], v[192:207]
  v_exp_f32 v83, v83
  s_waitcnt lgkmcnt(0)
  v_lshlrev_b32 v68, 16, v22
  v_and_b32 v69, 0xffff0000, v22
  v_mfma_f32_32x32x16_bf16 v[208:223], a[220:223], v[156:159], v[208:223]
  v_lshlrev_b32 v70, 16, v23
  v_and_b32 v71, 0xffff0000, v23
  v_lshlrev_b32 v72, 16, v24
  v_and_b32 v73, 0xffff0000, v24
  s_nop 7
  ds_write_b128 v18, v[208:211] offset:0
  v_lshlrev_b32 v74, 16, v25
  v_and_b32 v75, 0xffff0000, v25
  v_add_f32 v76, 1.0, v76
  v_add_f32 v77, 1.0, v77
  ds_write_b128 v18, v[212:215] offset:1024
  v_add_f32 v78, 1.0, v78
  v_add_f32 v79, 1.0, v79
  v_add_f32 v80, 1.0, v80
  v_add_f32 v81, 1.0, v81
  ds_write_b128 v19, v[200:203] offset:0
  v_add_f32 v82, 1.0, v82
  v_add_f32 v83, 1.0, v83
  v_mul_f32 v224, v224, v68
  v_mul_f32 v225, v225, v69
  ds_write_b128 v19, v[204:207] offset:1024
  v_mul_f32 v226, v226, v70
  v_mul_f32 v227, v227, v71
  v_mul_f32 v228, v228, v72
  v_mul_f32 v229, v229, v73
  ds_write_b128 v20, v[216:219] offset:0
  v_mul_f32 v230, v230, v74
  v_mul_f32 v231, v231, v75
  v_rcp_f32 v76, v76
  v_rcp_f32 v77, v77
  ds_write_b128 v20, v[220:223] offset:1024
  v_rcp_f32 v78, v78
  v_rcp_f32 v79, v79
  v_rcp_f32 v80, v80
  v_rcp_f32 v81, v81
  s_waitcnt lgkmcnt(0)
  s_barrier
  v_rcp_f32 v82, v82
  v_rcp_f32 v83, v83
  v_lshlrev_b32 v68, 16, v32
  v_and_b32 v69, 0xffff0000, v32
  v_lshlrev_b32 v70, 16, v33
  v_and_b32 v71, 0xffff0000, v33
  v_lshlrev_b32 v72, 16, v34
  v_and_b32 v73, 0xffff0000, v34
  v_lshlrev_b32 v74, 16, v35
  v_and_b32 v75, 0xffff0000, v35
  v_fma_f32 v224, v224, v76, v68
  v_fma_f32 v225, v225, v77, v69
  v_fma_f32 v226, v226, v78, v70
  v_fma_f32 v227, v227, v79, v71
  v_fma_f32 v228, v228, v80, v72
  v_fma_f32 v229, v229, v81, v73
  v_fma_f32 v230, v230, v82, v74
  v_fma_f32 v231, v231, v83, v75
  v_cvt_pk_bf16_f32 v84, v224, v225
  v_cvt_pk_bf16_f32 v85, v226, v227
  v_cvt_pk_bf16_f32 v86, v228, v229
  v_cvt_pk_bf16_f32 v87, v230, v231
  s_lshl_b32 s82, s67, 10
  v_permlane32_swap_b32 v84, v86
  v_permlane32_swap_b32 v85, v87
  buffer_store_dwordx4 v[84:87], v3, s[56:59], s82 offen
  s_nop 1
  ds_read_b128 v[84:87], v21 offset:0
  ds_read_b128 v[88:91], v21 offset:1024
  ds_read_b128 v[92:95], v21 offset:2048
  ds_read_b128 v[96:99], v21 offset:3072
  ds_read_b128 v[100:103], v21 offset:4096
  ds_read_b128 v[104:107], v21 offset:5120
  s_mul_i32 s81, s66, 136
  v_add_u32 v6, s81, v11
  ds_read_b64 v[32:33], v6 offset:0
  ds_read_b64 v[34:35], v6 offset:16
  ds_read_b64_tr_b16 v[22:23], v17 offset:0
  ds_read_b64_tr_b16 v[24:25], v17 offset:512
  v_lshlrev_b32 v68, 16, v108
  v_and_b32 v69, 0xffff0000, v108
  v_lshlrev_b32 v70, 16, v109
  v_and_b32 v71, 0xffff0000, v109
  v_lshlrev_b32 v72, 16, v110
  v_and_b32 v73, 0xffff0000, v110
  v_lshlrev_b32 v74, 16, v111
  v_and_b32 v75, 0xffff0000, v111
  v_pk_add_f32 v[192:193], v[192:193], v[68:69]
  v_pk_add_f32 v[194:195], v[194:195], v[70:71]
  v_pk_add_f32 v[196:197], v[196:197], v[72:73]
  v_pk_add_f32 v[198:199], v[198:199], v[74:75]
  s_waitcnt lgkmcnt(9)
  v_pk_add_f32 v[192:193], v[192:193], v[84:85]
  v_pk_add_f32 v[194:195], v[194:195], v[86:87]
  s_waitcnt lgkmcnt(8)
  v_pk_add_f32 v[196:197], v[196:197], v[88:89]
  v_pk_add_f32 v[198:199], v[198:199], v[90:91]
  s_waitcnt lgkmcnt(7)
  v_pk_add_f32 v[192:193], v[192:193], v[92:93]
  v_pk_add_f32 v[194:195], v[194:195], v[94:95]
  s_waitcnt lgkmcnt(6)
  v_pk_add_f32 v[196:197], v[196:197], v[96:97]
  v_pk_add_f32 v[198:199], v[198:199], v[98:99]
  s_waitcnt lgkmcnt(5)
  v_pk_add_f32 v[192:193], v[192:193], v[100:101]
  v_pk_add_f32 v[194:195], v[194:195], v[102:103]
  s_waitcnt lgkmcnt(4)
  v_pk_add_f32 v[196:197], v[196:197], v[104:105]
  v_pk_add_f32 v[198:199], v[198:199], v[106:107]
  v_pk_mul_f32 v[76:77], v[192:193], s[64:65]
  v_pk_mul_f32 v[78:79], v[194:195], s[64:65]
  v_pk_mul_f32 v[80:81], v[196:197], s[64:65]
  v_pk_mul_f32 v[82:83], v[198:199], s[64:65]
  v_exp_f32 v76, v76
  v_exp_f32 v77, v77
  v_exp_f32 v78, v78
  v_exp_f32 v79, v79
  v_exp_f32 v80, v80
  v_exp_f32 v81, v81
  v_exp_f32 v82, v82
  v_exp_f32 v83, v83
  s_waitcnt lgkmcnt(0)
  v_lshlrev_b32 v68, 16, v22
  v_and_b32 v69, 0xffff0000, v22
  v_lshlrev_b32 v70, 16, v23
  v_and_b32 v71, 0xffff0000, v23
  v_lshlrev_b32 v72, 16, v24
  v_and_b32 v73, 0xffff0000, v24
  v_lshlrev_b32 v74, 16, v25
  v_and_b32 v75, 0xffff0000, v25
  v_pk_add_f32 v[76:77], v[76:77], 1.0 op_sel_hi:[1,0]
  v_pk_add_f32 v[78:79], v[78:79], 1.0 op_sel_hi:[1,0]
  v_pk_add_f32 v[80:81], v[80:81], 1.0 op_sel_hi:[1,0]
  v_pk_add_f32 v[82:83], v[82:83], 1.0 op_sel_hi:[1,0]
  v_pk_mul_f32 v[192:193], v[192:193], v[68:69]
  v_pk_mul_f32 v[194:195], v[194:195], v[70:71]
  v_pk_mul_f32 v[196:197], v[196:197], v[72:73]
  v_pk_mul_f32 v[198:199], v[198:199], v[74:75]
  v_rcp_f32 v76, v76
  v_rcp_f32 v77, v77
  v_rcp_f32 v78, v78
  v_rcp_f32 v79, v79
  v_rcp_f32 v80, v80
  v_rcp_f32 v81, v81
  v_rcp_f32 v82, v82
  v_rcp_f32 v83, v83
  v_lshlrev_b32 v68, 16, v32
  v_and_b32 v69, 0xffff0000, v32
  v_lshlrev_b32 v70, 16, v33
  v_and_b32 v71, 0xffff0000, v33
  v_lshlrev_b32 v72, 16, v34
  v_and_b32 v73, 0xffff0000, v34
  v_lshlrev_b32 v74, 16, v35
  v_and_b32 v75, 0xffff0000, v35
  v_pk_fma_f32 v[192:193], v[192:193], v[76:77], v[68:69]
  v_pk_fma_f32 v[194:195], v[194:195], v[78:79], v[70:71]
  v_pk_fma_f32 v[196:197], v[196:197], v[80:81], v[72:73]
  v_pk_fma_f32 v[198:199], v[198:199], v[82:83], v[74:75]
  v_cvt_pk_bf16_f32 v84, v192, v193
  v_cvt_pk_bf16_f32 v85, v194, v195
  v_cvt_pk_bf16_f32 v86, v196, v197
  v_cvt_pk_bf16_f32 v87, v198, v199
  s_lshl_b32 s82, s66, 10
  v_permlane32_swap_b32 v84, v86
  v_permlane32_swap_b32 v85, v87
  buffer_store_dwordx4 v[84:87], v3, s[56:59], s82 offen
  s_xor_b32 s81, s2, 0
  s_or_b32 s81, s81, s3
  s_cmp_lg_u32 s81, 0
  s_cbranch_scc1 L_fin
  v_lshrrev_b32 v6, 3, v1
  v_lshlrev_b32 v6, 9, v6
  v_and_b32 v7, 7, v1
  v_lshl_add_u32 v6, v7, 4, v6
  v_add_u32 v6, 0x5000, v6
  s_mov_b32 s86, 0x100000
L_gen_53:
  buffer_load_dwordx4 v[240:243], v6, s[60:63], 0 offen sc1
  s_waitcnt vmcnt(0)
  v_xor_b32 v240, s80, v240
  v_xor_b32 v241, s80, v241
  v_xor_b32 v242, s80, v242
  v_xor_b32 v243, s80, v243
  v_or3_b32 v240, v240, v241, v242
  v_or_b32 v240, v240, v243
  v_cmp_ne_u32 vcc, 0, v240
  s_cbranch_vccz L_gend_54
  s_sub_u32 s86, s86, 1
  s_cbranch_scc0 L_gen_53
L_gend_54:
  s_mov_b64 exec, 1
  buffer_store_dword v10, v9, s[60:63], 0 offen sc1
  s_mov_b64 exec, -1
  s_branch L_fin
L_p3skip_41:
  s_waitcnt vmcnt(1)
  s_mov_b64 exec, 1
  buffer_store_dword v10, v9, s[60:63], s7 offen sc1
  s_mov_b64 exec, -1
  s_and_b32 s82, s76, 1
  s_xor_b32 s83, s82, 1
  s_lshl_b32 s66, s82, 5
  s_lshl_b32 s67, s83, 5
  s_lshr_b32 s81, s78, 5
  s_mul_i32 s84, s81, 114688
  s_mul_i32 s85, s3, 28672
  s_add_u32 s84, s84, s85
  s_add_u32 s84, s84, 0x600000
  s_mul_i32 s24, s82, 129024
  s_add_u32 s24, s24, s84
  s_mul_i32 s25, s83, 114688
  s_mul_i32 s85, s82, 14336
  s_add_u32 s25, s25, s85
  s_add_u32 s25, s25, s84
  s_mul_i32 s26, s83, 129024
  s_add_u32 s26, s26, s84
  s_mul_i32 s27, s82, 114688
  s_mul_i32 s85, s83, 14336
  s_add_u32 s27, s27, s85
  s_add_u32 s27, s27, s84
  s_lshr_b32 s81, s78, 7
  s_lshl_b32 s84, s81, 10
  s_lshl_b32 s85, s3, 5
  s_add_u32 s84, s84, s85
  s_add_u32 s84, s84, 0x8000
  v_min_u32 v6, 6, v1
  v_lshl_add_u32 v14, v6, 2, s84
  s_mul_i32 s19, s82, 896
  s_mul_i32 s20, s82, 384
  s_add_u32 s20, s20, 0x100
  s_lshl_b32 s21, s82, 7
  s_add_u32 s21, s21, 0x180
  s_mul_i32 s22, s82, 640
  s_add_u32 s22, s22, 0x80
  s_lshl_b32 s81, s78, 10
  s_lshl_b32 s85, s77, 7
  s_add_u32 s81, s81, s85
  s_lshl_b32 s85, s90, 6
  s_add_u32 s81, s81, s85
  s_lshl_b32 s85, s89, 5
  s_add_u32 s81, s81, s85
  v_lshlrev_b32 v6, 10, v4
  v_add_u32 v6, s81, v6
  v_lshl_add_u32 v3, v5, 4, v6
  s_lshl_b32 s81, s90, 6
  s_lshl_b32 s85, s89, 5
  s_add_u32 s81, s81, s85
  s_add_u32 s81, s81, 0x24000
  v_mul_u32_u24 v11, 136, v4
  v_lshl_add_u32 v11, v5, 3, v11
  v_add_u32 v11, s81, v11
  s_lshl_b32 s81, s77, 18
  s_lshl_b32 s85, s90, 17
  s_add_u32 s81, s81, s85
  s_lshl_b32 s85, s89, 3
  s_add_u32 s81, s81, s85
  s_lshl_b32 s85, s78, 4
  s_add_u32 s81, s81, s85
  s_add_u32 s81, s81, 0x300000
  v_lshl_add_u32 v6, v5, 11, v4
  v_lshl_add_u32 v12, v6, 4, s81
  s_lshl_b32 s81, s77, 18
  s_lshl_b32 s85, s90, 17
  s_add_u32 s81, s81, s85
  s_lshl_b32 s85, s89, 16
  s_add_u32 s81, s81, s85
  s_lshl_b32 s85, s78, 1
  s_add_u32 s81, s81, s85
  s_add_u32 s81, s81, 0x1000000
  v_lshrrev_b32 v6, 2, v1
  v_lshlrev_b32 v6, 12, v6
  v_and_b32 v7, 3, v1
  v_lshl_add_u32 v6, v7, 4, v6
  v_add_u32 v13, s81, v6
  s_lshl_b32 s81, s3, 11
  s_add_u32 s81, s81, 0xc000
  v_add_u32 v17, s81, v37
  s_xor_b32 s81, s3, 1
  s_mul_i32 s82, s81, 6144
  v_add_u32 v18, s82, v38
  s_xor_b32 s81, s3, 2
  s_mul_i32 s82, s81, 6144
  s_add_u32 s82, s82, 0x800
  v_add_u32 v19, s82, v38
  s_xor_b32 s81, s3, 3
  s_mul_i32 s82, s81, 6144
  s_add_u32 s82, s82, 0x1000
  v_add_u32 v20, s82, v38
  s_mul_i32 s81, s3, 6144
  v_add_u32 v21, s81, v38
  s_lshr_b32 s82, s34, 2
  s_lshl_b32 s81, s77, 9
  s_lshl_b32 s85, s82, 8
  s_add_u32 s81, s81, s85
  s_lshl_b32 s85, s90, 6
  s_add_u32 s81, s81, s85
  s_lshl_b32 s85, s89, 5
  s_add_u32 s81, s81, s85
  s_add_u32 s81, s81, 0x5000
  v_bfe_u32 v6, v1, 3, 1
  v_and_b32 v7, 7, v1
  v_lshl_add_u32 v6, v6, 5, v7
  v_lshl_add_u32 v2, v6, 2, s81
  s_mov_b32 s64, 0xbfb8aa3b
  s_mov_b32 s65, 0xbfb8aa3b
  s_waitcnt vmcnt(0) lgkmcnt(0)
  s_barrier
  buffer_load_dwordx4 a[44:47], v16, s[60:63], s4 offen offset:2048 sc1
  s_add_u32 s4, s4, 0x1000
  buffer_load_dwordx4 a[48:51], v15, s[60:63], s4 offen sc1
  buffer_load_dwordx4 a[52:55], v16, s[60:63], s4 offen sc1
  buffer_load_dwordx4 a[56:59], v15, s[60:63], s4 offen offset:2048 sc1
  buffer_load_dwordx4 a[60:63], v16, s[60:63], s4 offen offset:2048 sc1
  s_add_u32 s4, s4, 0x1000
  buffer_load_dwordx4 a[64:67], v15, s[60:63], s4 offen sc1
  buffer_load_dwordx4 a[68:71], v16, s[60:63], s4 offen sc1
  buffer_load_dwordx4 a[72:75], v15, s[60:63], s4 offen offset:2048 sc1
  buffer_load_dwordx4 a[76:79], v16, s[60:63], s4 offen offset:2048 sc1
  s_add_u32 s4, s4, 0x1000
  buffer_load_dwordx4 a[80:83], v15, s[60:63], s4 offen sc1
  buffer_load_dwordx4 a[84:87], v16, s[60:63], s4 offen sc1
  buffer_load_dwordx4 a[88:91], v15, s[60:63], s4 offen offset:2048 sc1
  buffer_load_dwordx4 a[92:95], v16, s[60:63], s4 offen offset:2048 sc1
  s_add_u32 s4, s4, 0x1000
  buffer_load_dwordx4 a[96:99], v15, s[60:63], s4 offen sc1
  buffer_load_dwordx4 a[100:103], v16, s[60:63], s4 offen sc1
  buffer_load_dwordx4 a[104:107], v15, s[60:63], s4 offen offset:2048 sc1
  buffer_load_dwordx4 a[108:111], v16, s[60:63], s4 offen offset:2048 sc1
  s_mov_b32 s4, s9
  buffer_load_dwordx4 a[112:115], v15, s[60:63], s4 offen sc1
  buffer_load_dwordx4 a[116:119], v16, s[60:63], s4 offen sc1
  buffer_load_dwordx4 a[120:123], v15, s[60:63], s4 offen offset:2048 sc1
  buffer_load_dwordx4 a[124:127], v16, s[60:63], s4 offen offset:2048 sc1
  s_add_u32 s4, s4, 0x1000
  buffer_load_dwordx4 a[128:131], v15, s[60:63], s4 offen sc1
  buffer_load_dwordx4 a[132:135], v16, s[60:63], s4 offen sc1
  buffer_load_dwordx4 a[136:139], v15, s[60:63], s4 offen offset:2048 sc1
  buffer_load_dwordx4 a[140:143], v16, s[60:63], s4 offen offset:2048 sc1
  s_add_u32 s4, s4, 0x1000
  buffer_load_dwordx4 a[144:147], v15, s[60:63], s4 offen sc1
  buffer_load_dwordx4 a[148:151], v16, s[60:63], s4 offen sc1
  buffer_load_dwordx4 a[152:155], v15, s[60:63], s4 offen offset:2048 sc1
  buffer_load_dwordx4 a[156:159], v16, s[60:63], s4 offen offset:2048 sc1
  s_add_u32 s4, s4, 0x1000
  buffer_load_dwordx4 a[160:163], v15, s[60:63], s4 offen sc1
  buffer_load_dwordx4 a[164:167], v16, s[60:63], s4 offen sc1
  buffer_load_dwordx4 a[168:171], v15, s[60:63], s4 offen offset:2048 sc1
  buffer_load_dwordx4 a[172:175], v16, s[60:63], s4 offen offset:2048 sc1
  s_add_u32 s4, s4, 0x1000
  buffer_load_dwordx4 a[176:179], v15, s[60:63], s4 offen sc1
  buffer_load_dwordx4 a[180:183], v16, s[60:63], s4 offen sc1
  buffer_load_dwordx4 a[184:187], v15, s[60:63], s4 offen offset:2048 sc1
  buffer_load_dwordx4 a[188:191], v16, s[60:63], s4 offen offset:2048 sc1
  s_lshl_b32 s82, s66, 10
  s_lshl_b32 s84, s66, 4
  s_add_u32 s83, s84, 0x10000
  buffer_load_dwordx2 v[108:109], v12, s[60:63], s84 offen sc1
  buffer_load_dwordx2 v[110:111], v12, s[60:63], s83 offen sc1
  s_lshl_b32 s82, s67, 10
  s_lshl_b32 s84, s67, 4
  s_add_u32 s83, s84, 0x10000
  buffer_load_dwordx2 v[112:113], v12, s[60:63], s84 offen sc1
  buffer_load_dwordx2 v[114:115], v12, s[60:63], s83 offen sc1
  buffer_load_dword v8, v2, s[60:63], 0 offen sc1
  s_waitcnt vmcnt(0)
  v_cmp_ne_u32 vcc, s80, v8
  s_cbranch_vccz L_pd_56
  s_mov_b32 s86, 0x100000
L_poll_55:
  buffer_load_dword v8, v2, s[60:63], 0 offen sc1
  s_waitcnt vmcnt(0)
  v_cmp_ne_u32 vcc, s80, v8
  s_cbranch_vccz L_pd_56
  s_sub_u32 s86, s86, 1
  s_cbranch_scc0 L_poll_55
L_pd_56:
  s_lshl_b32 s81, s3, 11
  s_add_u32 m0, s81, 0xc000
  s_lshl_b32 s81, s66, 1
  buffer_load_dwordx4 v13, s[60:63], s81 offen sc1 lds
  s_lshl_b32 s81, s3, 11
  s_add_u32 m0, s81, 0xc400
  s_lshl_b32 s81, s67, 1
  buffer_load_dwordx4 v13, s[60:63], s81 offen sc1 lds
  buffer_load_dword v7, v14, s[60:63], s19 offen sc1
  s_waitcnt vmcnt(0)
  v_cmp_ne_u32 vcc, s80, v7
  s_cbranch_vccz L_pd_58
  s_mov_b32 s86, 0x100000
L_poll_57:
  buffer_load_dword v7, v14, s[60:63], s19 offen sc1
  s_waitcnt vmcnt(0)
  v_cmp_ne_u32 vcc, s80, v7
  s_cbranch_vccz L_pd_58
  s_sub_u32 s86, s86, 1
  s_cbranch_scc0 L_poll_57
L_pd_58:
  buffer_load_dwordx4 v[128:131], v38, s[60:63], s24 offen sc1
  buffer_load_dwordx4 v[132:135], v38, s[60:63], s24 offen offset:1024 sc1
  buffer_load_dwordx4 v[136:139], v38, s[60:63], s24 offen offset:2048 sc1
  buffer_load_dwordx4 v[140:143], v38, s[60:63], s24 offen offset:3072 sc1
  s_add_u32 s24, s24, 0x1000
  buffer_load_dwordx4 v[144:147], v38, s[60:63], s24 offen sc1
  buffer_load_dwordx4 v[148:151], v38, s[60:63], s24 offen offset:1024 sc1
  buffer_load_dwordx4 v[152:155], v38, s[60:63], s24 offen offset:2048 sc1
  s_waitcnt vmcnt(0) lgkmcnt(0)
  s_branch L_tail_42
L_fin:
L_end:
  s_endpgm
.section .rodata,"a"
.p2align 6
.amdhsa_kernel recurrent_scan__ssm_conv_s4d__mixer_s_mlp__prompt_kernel
  .amdhsa_next_free_vgpr 512
  .amdhsa_next_free_sgpr 102
  .amdhsa_accum_offset 256
  .amdhsa_group_segment_fixed_size 0
  .amdhsa_kernarg_size 120
  .amdhsa_user_sgpr_count 2
  .amdhsa_user_sgpr_kernarg_segment_ptr 1
  .amdhsa_system_sgpr_workgroup_id_x 1
.end_amdhsa_kernel
```
